```python
import torch

def _softmax(x, axis=-1):
    return torch.softmax(x, dim=axis)
def _gelu(x):
    return torch.nn.functional.gelu(x, approximate="tanh")
def _silu(x):
    return torch.nn.functional.silu(x)
def _sigmoid(x):
    return torch.sigmoid(x)
def _layernorm(x, axis=-1, eps=1e-5):
    m = x.mean(dim=axis, keepdim=True)
    v = x.var(dim=axis, keepdim=True, unbiased=False)
    return (x - m) / torch.sqrt(v + eps)
def _scatter_add(tgt, idx, src, axis=0):
    return tgt.clone().index_add_(axis, idx, src)
def _segment_sum(src, seg, n):
    out = torch.zeros((n,) + src.shape[1:], dtype=src.dtype)
    return out.index_add_(0, seg, src)
def _pad(x, pw):
    flat = tuple(v for pair in reversed(pw) for v in pair)
    return torch.nn.functional.pad(x, flat)

kernel_name = 'interleave_layers__linear_kernel_hedgehog__mixer_s_mlp__prompt'

def setup_inputs():

    _w = (lambda a: (lambda t: t.to(torch.bfloat16) if t.is_floating_point() else t)(torch.as_tensor(a)))
    def _A_setup():
        B, S, D, H = 1, 2048, 512, 32
        Dh = D // H
        return {
            "x": _w((lambda *s: torch.randn(*s, dtype=torch.bfloat16) * 0.05)(B, S, D)),
            "wqkv": _w((lambda *s: torch.randn(*s, dtype=torch.bfloat16) * 0.2)(D, 3 * D)),
            "w_phi": _w((lambda *s: torch.randn(*s, dtype=torch.bfloat16) * 0.2)(H, Dh, Dh) * (Dh ** -0.5)),
            "wo": _w((lambda *s: torch.randn(*s, dtype=torch.bfloat16) * 0.05)(D, D)),
        }
    _A_in = _A_setup()

    def _B_setup():
        B, S, D, F = 1, 2048, 512, 1376
        return {
            "x":  _w((lambda *s: torch.randn(*s, dtype=torch.bfloat16) * 0.05)(B, S, D)),
            "w1": _w((lambda *s: torch.randn(*s, dtype=torch.bfloat16) * 3.2)(D, D) * (D ** -0.5)),
            "w2": _w((lambda *s: torch.randn(*s, dtype=torch.bfloat16) * 3.2)(D, D) * (D ** -0.5)),
            "w3": _w((lambda *s: torch.randn(*s, dtype=torch.bfloat16) * 3.2)(D, F) * (D ** -0.5)),
            "w4": _w((lambda *s: torch.randn(*s, dtype=torch.bfloat16) * 3.2)(F, D) * (F ** -0.5)),
        }
    _B_in = _B_setup()

    return {
        "A_x": _A_in["x"],
        "A_wqkv": _A_in["wqkv"],
        "A_w_phi": _A_in["w_phi"],
        "A_wo": _A_in["wo"],
        "B_x": _B_in["x"],
        "B_w1": _B_in["w1"],
        "B_w2": _B_in["w2"],
        "B_w3": _B_in["w3"],
        "B_w4": _B_in["w4"],
    }

def reference(A_x, A_wqkv, A_w_phi, A_wo, B_x, B_w1, B_w2, B_w3, B_w4):
    def _A_ref(x, wqkv, w_phi, wo):
        B, S, D = x.shape
        H = 32; Dh = D // H
        qkv = (lambda x, *d: x.permute(*d))((x @ wqkv).reshape(B, S, 3, H, Dh), 2, 0, 3, 1, 4)
        q, k, v = qkv[0], qkv[1], qkv[2]
        pq = torch.einsum("bhsd,hdf->bhsf", q, w_phi)
        pk = torch.einsum("bhsd,hdf->bhsf", k, w_phi)
        phi_q = torch.concatenate([_softmax(pq, axis=-1), _softmax(-pq, axis=-1)], axis=-1)
        phi_k = torch.concatenate([_softmax(pk, axis=-1), _softmax(-pk, axis=-1)], axis=-1)
        kv = torch.einsum("bhsf,bhsd->bhfd", phi_k, v)
        z  = torch.einsum("bhsf->bhf", phi_k)
        num = torch.einsum("bhqf,bhfd->bhqd", phi_q, kv)
        den = torch.einsum("bhqf,bhf->bhq", phi_q, z)[..., None] + 1e-6
        o = num / den
        return (lambda x, *d: x.permute(*d))(o, 0, 2, 1, 3).reshape(B, S, D) @ wo

    def _B_ref(x, w1, w2, w3, w4):
        B, S, D = x.shape
        h = _gelu(_layernorm(x, axis=-1) @ w1)
        c = D // 4
        g0 = _pad(h[:, :, 0*c:1*c], ((0, 0), (1, 0), (0, 0)))[:, :S, :]
        g1 = _pad(h[:, :, 1*c:2*c], ((0, 0), (0, 1), (0, 0)))[:, 1:, :]
        g2 = _pad(h[:, :, 2*c:3*c], ((0, 0), (2, 0), (0, 0)))[:, :S, :]
        g3 = _pad(h[:, :, 3*c:   ], ((0, 0), (0, 2), (0, 0)))[:, 2:, :]
        hs = torch.concatenate([g0, g1, g2, g3], axis=-1) @ w2
        x1 = x + hs
        h2 = _gelu(_layernorm(x1, axis=-1) @ w3) @ w4
        return x1 + h2

    x = A_x
    x = x + _A_ref(_layernorm(x, axis=-1), A_wqkv, A_w_phi, A_wo)
    x = x + _B_ref(_layernorm(x, axis=-1), B_w1, B_w2, B_w3, B_w4)
    x = x + _A_ref(_layernorm(x, axis=-1), A_wqkv, A_w_phi, A_wo)
    x = x + _B_ref(_layernorm(x, axis=-1), B_w1, B_w2, B_w3, B_w4)
    return x
```

```asm
; @launch kernel=main_kernel grid=(256,1,1) block=(320,1,1) lds=163840
.amdgcn_target "amdgcn-amd-amdhsa--gfx950"
.text
.globl main_kernel
.p2align 8
.type main_kernel,@function
main_kernel:
    s_cmp_ge_u32 s2, 256
    s_cbranch_scc1 L_end_main_kernel
    s_load_dwordx16 s[64:79], s[0:1], 0
    s_load_dwordx8 s[80:87], s[0:1], 64
    v_lshrrev_b32 v1, 6, v0
    v_and_b32 v2, 63, v0
    v_readfirstlane_b32 s32, v1
    v_lshlrev_b32 v10, 6, v2
    s_getreg_b32 s37, hwreg(HW_REG_XCC_ID)
    s_and_b32 s37, s37, 7
    v_mov_b32 v6, 1
    s_cmp_lg_u32 s32, 4
    s_cbranch_scc1 L_pf_main_kernel
    s_lshl_b32 s38, s37, 7
    s_add_u32 s38, s38, 0xe000
    s_mov_b32 s39, 0xe000
    v_lshrrev_b32 v40, 3, v2
    v_lshlrev_b32 v40, 7, v40
    s_mov_b32 s30, 0x20000
    s_mov_b32 s31, 0x00020000
    s_mov_b64 exec, 1
    s_waitcnt lgkmcnt(0)
    s_add_u32 s28, s86, 0x1400000
    s_addc_u32 s29, s87, 0
    buffer_atomic_add v6, v10, s[28:31], s38 offen sc0
    s_mov_b64 exec, -1
    buffer_load_dword v40, v40, s[28:31], s39 offen sc1
    v_mov_b32 v1, 0x27f00
    s_mov_b64 exec, 1
    s_waitcnt vmcnt(1)
    ds_write_b32 v1, v6
    s_mov_b64 exec, -1
    s_branch L_nt_main_kernel
L_pf_main_kernel:
    s_getpc_b64 s[12:13]
L_pc_main_kernel:
    s_sub_u32 s12, s12, L_pc_main_kernel-main_kernel
    s_subb_u32 s13, s13, 0
    s_mov_b32 s14, L_end_main_kernel-main_kernel
    s_mov_b32 s15, 0x00020000
    s_lshr_b32 s39, s2, 6
    s_lshl_b32 s39, s39, 2
    s_add_u32 s39, s39, s32
    s_lshl_b32 s39, s39, 12
    buffer_load_dword v42, v10, s[12:15], s39 offen
    s_add_u32 s39, s39, 0x10000
    buffer_load_dword v43, v10, s[12:15], s39 offen
    s_lshl_b32 s63, s2, 2
    s_add_u32 s63, s63, s32
    s_waitcnt lgkmcnt(0)
    s_sleep 6
    s_mov_b32 s12, s64
    s_mov_b32 s13, s65
    s_mov_b32 s39, s63
    s_sub_u32 s38, s63, 512
    s_cmp_ge_u32 s63, 512
    s_cselect_b32 s12, s66, s12
    s_cselect_b32 s13, s67, s13
    s_cselect_b32 s39, s38, s39
    s_sub_u32 s38, s63, 896
    s_cmp_ge_u32 s63, 896
    s_cselect_b32 s12, s70, s12
    s_cselect_b32 s13, s71, s13
    s_cselect_b32 s39, s38, s39
    s_min_u32 s39, s39, 511
    s_lshl_b32 s39, s39, 12
    s_mov_b32 s14, 0x200000
    s_mov_b32 s15, 0x00020000
    buffer_load_dword v41, v10, s[12:15], s39 offen
L_nt_main_kernel:
    v_lshrrev_b32 v3, 4, v2
    v_and_b32 v4, 15, v2
    v_lshlrev_b32 v5, 4, v2
    v_lshlrev_b32 v7, 7, v2
    v_and_b32 v1, 1, v3
    v_lshlrev_b32 v8, 9, v1
    v_lshrrev_b32 v1, 1, v3
    v_lshl_add_u32 v8, v1, 8, v8
    v_lshl_add_u32 v8, v4, 4, v8
    v_mov_b32 v1, 0x27f00
    s_waitcnt lgkmcnt(0)
    s_barrier
    ds_read_b32 v1, v1
    s_waitcnt lgkmcnt(0)
    s_barrier
    v_readfirstlane_b32 s38, v1
    v_and_b32 v6, 0xffffffe0, v1
    v_add_u32 v6, 0x5bd1e900, v6
    s_nop 0
    v_readfirstlane_b32 s91, v6
    s_sub_u32 s91, s91, 32
    s_and_b32 s38, s38, 31
    s_lshr_b32 s33, s38, 3
    s_lshl_b32 s39, s37, 2
    s_add_u32 s33, s33, s39
    s_and_b32 s34, s38, 7
    s_lshr_b32 s35, s38, 4
    s_lshl_b32 s39, s37, 1
    s_add_u32 s35, s35, s39
    s_and_b32 s36, s38, 15
    s_lshl_b32 s92, s33, 6
    s_lshl_b32 s37, s32, 4
    s_add_u32 s92, s92, s37
    s_lshl_b32 s93, s35, 7
    s_lshl_b32 s37, s32, 5
    s_add_u32 s93, s93, s37
    s_lshl_b32 s7, s33, 3
    s_add_u32 s7, s7, s34
    s_lshl_b32 s7, s7, 11
    s_mul_i32 s94, s36, 43
    s_lshr_b32 s94, s94, 4
    s_min_u32 s94, s94, 40
    s_mov_b32 s40, 0x3f803f80
    s_mov_b32 s41, 0x3fb8aa3b
    s_mov_b32 s42, 0x358637bd
    s_mov_b32 s98, 0xbdd2d3e8
    s_mov_b32 s99, 0xc0135761
    s_mov_b32 s96, 0x4000
    s_mov_b32 s62, 0
    s_mov_b32 s3, 20000
    s_waitcnt lgkmcnt(0)
    s_mov_b32 s60, s86
    s_mov_b32 s61, s87
    s_cmp_eq_u32 s32, 4
    s_cbranch_scc1 L_loader_main_kernel
L_layer_main_kernel:
    s_nop 4
    s_mov_b32 s46, s93
    s_mul_i32 s45, s46, 1024
    v_and_b32 v14, 3, v2
    v_lshrrev_b32 v13, 2, v2
    v_and_b32 v13, 3, v13
    v_lshlrev_b32 v13, 6, v13
    v_lshl_add_u32 v13, v14, 3, v13
    v_lshl_add_u32 v13, v3, 9, v13
    v_and_b32 v14, 1, v3
    v_lshl_add_u32 v11, v14, 5, v13
    v_xor_b32 v14, 1, v14
    v_lshl_add_u32 v12, v14, 5, v13
    v_add_u32 v14, 0x10000, v11
    v_add_u32 v13, 0x10000, v12
    v_add_u32 v15, 0x1fc00, v5
    v_add_u32 v16, s46, v4
    v_lshlrev_b32 v16, 3, v16
    v_lshl_add_u32 v16, v3, 15, v16
    v_lshlrev_b32 v28, 4, v3
    v_add_u32 v29, 0x1f800, v28
    s_cmp_eq_u32 s62, 0
    s_cselect_b32 s97, 64, 1024
    s_cselect_b64 s[100:101], 0, -1
    s_add_u32 s8, s60, 0x0
    s_addc_u32 s9, s61, 0
    s_cmp_eq_u32 s62, 0
    s_cselect_b32 s8, s64, s8
    s_cselect_b32 s9, s65, s9
    s_mov_b32 s10, 0x200000
    s_mov_b32 s11, 0x00020000
    s_add_u32 s16, s60, 0x400000
    s_addc_u32 s17, s61, 0
    s_mov_b32 s18, 0x200000
    s_mov_b32 s19, 0x00020000
    s_add_u32 s24, s60, 0x600000
    s_addc_u32 s25, s61, 0
    s_mov_b32 s26, 0x200000
    s_mov_b32 s27, 0x00020000
    s_add_u32 s48, s60, 0x1200000
    s_addc_u32 s49, s61, 0
    s_mov_b32 s50, 0x20000
    s_mov_b32 s51, 0x00020000
    s_add_u32 s52, s60, 0x0
    s_addc_u32 s53, s61, 0
    s_mov_b32 s54, 0x4000000
    s_mov_b32 s55, 0x00020000
    s_cmp_lg_u32 s62, 0
    s_cbranch_scc1 L_np_main_kernel
    s_add_u32 s38, s45, 0x0
    buffer_load_dwordx4 v[32:35], v5, s[8:11], s38 offen offset:0 sc1
    buffer_load_dwordx4 v[36:39], v5, s[8:11], s38 offen offset:1024 sc1
    buffer_load_dwordx4 v[40:43], v5, s[8:11], s38 offen offset:2048 sc1
    buffer_load_dwordx4 v[44:47], v5, s[8:11], s38 offen offset:3072 sc1
    s_add_u32 s38, s45, 0x1000
    buffer_load_dwordx4 v[48:51], v5, s[8:11], s38 offen offset:0 sc1
    buffer_load_dwordx4 v[52:55], v5, s[8:11], s38 offen offset:1024 sc1
    buffer_load_dwordx4 v[56:59], v5, s[8:11], s38 offen offset:2048 sc1
    buffer_load_dwordx4 v[60:63], v5, s[8:11], s38 offen offset:3072 sc1
    s_add_u32 s38, s45, 0x2000
    buffer_load_dwordx4 v[64:67], v5, s[8:11], s38 offen offset:0 sc1
    buffer_load_dwordx4 v[68:71], v5, s[8:11], s38 offen offset:1024 sc1
    buffer_load_dwordx4 v[72:75], v5, s[8:11], s38 offen offset:2048 sc1
    buffer_load_dwordx4 v[76:79], v5, s[8:11], s38 offen offset:3072 sc1
    s_add_u32 s38, s45, 0x3000
    buffer_load_dwordx4 v[80:83], v5, s[8:11], s38 offen offset:0 sc1
    buffer_load_dwordx4 v[84:87], v5, s[8:11], s38 offen offset:1024 sc1
    buffer_load_dwordx4 v[88:91], v5, s[8:11], s38 offen offset:2048 sc1
    buffer_load_dwordx4 v[92:95], v5, s[8:11], s38 offen offset:3072 sc1
    s_add_u32 s39, s45, 0x4000
    buffer_load_dwordx4 v[96:99], v5, s[8:11], s39 offen offset:0 sc1
    buffer_load_dwordx4 v[100:103], v5, s[8:11], s39 offen offset:1024 sc1
    buffer_load_dwordx4 v[104:107], v5, s[8:11], s39 offen offset:2048 sc1
    buffer_load_dwordx4 v[108:111], v5, s[8:11], s39 offen offset:3072 sc1
    s_add_u32 s39, s45, 0x5000
    buffer_load_dwordx4 v[112:115], v5, s[8:11], s39 offen offset:0 sc1
    buffer_load_dwordx4 v[116:119], v5, s[8:11], s39 offen offset:1024 sc1
    buffer_load_dwordx4 v[120:123], v5, s[8:11], s39 offen offset:2048 sc1
    buffer_load_dwordx4 v[124:127], v5, s[8:11], s39 offen offset:3072 sc1
    s_add_u32 s39, s45, 0x6000
    buffer_load_dwordx4 v[128:131], v5, s[8:11], s39 offen offset:0 sc1
    buffer_load_dwordx4 v[132:135], v5, s[8:11], s39 offen offset:1024 sc1
    buffer_load_dwordx4 v[136:139], v5, s[8:11], s39 offen offset:2048 sc1
    buffer_load_dwordx4 v[140:143], v5, s[8:11], s39 offen offset:3072 sc1
    s_add_u32 s39, s45, 0x7000
    buffer_load_dwordx4 v[144:147], v5, s[8:11], s39 offen offset:0 sc1
    buffer_load_dwordx4 v[148:151], v5, s[8:11], s39 offen offset:1024 sc1
    buffer_load_dwordx4 v[152:155], v5, s[8:11], s39 offen offset:2048 sc1
    buffer_load_dwordx4 v[156:159], v5, s[8:11], s39 offen offset:3072 sc1
    s_lshl_b32 s37, s32, 14
    s_add_u32 s37, s37, 0x18000
    v_add_u32 v180, s37, v5
    v_add_u32 v181, 0, v3
    v_xor_b32 v181, v181, v4
    v_lshlrev_b32 v181, 4, v181
    v_lshl_add_u32 v181, v4, 10, v181
    v_add_u32 v181, s37, v181
    v_add_u32 v182, 4, v3
    v_xor_b32 v182, v182, v4
    v_lshlrev_b32 v182, 4, v182
    v_lshl_add_u32 v182, v4, 10, v182
    v_add_u32 v182, s37, v182
    v_add_u32 v183, 8, v3
    v_xor_b32 v183, v183, v4
    v_lshlrev_b32 v183, 4, v183
    v_lshl_add_u32 v183, v4, 10, v183
    v_add_u32 v183, s37, v183
    v_add_u32 v184, 12, v3
    v_xor_b32 v184, v184, v4
    v_lshlrev_b32 v184, 4, v184
    v_lshl_add_u32 v184, v4, 10, v184
    v_add_u32 v184, s37, v184
    v_mov_b32 v160, 0x3f803f80
    v_mov_b32 v161, 0x3f803f80
    v_mov_b32 v162, 0x3f803f80
    v_mov_b32 v163, 0x3f803f80
    s_waitcnt vmcnt(28)
    v_xor_b32 v185, 0, v180
    ds_write_b128 v185, v[32:35] offset:0
    v_xor_b32 v186, 16, v180
    ds_write_b128 v186, v[36:39] offset:1024
    v_xor_b32 v187, 32, v180
    ds_write_b128 v187, v[40:43] offset:2048
    v_xor_b32 v188, 48, v180
    ds_write_b128 v188, v[44:47] offset:3072
    s_waitcnt vmcnt(24)
    v_xor_b32 v185, 64, v180
    ds_write_b128 v185, v[48:51] offset:4096
    v_xor_b32 v186, 80, v180
    ds_write_b128 v186, v[52:55] offset:5120
    v_xor_b32 v187, 96, v180
    ds_write_b128 v187, v[56:59] offset:6144
    v_xor_b32 v188, 112, v180
    ds_write_b128 v188, v[60:63] offset:7168
    s_waitcnt vmcnt(20)
    v_xor_b32 v185, 128, v180
    ds_write_b128 v185, v[64:67] offset:8192
    v_xor_b32 v186, 144, v180
    ds_write_b128 v186, v[68:71] offset:9216
    v_xor_b32 v187, 160, v180
    ds_write_b128 v187, v[72:75] offset:10240
    v_xor_b32 v188, 176, v180
    ds_write_b128 v188, v[76:79] offset:11264
    s_waitcnt vmcnt(16)
    v_xor_b32 v185, 192, v180
    ds_write_b128 v185, v[80:83] offset:12288
    v_xor_b32 v186, 208, v180
    ds_write_b128 v186, v[84:87] offset:13312
    v_xor_b32 v187, 224, v180
    ds_write_b128 v187, v[88:91] offset:14336
    v_xor_b32 v188, 240, v180
    ds_write_b128 v188, v[92:95] offset:15360
    s_waitcnt lgkmcnt(0)
    ds_read_b128 v[32:35], v181 offset:0
    ds_read_b128 v[36:39], v182 offset:0
    ds_read_b128 v[40:43], v183 offset:0
    ds_read_b128 v[44:47], v184 offset:0
    ds_read_b128 v[48:51], v181 offset:256
    ds_read_b128 v[52:55], v182 offset:256
    ds_read_b128 v[56:59], v183 offset:256
    ds_read_b128 v[60:63], v184 offset:256
    ds_read_b128 v[64:67], v181 offset:512
    ds_read_b128 v[68:71], v182 offset:512
    ds_read_b128 v[72:75], v183 offset:512
    ds_read_b128 v[76:79], v184 offset:512
    ds_read_b128 v[80:83], v181 offset:768
    ds_read_b128 v[84:87], v182 offset:768
    ds_read_b128 v[88:91], v183 offset:768
    ds_read_b128 v[92:95], v184 offset:768
    v_mov_b32 v192, -1
    v_mov_b32 v193, -1
    v_mov_b32 v194, -1
    v_mov_b32 v195, -1
    v_lshlrev_b32 v196, 3, v2
    s_lshl_b32 s39, s36, 2
    s_add_u32 s39, s39, s32
    s_lshl_b32 s39, s39, 4
    s_add_u32 s39, s39, s35
    s_lshl_b32 s38, s39, 6
    s_lshl_b32 s37, s39, 9
    s_add_u32 s39, s46, s36
    s_lshl_b32 s39, s39, 10
    s_add_u32 s4, s37, 0x600000
    buffer_store_dwordx2 v[192:193], v196, s[52:55], s4 offen sc1
    s_add_u32 s4, s38, 0x700000
    s_mov_b32 exec_lo, 0x00010001
    s_mov_b32 exec_hi, 0x00010001
    buffer_store_dwordx4 v[192:195], v28, s[52:55], s4 offen sc1
    s_mov_b64 exec, -1
    s_add_u32 s4, s39, 0x400000
    buffer_store_dwordx4 v[192:195], v5, s[52:55], s4 offen
    s_add_u32 s4, s39, 0x404000
    buffer_store_dwordx4 v[192:195], v5, s[52:55], s4 offen
    s_add_u32 s4, s37, 0x2600000
    buffer_store_dwordx2 v[192:193], v196, s[52:55], s4 offen sc1
    s_add_u32 s4, s38, 0x2700000
    s_mov_b32 exec_lo, 0x00010001
    s_mov_b32 exec_hi, 0x00010001
    buffer_store_dwordx4 v[192:195], v28, s[52:55], s4 offen sc1
    s_mov_b64 exec, -1
    s_add_u32 s4, s39, 0x2400000
    buffer_store_dwordx4 v[192:195], v5, s[52:55], s4 offen
    s_add_u32 s4, s39, 0x2404000
    buffer_store_dwordx4 v[192:195], v5, s[52:55], s4 offen
    s_waitcnt lgkmcnt(0)
    s_waitcnt vmcnt(20)
    v_xor_b32 v185, 0, v180
    ds_write_b128 v185, v[96:99] offset:0
    v_mfma_f32_16x16x32_bf16 v[164:167], v[160:163], v[32:35], 0
    v_mfma_f32_16x16x32_bf16 v[172:175], v[32:35], v[32:35], 0
    v_xor_b32 v186, 16, v180
    ds_write_b128 v186, v[100:103] offset:1024
    v_mfma_f32_16x16x32_bf16 v[164:167], v[160:163], v[36:39], v[164:167]
    v_mfma_f32_16x16x32_bf16 v[172:175], v[36:39], v[36:39], v[172:175]
    v_xor_b32 v187, 32, v180
    ds_write_b128 v187, v[104:107] offset:2048
    v_mfma_f32_16x16x32_bf16 v[164:167], v[160:163], v[40:43], v[164:167]
    v_mfma_f32_16x16x32_bf16 v[172:175], v[40:43], v[40:43], v[172:175]
    v_xor_b32 v188, 48, v180
    ds_write_b128 v188, v[108:111] offset:3072
    v_mfma_f32_16x16x32_bf16 v[164:167], v[160:163], v[44:47], v[164:167]
    v_mfma_f32_16x16x32_bf16 v[172:175], v[44:47], v[44:47], v[172:175]
    s_waitcnt vmcnt(16)
    v_xor_b32 v185, 64, v180
    ds_write_b128 v185, v[112:115] offset:4096
    v_mfma_f32_16x16x32_bf16 v[164:167], v[160:163], v[48:51], v[164:167]
    v_mfma_f32_16x16x32_bf16 v[172:175], v[48:51], v[48:51], v[172:175]
    v_xor_b32 v186, 80, v180
    ds_write_b128 v186, v[116:119] offset:5120
    v_mfma_f32_16x16x32_bf16 v[164:167], v[160:163], v[52:55], v[164:167]
    v_mfma_f32_16x16x32_bf16 v[172:175], v[52:55], v[52:55], v[172:175]
    v_xor_b32 v187, 96, v180
    ds_write_b128 v187, v[120:123] offset:6144
    v_mfma_f32_16x16x32_bf16 v[164:167], v[160:163], v[56:59], v[164:167]
    v_mfma_f32_16x16x32_bf16 v[172:175], v[56:59], v[56:59], v[172:175]
    v_xor_b32 v188, 112, v180
    ds_write_b128 v188, v[124:127] offset:7168
    v_mfma_f32_16x16x32_bf16 v[164:167], v[160:163], v[60:63], v[164:167]
    v_mfma_f32_16x16x32_bf16 v[172:175], v[60:63], v[60:63], v[172:175]
    s_waitcnt vmcnt(12)
    v_xor_b32 v185, 128, v180
    ds_write_b128 v185, v[128:131] offset:8192
    v_mfma_f32_16x16x32_bf16 v[164:167], v[160:163], v[64:67], v[164:167]
    v_mfma_f32_16x16x32_bf16 v[172:175], v[64:67], v[64:67], v[172:175]
    v_xor_b32 v186, 144, v180
    ds_write_b128 v186, v[132:135] offset:9216
    v_mfma_f32_16x16x32_bf16 v[164:167], v[160:163], v[68:71], v[164:167]
    v_mfma_f32_16x16x32_bf16 v[172:175], v[68:71], v[68:71], v[172:175]
    v_xor_b32 v187, 160, v180
    ds_write_b128 v187, v[136:139] offset:10240
    v_mfma_f32_16x16x32_bf16 v[164:167], v[160:163], v[72:75], v[164:167]
    v_mfma_f32_16x16x32_bf16 v[172:175], v[72:75], v[72:75], v[172:175]
    v_xor_b32 v188, 176, v180
    ds_write_b128 v188, v[140:143] offset:11264
    v_mfma_f32_16x16x32_bf16 v[164:167], v[160:163], v[76:79], v[164:167]
    v_mfma_f32_16x16x32_bf16 v[172:175], v[76:79], v[76:79], v[172:175]
    s_waitcnt vmcnt(8)
    v_xor_b32 v185, 192, v180
    ds_write_b128 v185, v[144:147] offset:12288
    v_xor_b32 v186, 208, v180
    ds_write_b128 v186, v[148:151] offset:13312
    v_xor_b32 v187, 224, v180
    ds_write_b128 v187, v[152:155] offset:14336
    v_xor_b32 v188, 240, v180
    ds_write_b128 v188, v[156:159] offset:15360
    s_waitcnt lgkmcnt(0)
    ds_read_b128 v[96:99], v181 offset:0
    ds_read_b128 v[100:103], v182 offset:0
    ds_read_b128 v[104:107], v183 offset:0
    ds_read_b128 v[108:111], v184 offset:0
    ds_read_b128 v[112:115], v181 offset:256
    ds_read_b128 v[116:119], v182 offset:256
    ds_read_b128 v[120:123], v183 offset:256
    ds_read_b128 v[124:127], v184 offset:256
    ds_read_b128 v[128:131], v181 offset:512
    ds_read_b128 v[132:135], v182 offset:512
    ds_read_b128 v[136:139], v183 offset:512
    ds_read_b128 v[140:143], v184 offset:512
    ds_read_b128 v[144:147], v181 offset:768
    ds_read_b128 v[148:151], v182 offset:768
    ds_read_b128 v[152:155], v183 offset:768
    ds_read_b128 v[156:159], v184 offset:768
    v_mfma_f32_16x16x32_bf16 v[164:167], v[160:163], v[80:83], v[164:167]
    v_mfma_f32_16x16x32_bf16 v[172:175], v[80:83], v[80:83], v[172:175]
    v_mfma_f32_16x16x32_bf16 v[164:167], v[160:163], v[84:87], v[164:167]
    v_mfma_f32_16x16x32_bf16 v[172:175], v[84:87], v[84:87], v[172:175]
    v_mfma_f32_16x16x32_bf16 v[164:167], v[160:163], v[88:91], v[164:167]
    v_mfma_f32_16x16x32_bf16 v[172:175], v[88:91], v[88:91], v[172:175]
    v_mfma_f32_16x16x32_bf16 v[164:167], v[160:163], v[92:95], v[164:167]
    v_mfma_f32_16x16x32_bf16 v[172:175], v[92:95], v[92:95], v[172:175]
    s_waitcnt lgkmcnt(15)
    v_mfma_f32_16x16x32_bf16 v[168:171], v[160:163], v[96:99], 0
    v_mfma_f32_16x16x32_bf16 v[176:179], v[96:99], v[96:99], 0
    s_waitcnt lgkmcnt(14)
    v_mfma_f32_16x16x32_bf16 v[168:171], v[160:163], v[100:103], v[168:171]
    v_mfma_f32_16x16x32_bf16 v[176:179], v[100:103], v[100:103], v[176:179]
    s_waitcnt lgkmcnt(13)
    v_mfma_f32_16x16x32_bf16 v[168:171], v[160:163], v[104:107], v[168:171]
    v_mfma_f32_16x16x32_bf16 v[176:179], v[104:107], v[104:107], v[176:179]
    s_waitcnt lgkmcnt(12)
    v_mfma_f32_16x16x32_bf16 v[168:171], v[160:163], v[108:111], v[168:171]
    v_mfma_f32_16x16x32_bf16 v[176:179], v[108:111], v[108:111], v[176:179]
    s_waitcnt lgkmcnt(11)
    v_mfma_f32_16x16x32_bf16 v[168:171], v[160:163], v[112:115], v[168:171]
    v_mfma_f32_16x16x32_bf16 v[176:179], v[112:115], v[112:115], v[176:179]
    s_waitcnt lgkmcnt(10)
    v_mfma_f32_16x16x32_bf16 v[168:171], v[160:163], v[116:119], v[168:171]
    v_mfma_f32_16x16x32_bf16 v[176:179], v[116:119], v[116:119], v[176:179]
    s_waitcnt lgkmcnt(9)
    v_mfma_f32_16x16x32_bf16 v[168:171], v[160:163], v[120:123], v[168:171]
    v_mfma_f32_16x16x32_bf16 v[176:179], v[120:123], v[120:123], v[176:179]
    s_waitcnt lgkmcnt(8)
    v_mfma_f32_16x16x32_bf16 v[168:171], v[160:163], v[124:127], v[168:171]
    v_mfma_f32_16x16x32_bf16 v[176:179], v[124:127], v[124:127], v[176:179]
    s_waitcnt lgkmcnt(7)
    v_mfma_f32_16x16x32_bf16 v[168:171], v[160:163], v[128:131], v[168:171]
    v_mfma_f32_16x16x32_bf16 v[176:179], v[128:131], v[128:131], v[176:179]
    s_waitcnt lgkmcnt(6)
    v_mfma_f32_16x16x32_bf16 v[168:171], v[160:163], v[132:135], v[168:171]
    v_mfma_f32_16x16x32_bf16 v[176:179], v[132:135], v[132:135], v[176:179]
    s_waitcnt lgkmcnt(5)
    v_mfma_f32_16x16x32_bf16 v[168:171], v[160:163], v[136:139], v[168:171]
    v_mfma_f32_16x16x32_bf16 v[176:179], v[136:139], v[136:139], v[176:179]
    s_waitcnt lgkmcnt(4)
    v_mfma_f32_16x16x32_bf16 v[168:171], v[160:163], v[140:143], v[168:171]
    v_mfma_f32_16x16x32_bf16 v[176:179], v[140:143], v[140:143], v[176:179]
    s_waitcnt lgkmcnt(3)
    v_mfma_f32_16x16x32_bf16 v[168:171], v[160:163], v[144:147], v[168:171]
    v_mfma_f32_16x16x32_bf16 v[176:179], v[144:147], v[144:147], v[176:179]
    s_waitcnt lgkmcnt(2)
    v_mfma_f32_16x16x32_bf16 v[168:171], v[160:163], v[148:151], v[168:171]
    v_mfma_f32_16x16x32_bf16 v[176:179], v[148:151], v[148:151], v[176:179]
    s_waitcnt lgkmcnt(1)
    v_mfma_f32_16x16x32_bf16 v[168:171], v[160:163], v[152:155], v[168:171]
    v_mfma_f32_16x16x32_bf16 v[176:179], v[152:155], v[152:155], v[176:179]
    s_waitcnt lgkmcnt(0)
    v_mfma_f32_16x16x32_bf16 v[168:171], v[160:163], v[156:159], v[168:171]
    v_mfma_f32_16x16x32_bf16 v[176:179], v[156:159], v[156:159], v[176:179]
    v_and_b32 v185, 3, v4
    v_lshrrev_b32 v186, 2, v4
    v_mul_f32 v20, 0.25, v164
    v_mov_b32 v22, 0
    v_mov_b32 v23, 0
    s_nop 1
    v_mul_f32 v24, 0.25, v168
    v_mov_b32 v26, 0
    v_mov_b32 v27, 0
    v_cmp_eq_u32 vcc, 1, v185
    s_nop 1
    v_cndmask_b32 v172, v172, v173, vcc
    v_cndmask_b32 v176, v176, v177, vcc
    v_cmp_eq_u32 vcc, 2, v185
    s_nop 1
    v_cndmask_b32 v172, v172, v174, vcc
    v_cndmask_b32 v176, v176, v178, vcc
    v_cmp_eq_u32 vcc, 3, v185
    s_nop 1
    v_cndmask_b32 v172, v172, v175, vcc
    v_cndmask_b32 v176, v176, v179, vcc
    v_cmp_eq_u32 vcc, v186, v3
    s_nop 1
    v_cndmask_b32 v21, 0, v172, vcc
    v_cndmask_b32 v25, 0, v176, vcc
    s_waitcnt vmcnt(0)
    s_barrier
L_np_main_kernel:
    s_nop 4
    ds_read_b64_tr_b16 v[208:209], v11 offset:0
    ds_read_b64_tr_b16 v[210:211], v11 offset:256
    ds_read_b64_tr_b16 v[212:213], v12 offset:0
    ds_read_b64_tr_b16 v[214:215], v12 offset:256
    ds_read_b64_tr_b16 v[216:217], v14 offset:0
    ds_read_b64_tr_b16 v[218:219], v14 offset:256
    ds_read_b64_tr_b16 v[220:221], v13 offset:0
    ds_read_b64_tr_b16 v[222:223], v13 offset:256
    ds_read_b64_tr_b16 v[224:225], v11 offset:2048
    ds_read_b64_tr_b16 v[226:227], v11 offset:2304
    ds_read_b64_tr_b16 v[228:229], v12 offset:2048
    ds_read_b64_tr_b16 v[230:231], v12 offset:2304
    ds_read_b64_tr_b16 v[232:233], v14 offset:2048
    ds_read_b64_tr_b16 v[234:235], v14 offset:2304
    ds_read_b64_tr_b16 v[236:237], v13 offset:2048
    ds_read_b64_tr_b16 v[238:239], v13 offset:2304
    ds_read_b64_tr_b16 v[240:241], v11 offset:4096
    ds_read_b64_tr_b16 v[242:243], v11 offset:4352
    ds_read_b64_tr_b16 v[244:245], v12 offset:4096
    ds_read_b64_tr_b16 v[246:247], v12 offset:4352
    ds_read_b64_tr_b16 v[248:249], v14 offset:4096
    ds_read_b64_tr_b16 v[250:251], v14 offset:4352
    ds_read_b64_tr_b16 v[252:253], v13 offset:4096
    ds_read_b64_tr_b16 v[254:255], v13 offset:4352
    s_cmp_eq_u32 s62, 0
    s_cbranch_scc1 L_go0_main_kernel
    buffer_load_dwordx2 v[20:21], v16, s[48:51], 0 offen offset:0 sc1
    buffer_load_dwordx2 v[22:23], v16, s[48:51], s96 offen offset:0 sc1
    buffer_load_dwordx2 v[24:25], v16, s[48:51], 0 offen offset:128 sc1
    buffer_load_dwordx2 v[26:27], v16, s[48:51], s96 offen offset:128 sc1
    s_add_u32 s38, s45, 0x0
    buffer_load_dwordx4 v[32:35], v5, s[8:11], s38 offen offset:0 sc1
    s_add_u32 s39, s45, 0x4000
    buffer_load_dwordx4 v[96:99], v5, s[8:11], s39 offen offset:0 sc1
    buffer_load_dwordx4 v[36:39], v5, s[8:11], s38 offen offset:1024 sc1
    buffer_load_dwordx4 v[100:103], v5, s[8:11], s39 offen offset:1024 sc1
    buffer_load_dwordx4 v[40:43], v5, s[8:11], s38 offen offset:2048 sc1
    buffer_load_dwordx4 v[104:107], v5, s[8:11], s39 offen offset:2048 sc1
    buffer_load_dwordx4 v[44:47], v5, s[8:11], s38 offen offset:3072 sc1
    buffer_load_dwordx4 v[108:111], v5, s[8:11], s39 offen offset:3072 sc1
    s_add_u32 s38, s45, 0x1000
    buffer_load_dwordx4 v[48:51], v5, s[8:11], s38 offen offset:0 sc1
    s_add_u32 s39, s45, 0x5000
    buffer_load_dwordx4 v[112:115], v5, s[8:11], s39 offen offset:0 sc1
    buffer_load_dwordx4 v[52:55], v5, s[8:11], s38 offen offset:1024 sc1
    buffer_load_dwordx4 v[116:119], v5, s[8:11], s39 offen offset:1024 sc1
    s_waitcnt vmcnt(12)
    v_max_u32 v7, v21, v23
    v_max3_u32 v7, v7, v25, v27
    v_cmp_eq_u32 vcc, -1, v7
    s_cbranch_vccnz L_pl0_main_kernel
L_go0_main_kernel:
    s_waitcnt vmcnt(10)
    v_max_u32 v7, v35, v99
    v_cmp_eq_u32 vcc, -1, v7
    s_and_b64 vcc, vcc, s[100:101]
    s_cbranch_vccnz L_rt1_main_kernel
L_ok1_main_kernel:
    s_waitcnt lgkmcnt(15)
    v_mfma_f32_16x16x32_bf16 v[176:179], v[208:211], v[32:35], 0
    v_mfma_f32_16x16x32_bf16 v[180:183], v[208:211], v[96:99], 0
    s_mov_b64 exec, s[100:101]
    s_cbranch_execz L_sx6_main_kernel
    buffer_load_dwordx4 v[56:59], v5, s[8:11], s38 offen offset:2048 sc1
    buffer_load_dwordx4 v[120:123], v5, s[8:11], s39 offen offset:2048 sc1
L_sx6_main_kernel:
    s_mov_b64 exec, -1
    ds_read_b64_tr_b16 v[208:209], v11 offset:6144
    ds_read_b64_tr_b16 v[210:211], v11 offset:6400
    v_mfma_f32_16x16x32_bf16 v[184:187], v[212:215], v[32:35], 0
    v_mfma_f32_16x16x32_bf16 v[188:191], v[212:215], v[96:99], 0
    s_waitcnt vmcnt(8)
    v_max3_u32 v7, v39, v103, v43
    v_max_u32 v7, v7, v107
    v_cmp_eq_u32 vcc, -1, v7
    ds_read_b64_tr_b16 v[212:213], v12 offset:6144
    ds_read_b64_tr_b16 v[214:215], v12 offset:6400
    v_mfma_f32_16x16x32_bf16 v[192:195], v[216:219], v[32:35], 0
    v_mfma_f32_16x16x32_bf16 v[196:199], v[216:219], v[96:99], 0
    s_and_b64 vcc, vcc, s[100:101]
    s_cbranch_vccnz L_rt2_main_kernel
L_ok2_main_kernel:
    ds_read_b64_tr_b16 v[216:217], v14 offset:6144
    ds_read_b64_tr_b16 v[218:219], v14 offset:6400
    v_mfma_f32_16x16x32_bf16 v[200:203], v[220:223], v[32:35], 0
    v_mfma_f32_16x16x32_bf16 v[204:207], v[220:223], v[96:99], 0
    ds_read_b64_tr_b16 v[220:221], v13 offset:6144
    ds_read_b64_tr_b16 v[222:223], v13 offset:6400
    s_waitcnt lgkmcnt(15)
    v_mfma_f32_16x16x32_bf16 v[176:179], v[224:227], v[36:39], v[176:179]
    v_mfma_f32_16x16x32_bf16 v[180:183], v[224:227], v[100:103], v[180:183]
    s_mov_b64 exec, s[100:101]
    s_cbranch_execz L_sx7_main_kernel
    buffer_load_dwordx4 v[60:63], v5, s[8:11], s38 offen offset:3072 sc1
    buffer_load_dwordx4 v[124:127], v5, s[8:11], s39 offen offset:3072 sc1
L_sx7_main_kernel:
    s_mov_b64 exec, -1
    ds_read_b64_tr_b16 v[224:225], v11 offset:8192
    ds_read_b64_tr_b16 v[226:227], v11 offset:8448
    v_mfma_f32_16x16x32_bf16 v[184:187], v[228:231], v[36:39], v[184:187]
    v_mfma_f32_16x16x32_bf16 v[188:191], v[228:231], v[100:103], v[188:191]
    ds_read_b64_tr_b16 v[228:229], v12 offset:8192
    ds_read_b64_tr_b16 v[230:231], v12 offset:8448
    v_mfma_f32_16x16x32_bf16 v[192:195], v[232:235], v[36:39], v[192:195]
    v_mfma_f32_16x16x32_bf16 v[196:199], v[232:235], v[100:103], v[196:199]
    ds_read_b64_tr_b16 v[232:233], v14 offset:8192
    ds_read_b64_tr_b16 v[234:235], v14 offset:8448
    v_mfma_f32_16x16x32_bf16 v[200:203], v[236:239], v[36:39], v[200:203]
    v_mfma_f32_16x16x32_bf16 v[204:207], v[236:239], v[100:103], v[204:207]
    ds_read_b64_tr_b16 v[236:237], v13 offset:8192
    ds_read_b64_tr_b16 v[238:239], v13 offset:8448
    s_waitcnt lgkmcnt(15)
    v_mfma_f32_16x16x32_bf16 v[176:179], v[240:243], v[40:43], v[176:179]
    v_mfma_f32_16x16x32_bf16 v[180:183], v[240:243], v[104:107], v[180:183]
    s_mov_b64 exec, s[100:101]
    s_cbranch_execz L_sx8_main_kernel
    s_add_u32 s38, s45, 0x2000
    buffer_load_dwordx4 v[64:67], v5, s[8:11], s38 offen offset:0 sc1
    s_add_u32 s39, s45, 0x6000
    buffer_load_dwordx4 v[128:131], v5, s[8:11], s39 offen offset:0 sc1
L_sx8_main_kernel:
    s_mov_b64 exec, -1
    ds_read_b64_tr_b16 v[240:241], v11 offset:10240
    ds_read_b64_tr_b16 v[242:243], v11 offset:10496
    v_mfma_f32_16x16x32_bf16 v[184:187], v[244:247], v[40:43], v[184:187]
    v_mfma_f32_16x16x32_bf16 v[188:191], v[244:247], v[104:107], v[188:191]
    s_waitcnt vmcnt(8)
    v_max3_u32 v7, v47, v111, v51
    v_max_u32 v7, v7, v115
    v_cmp_eq_u32 vcc, -1, v7
    ds_read_b64_tr_b16 v[244:245], v12 offset:10240
    ds_read_b64_tr_b16 v[246:247], v12 offset:10496
    v_mfma_f32_16x16x32_bf16 v[192:195], v[248:251], v[40:43], v[192:195]
    v_mfma_f32_16x16x32_bf16 v[196:199], v[248:251], v[104:107], v[196:199]
    s_and_b64 vcc, vcc, s[100:101]
    s_cbranch_vccnz L_rt3_main_kernel
L_ok3_main_kernel:
    ds_read_b64_tr_b16 v[248:249], v14 offset:10240
    ds_read_b64_tr_b16 v[250:251], v14 offset:10496
    v_mfma_f32_16x16x32_bf16 v[200:203], v[252:255], v[40:43], v[200:203]
    v_mfma_f32_16x16x32_bf16 v[204:207], v[252:255], v[104:107], v[204:207]
    ds_read_b64_tr_b16 v[252:253], v13 offset:10240
    ds_read_b64_tr_b16 v[254:255], v13 offset:10496
    s_waitcnt lgkmcnt(15)
    v_mfma_f32_16x16x32_bf16 v[176:179], v[208:211], v[44:47], v[176:179]
    v_add_f32 v20, v20, v22
    v_mfma_f32_16x16x32_bf16 v[180:183], v[208:211], v[108:111], v[180:183]
    v_add_f32 v24, v24, v26
    s_mov_b64 exec, s[100:101]
    s_cbranch_execz L_sx9_main_kernel
    buffer_load_dwordx4 v[68:71], v5, s[8:11], s38 offen offset:1024 sc1
    buffer_load_dwordx4 v[132:135], v5, s[8:11], s39 offen offset:1024 sc1
L_sx9_main_kernel:
    s_mov_b64 exec, -1
    ds_read_b64_tr_b16 v[208:209], v11 offset:12288
    ds_read_b64_tr_b16 v[210:211], v11 offset:12544
    v_mfma_f32_16x16x32_bf16 v[184:187], v[212:215], v[44:47], v[184:187]
    v_add_f32 v21, v21, v23
    v_mfma_f32_16x16x32_bf16 v[188:191], v[212:215], v[108:111], v[188:191]
    v_add_f32 v25, v25, v27
    ds_read_b64_tr_b16 v[212:213], v12 offset:12288
    ds_read_b64_tr_b16 v[214:215], v12 offset:12544
    v_mfma_f32_16x16x32_bf16 v[192:195], v[216:219], v[44:47], v[192:195]
    v_mov_b32 v22, v20
    v_mfma_f32_16x16x32_bf16 v[196:199], v[216:219], v[108:111], v[196:199]
    v_mov_b32 v26, v24
    ds_read_b64_tr_b16 v[216:217], v14 offset:12288
    ds_read_b64_tr_b16 v[218:219], v14 offset:12544
    v_mfma_f32_16x16x32_bf16 v[200:203], v[220:223], v[44:47], v[200:203]
    v_mov_b32 v23, v21
    v_mfma_f32_16x16x32_bf16 v[204:207], v[220:223], v[108:111], v[204:207]
    v_mov_b32 v27, v25
    ds_read_b64_tr_b16 v[220:221], v13 offset:12288
    ds_read_b64_tr_b16 v[222:223], v13 offset:12544
    s_waitcnt lgkmcnt(15)
    v_mfma_f32_16x16x32_bf16 v[176:179], v[224:227], v[48:51], v[176:179]
    v_permlane32_swap_b32 v20, v22
    v_mfma_f32_16x16x32_bf16 v[180:183], v[224:227], v[112:115], v[180:183]
    v_permlane32_swap_b32 v24, v26
    s_mov_b64 exec, s[100:101]
    s_cbranch_execz L_sx10_main_kernel
    buffer_load_dwordx4 v[72:75], v5, s[8:11], s38 offen offset:2048 sc1
    buffer_load_dwordx4 v[136:139], v5, s[8:11], s39 offen offset:2048 sc1
L_sx10_main_kernel:
    s_mov_b64 exec, -1
    ds_read_b64_tr_b16 v[224:225], v11 offset:14336
    ds_read_b64_tr_b16 v[226:227], v11 offset:14592
    v_mfma_f32_16x16x32_bf16 v[184:187], v[228:231], v[48:51], v[184:187]
    v_permlane32_swap_b32 v21, v23
    v_mfma_f32_16x16x32_bf16 v[188:191], v[228:231], v[112:115], v[188:191]
    v_permlane32_swap_b32 v25, v27
    s_waitcnt vmcnt(8)
    v_max3_u32 v7, v55, v119, v59
    v_max_u32 v7, v7, v123
    v_cmp_eq_u32 vcc, -1, v7
    ds_read_b64_tr_b16 v[228:229], v12 offset:14336
    ds_read_b64_tr_b16 v[230:231], v12 offset:14592
    v_mfma_f32_16x16x32_bf16 v[192:195], v[232:235], v[48:51], v[192:195]
    v_add_f32 v20, v20, v22
    v_mfma_f32_16x16x32_bf16 v[196:199], v[232:235], v[112:115], v[196:199]
    v_add_f32 v24, v24, v26
    s_and_b64 vcc, vcc, s[100:101]
    s_cbranch_vccnz L_rt4_main_kernel
L_ok4_main_kernel:
    ds_read_b64_tr_b16 v[232:233], v14 offset:14336
    ds_read_b64_tr_b16 v[234:235], v14 offset:14592
    v_mfma_f32_16x16x32_bf16 v[200:203], v[236:239], v[48:51], v[200:203]
    v_add_f32 v21, v21, v23
    v_mfma_f32_16x16x32_bf16 v[204:207], v[236:239], v[112:115], v[204:207]
    v_add_f32 v25, v25, v27
    ds_read_b64_tr_b16 v[236:237], v13 offset:14336
    ds_read_b64_tr_b16 v[238:239], v13 offset:14592
    s_waitcnt lgkmcnt(15)
    s_barrier
    v_mfma_f32_16x16x32_bf16 v[176:179], v[240:243], v[52:55], v[176:179]
    v_mov_b32 v22, v20
    v_mfma_f32_16x16x32_bf16 v[180:183], v[240:243], v[116:119], v[180:183]
    v_mov_b32 v26, v24
    s_mov_b64 exec, s[100:101]
    s_cbranch_execz L_sx11_main_kernel
    buffer_load_dwordx4 v[76:79], v5, s[8:11], s38 offen offset:3072 sc1
    buffer_load_dwordx4 v[140:143], v5, s[8:11], s39 offen offset:3072 sc1
L_sx11_main_kernel:
    s_mov_b64 exec, -1
    ds_read_b64_tr_b16 v[240:241], v11 offset:16384
    ds_read_b64_tr_b16 v[242:243], v11 offset:16640
    v_mfma_f32_16x16x32_bf16 v[184:187], v[244:247], v[52:55], v[184:187]
    v_mov_b32 v23, v21
    v_mfma_f32_16x16x32_bf16 v[188:191], v[244:247], v[116:119], v[188:191]
    v_mov_b32 v27, v25
    ds_read_b64_tr_b16 v[244:245], v12 offset:16384
    ds_read_b64_tr_b16 v[246:247], v12 offset:16640
    v_mfma_f32_16x16x32_bf16 v[192:195], v[248:251], v[52:55], v[192:195]
    v_permlane16_swap_b32 v20, v22
    v_mfma_f32_16x16x32_bf16 v[196:199], v[248:251], v[116:119], v[196:199]
    v_permlane16_swap_b32 v24, v26
    ds_read_b64_tr_b16 v[248:249], v14 offset:16384
    ds_read_b64_tr_b16 v[250:251], v14 offset:16640
    v_mfma_f32_16x16x32_bf16 v[200:203], v[252:255], v[52:55], v[200:203]
    v_permlane16_swap_b32 v21, v23
    v_mfma_f32_16x16x32_bf16 v[204:207], v[252:255], v[116:119], v[204:207]
    v_permlane16_swap_b32 v25, v27
    ds_read_b64_tr_b16 v[252:253], v13 offset:16384
    ds_read_b64_tr_b16 v[254:255], v13 offset:16640
    s_waitcnt lgkmcnt(15)
    v_mfma_f32_16x16x32_bf16 v[176:179], v[208:211], v[56:59], v[176:179]
    v_add_f32 v20, v20, v22
    v_mfma_f32_16x16x32_bf16 v[180:183], v[208:211], v[120:123], v[180:183]
    v_add_f32 v24, v24, v26
    s_mov_b64 exec, s[100:101]
    s_cbranch_execz L_sx12_main_kernel
    s_add_u32 s38, s45, 0x3000
    buffer_load_dwordx4 v[80:83], v5, s[8:11], s38 offen offset:0 sc1
    s_add_u32 s39, s45, 0x7000
    buffer_load_dwordx4 v[144:147], v5, s[8:11], s39 offen offset:0 sc1
L_sx12_main_kernel:
    s_mov_b64 exec, -1
    ds_read_b64_tr_b16 v[208:209], v11 offset:18432
    ds_read_b64_tr_b16 v[210:211], v11 offset:18688
    v_mfma_f32_16x16x32_bf16 v[184:187], v[212:215], v[56:59], v[184:187]
    v_add_f32 v21, v21, v23
    v_mfma_f32_16x16x32_bf16 v[188:191], v[212:215], v[120:123], v[188:191]
    v_add_f32 v25, v25, v27
    s_waitcnt vmcnt(8)
    v_max3_u32 v7, v63, v127, v67
    v_max_u32 v7, v7, v131
    v_cmp_eq_u32 vcc, -1, v7
    ds_read_b64_tr_b16 v[212:213], v12 offset:18432
    ds_read_b64_tr_b16 v[214:215], v12 offset:18688
    v_mfma_f32_16x16x32_bf16 v[192:195], v[216:219], v[56:59], v[192:195]
    v_mul_f32 v23, 0xbb000000, v20
    v_mfma_f32_16x16x32_bf16 v[196:199], v[216:219], v[120:123], v[196:199]
    v_mul_f32 v27, 0xbb000000, v24
    s_and_b64 vcc, vcc, s[100:101]
    s_cbranch_vccnz L_rt5_main_kernel
L_ok5_main_kernel:
    ds_read_b64_tr_b16 v[216:217], v14 offset:18432
    ds_read_b64_tr_b16 v[218:219], v14 offset:18688
    v_mfma_f32_16x16x32_bf16 v[200:203], v[220:223], v[56:59], v[200:203]
    v_mul_f32 v21, 0x3b000000, v21
    v_mfma_f32_16x16x32_bf16 v[204:207], v[220:223], v[120:123], v[204:207]
    v_mul_f32 v25, 0x3b000000, v25
    ds_read_b64_tr_b16 v[220:221], v13 offset:18432
    ds_read_b64_tr_b16 v[222:223], v13 offset:18688
    s_waitcnt lgkmcnt(15)
    v_mfma_f32_16x16x32_bf16 v[176:179], v[224:227], v[60:63], v[176:179]
    v_fma_f32 v21, -v23, v23, v21
    v_mfma_f32_16x16x32_bf16 v[180:183], v[224:227], v[124:127], v[180:183]
    v_fma_f32 v25, -v27, v27, v25
    s_mov_b64 exec, s[100:101]
    s_cbranch_execz L_sx13_main_kernel
    buffer_load_dwordx4 v[84:87], v5, s[8:11], s38 offen offset:1024 sc1
    buffer_load_dwordx4 v[148:151], v5, s[8:11], s39 offen offset:1024 sc1
L_sx13_main_kernel:
    s_mov_b64 exec, -1
    ds_read_b64_tr_b16 v[224:225], v11 offset:20480
    ds_read_b64_tr_b16 v[226:227], v11 offset:20736
    v_mfma_f32_16x16x32_bf16 v[184:187], v[228:231], v[60:63], v[184:187]
    v_max_f32 v21, 0, v21
    v_mfma_f32_16x16x32_bf16 v[188:191], v[228:231], v[124:127], v[188:191]
    v_max_f32 v25, 0, v25
    ds_read_b64_tr_b16 v[228:229], v12 offset:20480
    ds_read_b64_tr_b16 v[230:231], v12 offset:20736
    v_mfma_f32_16x16x32_bf16 v[192:195], v[232:235], v[60:63], v[192:195]
    v_add_f32 v22, 0x3727c5ac, v21
    v_mfma_f32_16x16x32_bf16 v[196:199], v[232:235], v[124:127], v[196:199]
    v_add_f32 v26, 0x3727c5ac, v25
    ds_read_b64_tr_b16 v[232:233], v14 offset:20480
    ds_read_b64_tr_b16 v[234:235], v14 offset:20736
    v_mfma_f32_16x16x32_bf16 v[200:203], v[236:239], v[60:63], v[200:203]
    v_rsq_f32 v20, v22
    v_mfma_f32_16x16x32_bf16 v[204:207], v[236:239], v[124:127], v[204:207]
    v_rsq_f32 v24, v26
    ds_read_b64_tr_b16 v[236:237], v13 offset:20480
    ds_read_b64_tr_b16 v[238:239], v13 offset:20736
    s_waitcnt lgkmcnt(15)
    v_mfma_f32_16x16x32_bf16 v[176:179], v[240:243], v[64:67], v[176:179]
    v_mfma_f32_16x16x32_bf16 v[180:183], v[240:243], v[128:131], v[180:183]
    s_mov_b64 exec, s[100:101]
    s_cbranch_execz L_sx14_main_kernel
    buffer_load_dwordx4 v[88:91], v5, s[8:11], s38 offen offset:2048 sc1
    buffer_load_dwordx4 v[152:155], v5, s[8:11], s39 offen offset:2048 sc1
L_sx14_main_kernel:
    s_mov_b64 exec, -1
    ds_read_b64_tr_b16 v[240:241], v11 offset:22528
    ds_read_b64_tr_b16 v[242:243], v11 offset:22784
    v_mfma_f32_16x16x32_bf16 v[184:187], v[244:247], v[64:67], v[184:187]
    v_mfma_f32_16x16x32_bf16 v[188:191], v[244:247], v[128:131], v[188:191]
    s_waitcnt vmcnt(8)
    v_max3_u32 v7, v71, v135, v75
    v_max_u32 v7, v7, v139
    v_cmp_eq_u32 vcc, -1, v7
    ds_read_b64_tr_b16 v[244:245], v12 offset:22528
    ds_read_b64_tr_b16 v[246:247], v12 offset:22784
    v_mfma_f32_16x16x32_bf16 v[192:195], v[248:251], v[64:67], v[192:195]
    v_mfma_f32_16x16x32_bf16 v[196:199], v[248:251], v[128:131], v[196:199]
    s_and_b64 vcc, vcc, s[100:101]
    s_cbranch_vccnz L_rt6_main_kernel
L_ok6_main_kernel:
    ds_read_b64_tr_b16 v[248:249], v14 offset:22528
    ds_read_b64_tr_b16 v[250:251], v14 offset:22784
    v_mfma_f32_16x16x32_bf16 v[200:203], v[252:255], v[64:67], v[200:203]
    v_mfma_f32_16x16x32_bf16 v[204:207], v[252:255], v[128:131], v[204:207]
    ds_read_b64_tr_b16 v[252:253], v13 offset:22528
    ds_read_b64_tr_b16 v[254:255], v13 offset:22784
    s_waitcnt lgkmcnt(15)
    v_mfma_f32_16x16x32_bf16 v[176:179], v[208:211], v[68:71], v[176:179]
    v_mfma_f32_16x16x32_bf16 v[180:183], v[208:211], v[132:135], v[180:183]
    s_mov_b64 exec, s[100:101]
    s_cbranch_execz L_sx15_main_kernel
    buffer_load_dwordx4 v[92:95], v5, s[8:11], s38 offen offset:3072 sc1
    buffer_load_dwordx4 v[156:159], v5, s[8:11], s39 offen offset:3072 sc1
L_sx15_main_kernel:
    s_mov_b64 exec, -1
    ds_read_b64_tr_b16 v[208:209], v11 offset:24576
    ds_read_b64_tr_b16 v[210:211], v11 offset:24832
    v_mfma_f32_16x16x32_bf16 v[184:187], v[212:215], v[68:71], v[184:187]
    v_mfma_f32_16x16x32_bf16 v[188:191], v[212:215], v[132:135], v[188:191]
    ds_read_b64_tr_b16 v[212:213], v12 offset:24576
    ds_read_b64_tr_b16 v[214:215], v12 offset:24832
    v_mfma_f32_16x16x32_bf16 v[192:195], v[216:219], v[68:71], v[192:195]
    v_mfma_f32_16x16x32_bf16 v[196:199], v[216:219], v[132:135], v[196:199]
    ds_read_b64_tr_b16 v[216:217], v14 offset:24576
    ds_read_b64_tr_b16 v[218:219], v14 offset:24832
    v_mfma_f32_16x16x32_bf16 v[200:203], v[220:223], v[68:71], v[200:203]
    v_mfma_f32_16x16x32_bf16 v[204:207], v[220:223], v[132:135], v[204:207]
    ds_read_b64_tr_b16 v[220:221], v13 offset:24576
    ds_read_b64_tr_b16 v[222:223], v13 offset:24832
    s_waitcnt lgkmcnt(15)
    v_mfma_f32_16x16x32_bf16 v[176:179], v[224:227], v[72:75], v[176:179]
    v_mfma_f32_16x16x32_bf16 v[180:183], v[224:227], v[136:139], v[180:183]
    ds_read_b64_tr_b16 v[224:225], v11 offset:26624
    ds_read_b64_tr_b16 v[226:227], v11 offset:26880
    v_mfma_f32_16x16x32_bf16 v[184:187], v[228:231], v[72:75], v[184:187]
    v_mfma_f32_16x16x32_bf16 v[188:191], v[228:231], v[136:139], v[188:191]
    s_waitcnt vmcnt(6)
    v_max3_u32 v7, v79, v143, v83
    v_max_u32 v7, v7, v147
    v_cmp_eq_u32 vcc, -1, v7
    ds_read_b64_tr_b16 v[228:229], v12 offset:26624
    ds_read_b64_tr_b16 v[230:231], v12 offset:26880
    v_mfma_f32_16x16x32_bf16 v[192:195], v[232:235], v[72:75], v[192:195]
    v_mfma_f32_16x16x32_bf16 v[196:199], v[232:235], v[136:139], v[196:199]
    s_and_b64 vcc, vcc, s[100:101]
    s_cbranch_vccnz L_rt7_main_kernel
L_ok7_main_kernel:
    ds_read_b64_tr_b16 v[232:233], v14 offset:26624
    ds_read_b64_tr_b16 v[234:235], v14 offset:26880
    v_mfma_f32_16x16x32_bf16 v[200:203], v[236:239], v[72:75], v[200:203]
    v_mfma_f32_16x16x32_bf16 v[204:207], v[236:239], v[136:139], v[204:207]
    ds_read_b64_tr_b16 v[236:237], v13 offset:26624
    ds_read_b64_tr_b16 v[238:239], v13 offset:26880
    s_barrier
    ds_read_b128 v[160:163], v29 offset:128
    ds_read_b128 v[164:167], v29 offset:192
    ds_read_b128 v[168:171], v29 offset:256
    ds_read_b128 v[172:175], v29 offset:320
    s_waitcnt lgkmcnt(15)
    v_mfma_f32_16x16x32_bf16 v[176:179], v[240:243], v[76:79], v[176:179]
    v_mfma_f32_16x16x32_bf16 v[180:183], v[240:243], v[140:143], v[180:183]
    ds_read_b64_tr_b16 v[240:241], v11 offset:28672
    ds_read_b64_tr_b16 v[242:243], v11 offset:28928
    v_mfma_f32_16x16x32_bf16 v[184:187], v[244:247], v[76:79], v[184:187]
    v_mfma_f32_16x16x32_bf16 v[188:191], v[244:247], v[140:143], v[188:191]
    ds_read_b64_tr_b16 v[244:245], v12 offset:28672
    ds_read_b64_tr_b16 v[246:247], v12 offset:28928
    v_mfma_f32_16x16x32_bf16 v[192:195], v[248:251], v[76:79], v[192:195]
    v_mfma_f32_16x16x32_bf16 v[196:199], v[248:251], v[140:143], v[196:199]
    ds_read_b64_tr_b16 v[248:249], v14 offset:28672
    ds_read_b64_tr_b16 v[250:251], v14 offset:28928
    v_mfma_f32_16x16x32_bf16 v[200:203], v[252:255], v[76:79], v[200:203]
    v_mfma_f32_16x16x32_bf16 v[204:207], v[252:255], v[140:143], v[204:207]
    ds_read_b64_tr_b16 v[252:253], v13 offset:28672
    ds_read_b64_tr_b16 v[254:255], v13 offset:28928
    s_waitcnt lgkmcnt(8)
    v_mfma_f32_16x16x32_bf16 v[176:179], v[208:211], v[80:83], v[176:179]
    v_mfma_f32_16x16x32_bf16 v[180:183], v[208:211], v[144:147], v[180:183]
    ds_read_b64_tr_b16 v[208:209], v11 offset:30720
    ds_read_b64_tr_b16 v[210:211], v11 offset:30976
    v_mfma_f32_16x16x32_bf16 v[184:187], v[212:215], v[80:83], v[184:187]
    v_mfma_f32_16x16x32_bf16 v[188:191], v[212:215], v[144:147], v[188:191]
    s_waitcnt vmcnt(2)
    v_max3_u32 v7, v87, v151, v91
    v_max_u32 v7, v7, v155
    v_cmp_eq_u32 vcc, -1, v7
    ds_read_b64_tr_b16 v[212:213], v12 offset:30720
    ds_read_b64_tr_b16 v[214:215], v12 offset:30976
    v_mfma_f32_16x16x32_bf16 v[192:195], v[216:219], v[80:83], v[192:195]
    v_mfma_f32_16x16x32_bf16 v[196:199], v[216:219], v[144:147], v[196:199]
    v_pk_fma_f32 v[176:177], v[160:161], v[22:23], v[176:177] op_sel:[0,1,0] op_sel_hi:[1,1,1]
    v_pk_fma_f32 v[178:179], v[162:163], v[22:23], v[178:179] op_sel:[0,1,0] op_sel_hi:[1,1,1]
    v_pk_fma_f32 v[180:181], v[160:161], v[26:27], v[180:181] op_sel:[0,1,0] op_sel_hi:[1,1,1]
    v_pk_fma_f32 v[182:183], v[162:163], v[26:27], v[182:183] op_sel:[0,1,0] op_sel_hi:[1,1,1]
    s_and_b64 vcc, vcc, s[100:101]
    s_cbranch_vccnz L_rt8_main_kernel
L_ok8_main_kernel:
    ds_read_b64_tr_b16 v[216:217], v14 offset:30720
    ds_read_b64_tr_b16 v[218:219], v14 offset:30976
    v_mfma_f32_16x16x32_bf16 v[200:203], v[220:223], v[80:83], v[200:203]
    v_mfma_f32_16x16x32_bf16 v[204:207], v[220:223], v[144:147], v[204:207]
    v_pk_fma_f32 v[184:185], v[164:165], v[22:23], v[184:185] op_sel:[0,1,0] op_sel_hi:[1,1,1]
    v_pk_fma_f32 v[186:187], v[166:167], v[22:23], v[186:187] op_sel:[0,1,0] op_sel_hi:[1,1,1]
    v_pk_fma_f32 v[188:189], v[164:165], v[26:27], v[188:189] op_sel:[0,1,0] op_sel_hi:[1,1,1]
    v_pk_fma_f32 v[190:191], v[166:167], v[26:27], v[190:191] op_sel:[0,1,0] op_sel_hi:[1,1,1]
    ds_read_b64_tr_b16 v[220:221], v13 offset:30720
    ds_read_b64_tr_b16 v[222:223], v13 offset:30976
    s_waitcnt lgkmcnt(15)
    v_mfma_f32_16x16x32_bf16 v[176:179], v[224:227], v[84:87], v[176:179]
    v_mfma_f32_16x16x32_bf16 v[180:183], v[224:227], v[148:151], v[180:183]
    v_pk_fma_f32 v[192:193], v[168:169], v[22:23], v[192:193] op_sel:[0,1,0] op_sel_hi:[1,1,1]
    v_pk_fma_f32 v[194:195], v[170:171], v[22:23], v[194:195] op_sel:[0,1,0] op_sel_hi:[1,1,1]
    v_pk_fma_f32 v[196:197], v[168:169], v[26:27], v[196:197] op_sel:[0,1,0] op_sel_hi:[1,1,1]
    v_pk_fma_f32 v[198:199], v[170:171], v[26:27], v[198:199] op_sel:[0,1,0] op_sel_hi:[1,1,1]
    ds_read_b64_tr_b16 v[224:225], v11 offset:32768
    ds_read_b64_tr_b16 v[226:227], v11 offset:33024
    v_mfma_f32_16x16x32_bf16 v[184:187], v[228:231], v[84:87], v[184:187]
    v_mfma_f32_16x16x32_bf16 v[188:191], v[228:231], v[148:151], v[188:191]
    v_pk_fma_f32 v[200:201], v[172:173], v[22:23], v[200:201] op_sel:[0,1,0] op_sel_hi:[1,1,1]
    v_pk_fma_f32 v[202:203], v[174:175], v[22:23], v[202:203] op_sel:[0,1,0] op_sel_hi:[1,1,1]
    v_pk_fma_f32 v[204:205], v[172:173], v[26:27], v[204:205] op_sel:[0,1,0] op_sel_hi:[1,1,1]
    v_pk_fma_f32 v[206:207], v[174:175], v[26:27], v[206:207] op_sel:[0,1,0] op_sel_hi:[1,1,1]
    ds_read_b64_tr_b16 v[228:229], v12 offset:32768
    ds_read_b64_tr_b16 v[230:231], v12 offset:33024
    v_mfma_f32_16x16x32_bf16 v[192:195], v[232:235], v[84:87], v[192:195]
    v_mfma_f32_16x16x32_bf16 v[196:199], v[232:235], v[148:151], v[196:199]
    ds_read_b64_tr_b16 v[232:233], v11 offset:34816
    ds_read_b64_tr_b16 v[234:235], v11 offset:35072
    v_mfma_f32_16x16x32_bf16 v[200:203], v[236:239], v[84:87], v[200:203]
    v_mfma_f32_16x16x32_bf16 v[204:207], v[236:239], v[148:151], v[204:207]
    ds_read_b64_tr_b16 v[236:237], v12 offset:34816
    ds_read_b64_tr_b16 v[238:239], v12 offset:35072
    ds_read_b128 v[160:163], v29 offset:0
    ds_read_b128 v[168:171], v29 offset:64
    s_waitcnt lgkmcnt(15)
    v_mfma_f32_16x16x32_bf16 v[176:179], v[240:243], v[88:91], v[176:179]
    v_mfma_f32_16x16x32_bf16 v[180:183], v[240:243], v[152:155], v[180:183]
    ds_read_b64_tr_b16 v[240:241], v11 offset:36864
    ds_read_b64_tr_b16 v[242:243], v11 offset:37120
    v_mfma_f32_16x16x32_bf16 v[184:187], v[244:247], v[88:91], v[184:187]
    v_mfma_f32_16x16x32_bf16 v[188:191], v[244:247], v[152:155], v[188:191]
    s_waitcnt vmcnt(0)
    v_max_u32 v7, v95, v159
    v_cmp_eq_u32 vcc, -1, v7
    ds_read_b64_tr_b16 v[244:245], v12 offset:36864
    ds_read_b64_tr_b16 v[246:247], v12 offset:37120
    v_mfma_f32_16x16x32_bf16 v[192:195], v[248:251], v[88:91], v[192:195]
    v_mfma_f32_16x16x32_bf16 v[196:199], v[248:251], v[152:155], v[196:199]
    s_and_b64 vcc, vcc, s[100:101]
    s_cbranch_vccnz L_rt9_main_kernel
L_ok9_main_kernel:
    ds_read_b64_tr_b16 v[248:249], v11 offset:38912
    ds_read_b64_tr_b16 v[250:251], v11 offset:39168
    v_mfma_f32_16x16x32_bf16 v[200:203], v[252:255], v[88:91], v[200:203]
    v_mfma_f32_16x16x32_bf16 v[204:207], v[252:255], v[152:155], v[204:207]
    ds_read_b64_tr_b16 v[252:253], v12 offset:38912
    ds_read_b64_tr_b16 v[254:255], v12 offset:39168
    s_waitcnt lgkmcnt(15)
    v_mfma_f32_16x16x32_bf16 v[176:179], v[208:211], v[92:95], v[176:179]
    s_waitcnt lgkmcnt(8)
    v_pk_mul_f32 v[164:165], v[160:161], v[26:27] op_sel:[0,1] op_sel_hi:[1,1]
    s_nop 1
    v_mfma_f32_16x16x32_bf16 v[180:183], v[208:211], v[156:159], v[180:183]
    v_pk_mul_f32 v[166:167], v[162:163], v[26:27] op_sel:[0,1] op_sel_hi:[1,1]
    s_nop 1
    v_mfma_f32_16x16x32_bf16 v[184:187], v[212:215], v[92:95], v[184:187]
    v_pk_mul_f32 v[160:161], v[160:161], v[22:23] op_sel:[0,1] op_sel_hi:[1,1]
    s_nop 1
    v_mfma_f32_16x16x32_bf16 v[188:191], v[212:215], v[156:159], v[188:191]
    v_pk_mul_f32 v[162:163], v[162:163], v[22:23] op_sel:[0,1] op_sel_hi:[1,1]
    s_nop 1
    v_mfma_f32_16x16x32_bf16 v[192:195], v[216:219], v[92:95], v[192:195]
    v_pk_mul_f32 v[172:173], v[168:169], v[26:27] op_sel:[0,1] op_sel_hi:[1,1]
    s_nop 1
    v_mfma_f32_16x16x32_bf16 v[196:199], v[216:219], v[156:159], v[196:199]
    v_pk_mul_f32 v[174:175], v[170:171], v[26:27] op_sel:[0,1] op_sel_hi:[1,1]
    s_nop 1
    v_mfma_f32_16x16x32_bf16 v[200:203], v[220:223], v[92:95], v[200:203]
    v_pk_mul_f32 v[168:169], v[168:169], v[22:23] op_sel:[0,1] op_sel_hi:[1,1]
    s_nop 1
    v_mfma_f32_16x16x32_bf16 v[204:207], v[220:223], v[156:159], v[204:207]
    v_pk_mul_f32 v[170:171], v[170:171], v[22:23] op_sel:[0,1] op_sel_hi:[1,1]
    s_barrier
    s_waitcnt lgkmcnt(14)
    v_mfma_f32_16x16x32_bf16 v[160:163], v[224:227], v[32:35], v[160:163]
    v_pk_mul_f32 v[176:177], v[176:177], v[20:21] op_sel_hi:[1,0]
    v_pk_mul_f32 v[184:185], v[184:185], v[20:21] op_sel_hi:[1,0]
    v_pk_mul_f32 v[180:181], v[180:181], v[24:25] op_sel_hi:[1,0]
    v_pk_mul_f32 v[188:189], v[188:189], v[24:25] op_sel_hi:[1,0]
    s_nop 1
    v_mfma_f32_16x16x32_bf16 v[164:167], v[224:227], v[96:99], v[164:167]
    ds_read_b64_tr_b16 v[224:225], v11 offset:40960
    ds_read_b64_tr_b16 v[226:227], v11 offset:41216
    v_pk_mul_f32 v[178:179], v[178:179], v[20:21] op_sel_hi:[1,0]
    v_pk_mul_f32 v[186:187], v[186:187], v[20:21] op_sel_hi:[1,0]
    v_pk_mul_f32 v[182:183], v[182:183], v[24:25] op_sel_hi:[1,0]
    v_pk_mul_f32 v[190:191], v[190:191], v[24:25] op_sel_hi:[1,0]
    s_nop 1
    v_mfma_f32_16x16x32_bf16 v[168:171], v[228:231], v[32:35], v[168:171]
    v_cvt_pk_bf16_f32 v208, v176, v177
    v_cvt_pk_bf16_f32 v210, v184, v185
    v_cvt_pk_bf16_f32 v212, v180, v181
    v_cvt_pk_bf16_f32 v214, v188, v189
    v_mfma_f32_16x16x32_bf16 v[172:175], v[228:231], v[96:99], v[172:175]
    ds_read_b64_tr_b16 v[228:229], v12 offset:40960
    ds_read_b64_tr_b16 v[230:231], v12 offset:41216
    v_cvt_pk_bf16_f32 v209, v178, v179
    v_cvt_pk_bf16_f32 v211, v186, v187
    v_cvt_pk_bf16_f32 v213, v182, v183
    v_cvt_pk_bf16_f32 v215, v190, v191
    ds_read_b128 v[32:35], v15
    s_waitcnt lgkmcnt(15)
    v_mfma_f32_16x16x32_bf16 v[160:163], v[232:235], v[36:39], v[160:163]
    v_mov_b32 v98, 0x3f803f80
    v_mov_b32 v99, 0x3f803f80
    v_mfma_f32_16x16x32_bf16 v[164:167], v[232:235], v[100:103], v[164:167]
    ds_read_b64_tr_b16 v[232:233], v11 offset:43008
    ds_read_b64_tr_b16 v[234:235], v11 offset:43264
    v_and_b32 v21, 1, v4
    v_lshlrev_b32 v21, 4, v21
    v_mov_b32 v22, 0x3f80
    v_mfma_f32_16x16x32_bf16 v[168:171], v[236:239], v[36:39], v[168:171]
    v_lshlrev_b32 v22, v21, v22
    v_lshrrev_b32 v21, 2, v4
    v_mfma_f32_16x16x32_bf16 v[172:175], v[236:239], v[100:103], v[172:175]
    ds_read_b64_tr_b16 v[236:237], v12 offset:43008
    ds_read_b64_tr_b16 v[238:239], v12 offset:43264
    v_cmp_eq_u32 vcc, v21, v3
    s_nop 1
    v_cndmask_b32 v22, 0, v22, vcc
    v_and_b32 v21, 2, v4
    s_waitcnt lgkmcnt(13)
    v_mfma_f32_16x16x32_bf16 v[160:163], v[240:243], v[40:43], v[160:163]
    v_cmp_eq_u32 vcc, 0, v21
    s_nop 1
    v_cndmask_b32 v96, 0, v22, vcc
    v_mfma_f32_16x16x32_bf16 v[164:167], v[240:243], v[104:107], v[164:167]
    ds_read_b64_tr_b16 v[240:241], v11 offset:45056
    ds_read_b64_tr_b16 v[242:243], v11 offset:45312
    v_cndmask_b32 v97, v22, 0, vcc
    s_lshl_b32 s37, s32, 13
    s_add_u32 s37, s37, 0x10000
    v_mfma_f32_16x16x32_bf16 v[168:171], v[244:247], v[40:43], v[168:171]
    v_add_u32 v21, s37, v5
    s_lshr_b32 s37, s32, 1
    v_mfma_f32_16x16x32_bf16 v[172:175], v[244:247], v[104:107], v[172:175]
    ds_read_b64_tr_b16 v[244:245], v12 offset:45056
    ds_read_b64_tr_b16 v[246:247], v12 offset:45312
    s_lshl_b32 s37, s37, 12
    s_and_b32 s38, s32, 1
    s_lshl_b32 s38, s38, 10
    s_waitcnt lgkmcnt(13)
    v_mfma_f32_16x16x32_bf16 v[160:163], v[248:251], v[44:47], v[160:163]
    s_add_u32 s37, s37, s38
    s_add_u32 s37, s37, 0x10000
    v_mfma_f32_16x16x32_bf16 v[164:167], v[248:251], v[108:111], v[164:167]
    ds_read_b64_tr_b16 v[248:249], v11 offset:47104
    ds_read_b64_tr_b16 v[250:251], v11 offset:47360
    v_add_u32 v22, s37, v5
    v_pk_mul_f32 v[192:193], v[192:193], v[20:21] op_sel_hi:[1,0]
    v_pk_mul_f32 v[200:201], v[200:201], v[20:21] op_sel_hi:[1,0]
    s_nop 1
    v_mfma_f32_16x16x32_bf16 v[168:171], v[252:255], v[44:47], v[168:171]
    v_pk_mul_f32 v[196:197], v[196:197], v[24:25] op_sel_hi:[1,0]
    v_pk_mul_f32 v[204:205], v[204:205], v[24:25] op_sel_hi:[1,0]
    s_nop 1
    v_mfma_f32_16x16x32_bf16 v[172:175], v[252:255], v[108:111], v[172:175]
    ds_read_b64_tr_b16 v[252:253], v12 offset:47104
    ds_read_b64_tr_b16 v[254:255], v12 offset:47360
    v_pk_mul_f32 v[194:195], v[194:195], v[20:21] op_sel_hi:[1,0]
    v_pk_mul_f32 v[202:203], v[202:203], v[20:21] op_sel_hi:[1,0]
    v_pk_mul_f32 v[198:199], v[198:199], v[24:25] op_sel_hi:[1,0]
    s_waitcnt lgkmcnt(13)
    s_nop 0
    v_mfma_f32_16x16x32_bf16 v[160:163], v[224:227], v[48:51], v[160:163]
    v_pk_mul_f32 v[206:207], v[206:207], v[24:25] op_sel_hi:[1,0]
    v_cvt_pk_bf16_f32 v216, v192, v193
    s_nop 0
    v_mfma_f32_16x16x32_bf16 v[164:167], v[224:227], v[112:115], v[164:167]
    ds_read_b64_tr_b16 v[224:225], v11 offset:49152
    ds_read_b64_tr_b16 v[226:227], v11 offset:49408
    v_cvt_pk_bf16_f32 v218, v200, v201
    v_cvt_pk_bf16_f32 v220, v196, v197
    v_cvt_pk_bf16_f32 v222, v204, v205
    v_mfma_f32_16x16x32_bf16 v[168:171], v[228:231], v[48:51], v[168:171]
    v_cvt_pk_bf16_f32 v217, v194, v195
    v_cvt_pk_bf16_f32 v219, v202, v203
    v_mfma_f32_16x16x32_bf16 v[172:175], v[228:231], v[112:115], v[172:175]
    ds_read_b64_tr_b16 v[228:229], v12 offset:49152
    ds_read_b64_tr_b16 v[230:231], v12 offset:49408
    v_cvt_pk_bf16_f32 v221, v198, v199
    v_cvt_pk_bf16_f32 v223, v206, v207
    s_waitcnt lgkmcnt(15)
    v_mfma_f32_16x16x16_bf16 v[176:179], v[32:33], v[208:209], 0
    v_mfma_f32_16x16x16_bf16 v[184:187], v[34:35], v[210:211], 0
    v_mfma_f32_16x16x16_bf16 v[180:183], v[32:33], v[212:213], 0
    v_mfma_f32_16x16x16_bf16 v[188:191], v[34:35], v[214:215], 0
    v_mfma_f32_16x16x16_bf16 v[192:195], v[216:217], v[96:97], 0
    v_mfma_f32_16x16x16_bf16 v[200:203], v[218:219], v[96:97], 0
    v_mfma_f32_16x16x16_bf16 v[196:199], v[220:221], v[96:97], 0
    v_mfma_f32_16x16x16_bf16 v[204:207], v[222:223], v[96:97], 0
    s_waitcnt lgkmcnt(12)
    v_mfma_f32_16x16x32_bf16 v[160:163], v[232:235], v[52:55], v[160:163]
    v_max3_f32 v36, v176, v177, v178
    v_max3_f32 v37, -v176, -v177, -v178
    v_max3_f32 v100, v184, v185, v186
    v_max3_f32 v101, -v184, -v185, -v186
    v_mfma_f32_16x16x32_bf16 v[164:167], v[232:235], v[116:119], v[164:167]
    ds_read_b64_tr_b16 v[232:233], v11 offset:51200
    ds_read_b64_tr_b16 v[234:235], v11 offset:51456
    v_max_f32 v36, v36, v179
    v_max_f32_e64 v37, v37, -v179
    v_max_f32 v100, v100, v187
    v_max_f32_e64 v101, v101, -v187
    v_mfma_f32_16x16x32_bf16 v[168:171], v[236:239], v[52:55], v[168:171]
    v_cvt_pk_bf16_f32 v216, v192, v193
    v_cvt_pk_bf16_f32 v217, v194, v195
    v_cvt_pk_bf16_f32 v218, v200, v201
    v_cvt_pk_bf16_f32 v219, v202, v203
    v_mfma_f32_16x16x32_bf16 v[172:175], v[236:239], v[116:119], v[172:175]
    ds_read_b64_tr_b16 v[236:237], v12 offset:51200
    ds_read_b64_tr_b16 v[238:239], v12 offset:51456
    v_cvt_pk_bf16_f32 v220, v196, v197
    v_cvt_pk_bf16_f32 v221, v198, v199
    v_cvt_pk_bf16_f32 v222, v204, v205
    v_cvt_pk_bf16_f32 v223, v206, v207
    s_waitcnt lgkmcnt(12)
    v_mfma_f32_16x16x32_bf16 v[160:163], v[240:243], v[56:59], v[160:163]
    v_permlane32_swap_b32 v36, v37
    v_permlane32_swap_b32 v100, v101
    v_max_f32 v36, v36, v37
    v_max_f32 v100, v100, v101
    v_mfma_f32_16x16x32_bf16 v[164:167], v[240:243], v[120:123], v[164:167]
    ds_read_b64_tr_b16 v[240:241], v11 offset:53248
    ds_read_b64_tr_b16 v[242:243], v11 offset:53504
    v_permlane16_swap_b32 v36, v100
    v_max_f32 v36, v36, v100
    v_mul_f32 v36, s41, v36
    v_mov_b32 v100, v36
    v_mfma_f32_16x16x32_bf16 v[168:171], v[244:247], v[56:59], v[168:171]
    s_nop 0
    v_permlane16_swap_b32 v36, v100
    v_mov_b32 v37, v36
    v_mov_b32 v101, v100
    s_nop 0
    v_permlane32_swap_b32 v36, v37
    v_mfma_f32_16x16x32_bf16 v[172:175], v[244:247], v[120:123], v[172:175]
    ds_read_b64_tr_b16 v[244:245], v12 offset:53248
    ds_read_b64_tr_b16 v[246:247], v12 offset:53504
    v_permlane32_swap_b32 v100, v101
    v_pk_fma_f32 v[40:41], v[176:177], s[40:41], v[36:37] op_sel:[0,1,0] op_sel_hi:[1,1,0] neg_lo:[0,0,1] neg_hi:[0,0,1]
    v_pk_fma_f32 v[44:45], v[176:177], s[40:41], v[36:37] op_sel:[0,1,1] op_sel_hi:[1,1,1] neg_lo:[1,0,1] neg_hi:[1,0,1]
    v_pk_fma_f32 v[42:43], v[178:179], s[40:41], v[36:37] op_sel:[0,1,0] op_sel_hi:[1,1,0] neg_lo:[0,0,1] neg_hi:[0,0,1]
    v_pk_fma_f32 v[46:47], v[178:179], s[40:41], v[36:37] op_sel:[0,1,1] op_sel_hi:[1,1,1] neg_lo:[1,0,1] neg_hi:[1,0,1]
    s_waitcnt lgkmcnt(12)
    s_nop 0
    v_mfma_f32_16x16x32_bf16 v[160:163], v[248:251], v[60:63], v[160:163]
    v_pk_fma_f32 v[104:105], v[184:185], s[40:41], v[100:101] op_sel:[0,1,0] op_sel_hi:[1,1,0] neg_lo:[0,0,1] neg_hi:[0,0,1]
    v_pk_fma_f32 v[108:109], v[184:185], s[40:41], v[100:101] op_sel:[0,1,1] op_sel_hi:[1,1,1] neg_lo:[1,0,1] neg_hi:[1,0,1]
    v_pk_fma_f32 v[106:107], v[186:187], s[40:41], v[100:101] op_sel:[0,1,0] op_sel_hi:[1,1,0] neg_lo:[0,0,1] neg_hi:[0,0,1]
    v_pk_fma_f32 v[110:111], v[186:187], s[40:41], v[100:101] op_sel:[0,1,1] op_sel_hi:[1,1,1] neg_lo:[1,0,1] neg_hi:[1,0,1]
    s_nop 1
    v_mfma_f32_16x16x32_bf16 v[164:167], v[248:251], v[124:127], v[164:167]
    ds_read_b64_tr_b16 v[248:249], v11 offset:55296
    ds_read_b64_tr_b16 v[250:251], v11 offset:55552
    v_exp_f32 v40, v40
    v_exp_f32 v104, v104
    v_exp_f32 v41, v41
    v_exp_f32 v105, v105
    v_mfma_f32_16x16x32_bf16 v[168:171], v[252:255], v[60:63], v[168:171]
    v_exp_f32 v42, v42
    v_exp_f32 v106, v106
    v_exp_f32 v43, v43
    v_exp_f32 v107, v107
    v_mfma_f32_16x16x32_bf16 v[172:175], v[252:255], v[124:127], v[172:175]
    ds_read_b64_tr_b16 v[252:253], v12 offset:55296
    ds_read_b64_tr_b16 v[254:255], v12 offset:55552
    v_exp_f32 v44, v44
    v_exp_f32 v108, v108
    v_exp_f32 v45, v45
    v_exp_f32 v109, v109
    s_waitcnt lgkmcnt(12)
    v_mfma_f32_16x16x32_bf16 v[160:163], v[224:227], v[64:67], v[160:163]
    v_exp_f32 v46, v46
    v_exp_f32 v110, v110
    v_exp_f32 v47, v47
    v_exp_f32 v111, v111
    v_mfma_f32_16x16x32_bf16 v[164:167], v[224:227], v[128:131], v[164:167]
    ds_read_b64_tr_b16 v[224:225], v11 offset:57344
    ds_read_b64_tr_b16 v[226:227], v11 offset:57600
    v_pk_add_f32 v[36:37], v[40:41], v[42:43]
    v_pk_add_f32 v[100:101], v[104:105], v[106:107]
    v_pk_add_f32 v[38:39], v[44:45], v[46:47]
    v_pk_add_f32 v[102:103], v[108:109], v[110:111]
    s_nop 1
    v_mfma_f32_16x16x32_bf16 v[168:171], v[228:231], v[64:67], v[168:171]
    v_add_f32 v36, v36, v37
    v_add_f32 v100, v100, v101
    v_add_f32 v37, v38, v39
    v_add_f32 v101, v102, v103
    s_nop 0
    v_permlane32_swap_b32 v36, v37
    v_mfma_f32_16x16x32_bf16 v[172:175], v[228:231], v[128:131], v[172:175]
    ds_read_b64_tr_b16 v[228:229], v12 offset:57344
    ds_read_b64_tr_b16 v[230:231], v12 offset:57600
    v_permlane32_swap_b32 v100, v101
    v_add_f32 v36, v36, v37
    v_add_f32 v100, v100, v101
    s_nop 1
    v_permlane16_swap_b32 v36, v100
    s_waitcnt lgkmcnt(12)
    v_mfma_f32_16x16x32_bf16 v[160:163], v[232:235], v[68:71], v[160:163]
    v_add_f32 v36, v36, v100
    v_rcp_f32 v36, v36
    s_nop 0
    v_mov_b32 v100, v36
    v_mfma_f32_16x16x32_bf16 v[164:167], v[232:235], v[132:135], v[164:167]
    ds_read_b64_tr_b16 v[232:233], v11 offset:59392
    ds_read_b64_tr_b16 v[234:235], v11 offset:59648
    v_permlane16_swap_b32 v36, v100
    v_mov_b32 v37, v36
    v_mov_b32 v101, v100
    s_nop 0
    v_permlane32_swap_b32 v36, v37
    v_mfma_f32_16x16x32_bf16 v[168:171], v[236:239], v[68:71], v[168:171]
    v_permlane32_swap_b32 v100, v101
    v_pk_mul_f32 v[40:41], v[40:41], v[36:37] op_sel_hi:[1,0]
    v_pk_mul_f32 v[44:45], v[44:45], v[36:37] op_sel:[0,1] op_sel_hi:[1,1]
    v_pk_mul_f32 v[42:43], v[42:43], v[36:37] op_sel_hi:[1,0]
    s_nop 1
    v_mfma_f32_16x16x32_bf16 v[172:175], v[236:239], v[132:135], v[172:175]
    ds_read_b64_tr_b16 v[236:237], v12 offset:59392
    ds_read_b64_tr_b16 v[238:239], v12 offset:59648
    v_pk_mul_f32 v[46:47], v[46:47], v[36:37] op_sel:[0,1] op_sel_hi:[1,1]
    v_pk_mul_f32 v[104:105], v[104:105], v[100:101] op_sel_hi:[1,0]
    v_pk_mul_f32 v[108:109], v[108:109], v[100:101] op_sel:[0,1] op_sel_hi:[1,1]
    v_pk_mul_f32 v[106:107], v[106:107], v[100:101] op_sel_hi:[1,0]
    s_waitcnt lgkmcnt(12)
    s_nop 0
    v_mfma_f32_16x16x32_bf16 v[160:163], v[240:243], v[72:75], v[160:163]
    v_pk_mul_f32 v[110:111], v[110:111], v[100:101] op_sel:[0,1] op_sel_hi:[1,1]
    v_cvt_pk_bf16_f32 v48, v40, v41
    v_cvt_pk_bf16_f32 v49, v42, v43
    v_cvt_pk_bf16_f32 v50, v44, v45
    v_mfma_f32_16x16x32_bf16 v[164:167], v[240:243], v[136:139], v[164:167]
    ds_read_b64_tr_b16 v[240:241], v11 offset:61440
    ds_read_b64_tr_b16 v[242:243], v11 offset:61696
    v_cvt_pk_bf16_f32 v51, v46, v47
    v_cvt_pk_bf16_f32 v112, v104, v105
    v_cvt_pk_bf16_f32 v113, v106, v107
    v_cvt_pk_bf16_f32 v114, v108, v109
    v_cvt_pk_bf16_f32 v115, v110, v111
    v_mfma_f32_16x16x32_bf16 v[168:171], v[244:247], v[72:75], v[168:171]
    v_max3_f32 v56, v180, v181, v182
    v_max3_f32 v57, -v180, -v181, -v182
    v_mfma_f32_16x16x16_bf16 v[36:39], v[48:49], v[96:97], 0
    v_mfma_f32_16x16x32_bf16 v[172:175], v[244:247], v[136:139], v[172:175]
    ds_read_b64_tr_b16 v[244:245], v12 offset:61440
    ds_read_b64_tr_b16 v[246:247], v12 offset:61696
    v_mfma_f32_16x16x16_bf16 v[40:43], v[50:51], v[96:97], 0
    v_mfma_f32_16x16x16_bf16 v[100:103], v[112:113], v[96:97], 0
    v_mfma_f32_16x16x16_bf16 v[104:107], v[114:115], v[96:97], 0
    v_max3_f32 v120, v188, v189, v190
    s_waitcnt lgkmcnt(12)
    v_mfma_f32_16x16x32_bf16 v[160:163], v[248:251], v[76:79], v[160:163]
    v_max3_f32 v121, -v188, -v189, -v190
    v_max_f32 v56, v56, v183
    v_max_f32_e64 v57, v57, -v183
    v_mfma_f32_16x16x32_bf16 v[164:167], v[248:251], v[140:143], v[164:167]
    ds_read_b64_tr_b16 v[248:249], v11 offset:63488
    ds_read_b64_tr_b16 v[250:251], v11 offset:63744
    v_max_f32 v120, v120, v191
    v_max_f32_e64 v121, v121, -v191
    v_permlane32_swap_b32 v56, v57
    s_nop 0
    v_permlane32_swap_b32 v120, v121
    v_mfma_f32_16x16x32_bf16 v[168:171], v[252:255], v[76:79], v[168:171]
    v_max_f32 v56, v56, v57
    v_max_f32 v120, v120, v121
    s_nop 1
    v_permlane16_swap_b32 v56, v120
    v_mfma_f32_16x16x32_bf16 v[172:175], v[252:255], v[140:143], v[172:175]
    ds_read_b64_tr_b16 v[252:253], v12 offset:63488
    ds_read_b64_tr_b16 v[254:255], v12 offset:63744
    v_max_f32 v56, v56, v120
    v_mul_f32 v56, s41, v56
    v_mov_b32 v120, v56
    s_nop 1
    v_permlane16_swap_b32 v56, v120
    s_waitcnt lgkmcnt(12)
    v_mfma_f32_16x16x32_bf16 v[160:163], v[224:227], v[80:83], v[160:163]
    v_mov_b32 v57, v56
    v_mov_b32 v121, v120
    s_nop 0
    v_permlane32_swap_b32 v56, v57
    v_permlane32_swap_b32 v120, v121
    v_mfma_f32_16x16x32_bf16 v[164:167], v[224:227], v[144:147], v[164:167]
    v_pk_fma_f32 v[60:61], v[180:181], s[40:41], v[56:57] op_sel:[0,1,0] op_sel_hi:[1,1,0] neg_lo:[0,0,1] neg_hi:[0,0,1]
    v_pk_fma_f32 v[64:65], v[180:181], s[40:41], v[56:57] op_sel:[0,1,1] op_sel_hi:[1,1,1] neg_lo:[1,0,1] neg_hi:[1,0,1]
    v_pk_fma_f32 v[62:63], v[182:183], s[40:41], v[56:57] op_sel:[0,1,0] op_sel_hi:[1,1,0] neg_lo:[0,0,1] neg_hi:[0,0,1]
    s_nop 1
    v_mfma_f32_16x16x32_bf16 v[168:171], v[228:231], v[80:83], v[168:171]
    v_cvt_pk_bf16_f32 v44, v36, v37
    v_cvt_pk_bf16_f32 v45, v38, v39
    v_cvt_pk_bf16_f32 v46, v40, v41
    v_cvt_pk_bf16_f32 v47, v42, v43
    v_mfma_f32_16x16x32_bf16 v[172:175], v[228:231], v[144:147], v[172:175]
    v_cvt_pk_bf16_f32 v108, v100, v101
    v_cvt_pk_bf16_f32 v109, v102, v103
    v_cvt_pk_bf16_f32 v110, v104, v105
    s_waitcnt lgkmcnt(8)
    v_mfma_f32_16x16x32_bf16 v[160:163], v[232:235], v[84:87], v[160:163]
    v_cvt_pk_bf16_f32 v111, v106, v107
    v_pk_fma_f32 v[66:67], v[182:183], s[40:41], v[56:57] op_sel:[0,1,1] op_sel_hi:[1,1,1] neg_lo:[1,0,1] neg_hi:[1,0,1]
    v_pk_fma_f32 v[124:125], v[188:189], s[40:41], v[120:121] op_sel:[0,1,0] op_sel_hi:[1,1,0] neg_lo:[0,0,1] neg_hi:[0,0,1]
    v_pk_fma_f32 v[128:129], v[188:189], s[40:41], v[120:121] op_sel:[0,1,1] op_sel_hi:[1,1,1] neg_lo:[1,0,1] neg_hi:[1,0,1]
    s_nop 1
    v_mfma_f32_16x16x32_bf16 v[164:167], v[232:235], v[148:151], v[164:167]
    v_pk_fma_f32 v[126:127], v[190:191], s[40:41], v[120:121] op_sel:[0,1,0] op_sel_hi:[1,1,0] neg_lo:[0,0,1] neg_hi:[0,0,1]
    v_pk_fma_f32 v[130:131], v[190:191], s[40:41], v[120:121] op_sel:[0,1,1] op_sel_hi:[1,1,1] neg_lo:[1,0,1] neg_hi:[1,0,1]
    v_exp_f32 v60, v60
    v_exp_f32 v124, v124
    v_mfma_f32_16x16x32_bf16 v[168:171], v[236:239], v[84:87], v[168:171]
    v_exp_f32 v61, v61
    v_exp_f32 v125, v125
    v_exp_f32 v62, v62
    v_mfma_f32_16x16x32_bf16 v[172:175], v[236:239], v[148:151], v[172:175]
    v_exp_f32 v126, v126
    v_exp_f32 v63, v63
    v_exp_f32 v127, v127
    v_exp_f32 v64, v64
    s_waitcnt lgkmcnt(4)
    v_mfma_f32_16x16x32_bf16 v[160:163], v[240:243], v[88:91], v[160:163]
    v_exp_f32 v128, v128
    v_exp_f32 v65, v65
    v_exp_f32 v129, v129
    v_mfma_f32_16x16x32_bf16 v[164:167], v[240:243], v[152:155], v[164:167]
    v_exp_f32 v66, v66
    v_exp_f32 v130, v130
    v_exp_f32 v67, v67
    v_exp_f32 v131, v131
    v_mfma_f32_16x16x32_bf16 v[168:171], v[244:247], v[88:91], v[168:171]
    v_pk_add_f32 v[56:57], v[60:61], v[62:63]
    v_pk_add_f32 v[120:121], v[124:125], v[126:127]
    v_pk_add_f32 v[58:59], v[64:65], v[66:67]
    v_pk_add_f32 v[122:123], v[128:129], v[130:131]
    s_nop 1
    v_mfma_f32_16x16x32_bf16 v[172:175], v[244:247], v[152:155], v[172:175]
    v_add_f32 v56, v56, v57
    v_add_f32 v120, v120, v121
    v_add_f32 v57, v58, v59
    s_waitcnt lgkmcnt(0)
    v_mfma_f32_16x16x32_bf16 v[160:163], v[248:251], v[92:95], v[160:163]
    v_add_f32 v121, v122, v123
    v_permlane32_swap_b32 v56, v57
    s_nop 0
    v_permlane32_swap_b32 v120, v121
    v_add_f32 v56, v56, v57
    v_mfma_f32_16x16x32_bf16 v[164:167], v[248:251], v[156:159], v[164:167]
    v_add_f32 v120, v120, v121
    s_nop 1
    v_permlane16_swap_b32 v56, v120
    v_add_f32 v56, v56, v120
    v_mfma_f32_16x16x32_bf16 v[168:171], v[252:255], v[92:95], v[168:171]
    v_rcp_f32 v56, v56
    s_nop 0
    v_mov_b32 v120, v56
    s_nop 1
    v_permlane16_swap_b32 v56, v120
    v_mfma_f32_16x16x32_bf16 v[172:175], v[252:255], v[156:159], v[172:175]
    v_mov_b32 v57, v56
    v_mov_b32 v121, v120
    s_nop 0
    v_permlane32_swap_b32 v56, v57
    v_permlane32_swap_b32 v120, v121
    v_pk_mul_f32 v[60:61], v[60:61], v[56:57] op_sel_hi:[1,0]
    v_pk_mul_f32 v[64:65], v[64:65], v[56:57] op_sel:[0,1] op_sel_hi:[1,1]
    v_pk_mul_f32 v[62:63], v[62:63], v[56:57] op_sel_hi:[1,0]
    v_pk_mul_f32 v[66:67], v[66:67], v[56:57] op_sel:[0,1] op_sel_hi:[1,1]
    v_pk_mul_f32 v[124:125], v[124:125], v[120:121] op_sel_hi:[1,0]
    v_pk_mul_f32 v[128:129], v[128:129], v[120:121] op_sel:[0,1] op_sel_hi:[1,1]
    v_pk_mul_f32 v[126:127], v[126:127], v[120:121] op_sel_hi:[1,0]
    v_pk_mul_f32 v[130:131], v[130:131], v[120:121] op_sel:[0,1] op_sel_hi:[1,1]
    v_cvt_pk_bf16_f32 v52, v60, v61
    v_cvt_pk_bf16_f32 v53, v62, v63
    v_cvt_pk_bf16_f32 v54, v64, v65
    v_cvt_pk_bf16_f32 v55, v66, v67
    v_cvt_pk_bf16_f32 v116, v124, v125
    v_cvt_pk_bf16_f32 v117, v126, v127
    v_cvt_pk_bf16_f32 v118, v128, v129
    v_cvt_pk_bf16_f32 v119, v130, v131
    v_mfma_f32_16x16x16_bf16 v[56:59], v[52:53], v[96:97], 0
    v_mfma_f32_16x16x16_bf16 v[60:63], v[54:55], v[96:97], 0
    v_mfma_f32_16x16x16_bf16 v[120:123], v[116:117], v[96:97], 0
    v_mfma_f32_16x16x16_bf16 v[124:127], v[118:119], v[96:97], 0
    v_mfma_f32_16x16x16_bf16 v[224:227], v[44:45], v[216:217], 0
    v_mfma_f32_16x16x16_bf16 v[228:231], v[46:47], v[216:217], 0
    v_mfma_f32_16x16x16_bf16 v[232:235], v[44:45], v[98:99], 0
    v_mfma_f32_16x16x16_bf16 v[236:239], v[46:47], v[98:99], 0
    v_mfma_f32_16x16x16_bf16 v[240:243], v[108:109], v[218:219], 0
    v_mfma_f32_16x16x16_bf16 v[244:247], v[110:111], v[218:219], 0
    v_mfma_f32_16x16x16_bf16 v[248:251], v[108:109], v[98:99], 0
    v_mfma_f32_16x16x16_bf16 v[252:255], v[110:111], v[98:99], 0
    v_cvt_pk_bf16_f32 v64, v56, v57
    v_cvt_pk_bf16_f32 v65, v58, v59
    v_cvt_pk_bf16_f32 v66, v60, v61
    v_cvt_pk_bf16_f32 v67, v62, v63
    v_cvt_pk_bf16_f32 v128, v120, v121
    v_cvt_pk_bf16_f32 v129, v122, v123
    v_cvt_pk_bf16_f32 v130, v124, v125
    v_cvt_pk_bf16_f32 v131, v126, v127
    v_mfma_f32_16x16x16_bf16 v[224:227], v[64:65], v[220:221], v[224:227]
    v_mfma_f32_16x16x16_bf16 v[228:231], v[66:67], v[220:221], v[228:231]
    v_mfma_f32_16x16x16_bf16 v[232:235], v[64:65], v[98:99], v[232:235]
    v_mfma_f32_16x16x16_bf16 v[236:239], v[66:67], v[98:99], v[236:239]
    v_mfma_f32_16x16x16_bf16 v[240:243], v[128:129], v[222:223], v[240:243]
    v_mfma_f32_16x16x16_bf16 v[244:247], v[130:131], v[222:223], v[244:247]
    v_mfma_f32_16x16x16_bf16 v[248:251], v[128:129], v[98:99], v[248:251]
    v_mfma_f32_16x16x16_bf16 v[252:255], v[130:131], v[98:99], v[252:255]
    s_nop 0
    ds_write_b128 v21, v[224:227] offset:0
    ds_write_b128 v21, v[228:231] offset:1024
    ds_write_b128 v21, v[232:235] offset:2048
    ds_write_b128 v21, v[236:239] offset:3072
    ds_write_b128 v21, v[240:243] offset:4096
    ds_write_b128 v21, v[244:247] offset:5120
    ds_write_b128 v21, v[248:251] offset:6144
    ds_write_b128 v21, v[252:255] offset:7168
    s_waitcnt lgkmcnt(0)
    s_barrier
    ds_read_b128 v[176:179], v22 offset:0
    ds_read_b128 v[192:195], v22 offset:2048
    ds_read_b128 v[184:187], v22 offset:8192
    ds_read_b128 v[200:203], v22 offset:10240
    ds_read_b128 v[180:183], v22 offset:16384
    ds_read_b128 v[196:199], v22 offset:18432
    ds_read_b128 v[188:191], v22 offset:24576
    ds_read_b128 v[204:207], v22 offset:26624
    s_lshl_b32 s39, s36, 2
    s_add_u32 s39, s39, s32
    s_lshl_b32 s39, s39, 4
    s_add_u32 s37, s39, s35
    s_lshl_b32 s38, s37, 6
    s_add_u32 s38, s38, 0x100000
    s_lshl_b32 s37, s37, 9
    v_lshlrev_b32 v15, 3, v2
    v_pk_mul_f32 v[160:161], v[160:161], v[20:21] op_sel_hi:[1,0]
    v_pk_mul_f32 v[168:169], v[168:169], v[20:21] op_sel_hi:[1,0]
    v_pk_mul_f32 v[164:165], v[164:165], v[24:25] op_sel_hi:[1,0]
    v_pk_mul_f32 v[172:173], v[172:173], v[24:25] op_sel_hi:[1,0]
    v_pk_mul_f32 v[162:163], v[162:163], v[20:21] op_sel_hi:[1,0]
    v_pk_mul_f32 v[170:171], v[170:171], v[20:21] op_sel_hi:[1,0]
    v_pk_mul_f32 v[166:167], v[166:167], v[24:25] op_sel_hi:[1,0]
    v_pk_mul_f32 v[174:175], v[174:175], v[24:25] op_sel_hi:[1,0]
    v_cvt_pk_bf16_f32 v48, v160, v161
    v_cvt_pk_bf16_f32 v50, v168, v169
    v_cvt_pk_bf16_f32 v112, v164, v165
    v_cvt_pk_bf16_f32 v114, v172, v173
    v_cvt_pk_bf16_f32 v49, v162, v163
    v_cvt_pk_bf16_f32 v51, v170, v171
    v_cvt_pk_bf16_f32 v113, v166, v167
    v_cvt_pk_bf16_f32 v115, v174, v175
    v_mfma_f32_16x16x16_bf16 v[160:163], v[32:33], v[48:49], 0
    v_mfma_f32_16x16x16_bf16 v[168:171], v[34:35], v[50:51], 0
    v_mfma_f32_16x16x16_bf16 v[164:167], v[32:33], v[112:113], 0
    v_mfma_f32_16x16x16_bf16 v[172:175], v[34:35], v[114:115], 0
    s_waitcnt lgkmcnt(0)
    v_pk_add_f32 v[176:177], v[176:177], v[184:185]
    v_pk_add_f32 v[180:181], v[180:181], v[188:189]
    v_pk_add_f32 v[178:179], v[178:179], v[186:187]
    v_pk_add_f32 v[182:183], v[182:183], v[190:191]
    v_pk_add_f32 v[192:193], v[192:193], v[200:201]
    v_pk_add_f32 v[196:197], v[196:197], v[204:205]
    v_pk_add_f32 v[194:195], v[194:195], v[202:203]
    v_pk_add_f32 v[198:199], v[198:199], v[206:207]
    v_pk_add_f32 v[176:177], v[176:177], v[180:181]
    v_pk_add_f32 v[178:179], v[178:179], v[182:183]
    v_pk_add_f32 v[192:193], v[192:193], v[196:197]
    v_pk_add_f32 v[194:195], v[194:195], v[198:199]
    v_cvt_pk_bf16_f32 v184, v176, v177
    v_cvt_pk_bf16_f32 v185, v178, v179
    buffer_store_dwordx2 v[184:185], v15, s[24:27], s37 offen sc1
    s_mov_b32 exec_lo, 0x00010001
    s_mov_b32 exec_hi, 0x00010001
    buffer_store_dwordx4 v[192:195], v28, s[24:27], s38 offen sc1
    s_mov_b64 exec, -1
    v_max3_f32 v36, v160, v161, v162
    v_max3_f32 v56, v164, v165, v166
    v_max3_f32 v37, -v160, -v161, -v162
    v_max3_f32 v57, -v164, -v165, -v166
    v_max3_f32 v100, v168, v169, v170
    v_max3_f32 v120, v172, v173, v174
    v_max3_f32 v101, -v168, -v169, -v170
    v_max3_f32 v121, -v172, -v173, -v174
    v_max_f32 v36, v36, v163
    v_max_f32 v56, v56, v167
    v_max_f32_e64 v37, v37, -v163
    v_max_f32_e64 v57, v57, -v167
    v_max_f32 v100, v100, v171
    v_max_f32 v120, v120, v175
    v_max_f32_e64 v101, v101, -v171
    v_max_f32_e64 v121, v121, -v175
    v_permlane32_swap_b32 v36, v37
    v_permlane32_swap_b32 v56, v57
    v_permlane32_swap_b32 v100, v101
    v_permlane32_swap_b32 v120, v121
    v_max_f32 v36, v36, v37
    v_max_f32 v56, v56, v57
    v_max_f32 v100, v100, v101
    v_max_f32 v120, v120, v121
    s_nop 0
    v_permlane16_swap_b32 v36, v100
    v_permlane16_swap_b32 v56, v120
    v_max_f32 v36, v36, v100
    v_max_f32 v56, v56, v120
    v_mul_f32 v36, s41, v36
    v_mul_f32 v56, s41, v56
    v_mov_b32 v100, v36
    v_mov_b32 v120, v56
    s_nop 0
    v_permlane16_swap_b32 v36, v100
    v_permlane16_swap_b32 v56, v120
    v_mov_b32 v37, v36
    v_mov_b32 v57, v56
    v_mov_b32 v101, v100
    v_mov_b32 v121, v120
    v_permlane32_swap_b32 v36, v37
    v_permlane32_swap_b32 v56, v57
    v_permlane32_swap_b32 v100, v101
    v_permlane32_swap_b32 v120, v121
    v_pk_fma_f32 v[40:41], v[160:161], s[40:41], v[36:37] op_sel:[0,1,0] op_sel_hi:[1,1,0] neg_lo:[0,0,1] neg_hi:[0,0,1]
    v_pk_fma_f32 v[60:61], v[164:165], s[40:41], v[56:57] op_sel:[0,1,0] op_sel_hi:[1,1,0] neg_lo:[0,0,1] neg_hi:[0,0,1]
    v_pk_fma_f32 v[44:45], v[160:161], s[40:41], v[36:37] op_sel:[0,1,1] op_sel_hi:[1,1,1] neg_lo:[1,0,1] neg_hi:[1,0,1]
    v_pk_fma_f32 v[64:65], v[164:165], s[40:41], v[56:57] op_sel:[0,1,1] op_sel_hi:[1,1,1] neg_lo:[1,0,1] neg_hi:[1,0,1]
    v_pk_fma_f32 v[42:43], v[162:163], s[40:41], v[36:37] op_sel:[0,1,0] op_sel_hi:[1,1,0] neg_lo:[0,0,1] neg_hi:[0,0,1]
    v_pk_fma_f32 v[62:63], v[166:167], s[40:41], v[56:57] op_sel:[0,1,0] op_sel_hi:[1,1,0] neg_lo:[0,0,1] neg_hi:[0,0,1]
    v_pk_fma_f32 v[46:47], v[162:163], s[40:41], v[36:37] op_sel:[0,1,1] op_sel_hi:[1,1,1] neg_lo:[1,0,1] neg_hi:[1,0,1]
    v_pk_fma_f32 v[66:67], v[166:167], s[40:41], v[56:57] op_sel:[0,1,1] op_sel_hi:[1,1,1] neg_lo:[1,0,1] neg_hi:[1,0,1]
    v_pk_fma_f32 v[104:105], v[168:169], s[40:41], v[100:101] op_sel:[0,1,0] op_sel_hi:[1,1,0] neg_lo:[0,0,1] neg_hi:[0,0,1]
    v_pk_fma_f32 v[124:125], v[172:173], s[40:41], v[120:121] op_sel:[0,1,0] op_sel_hi:[1,1,0] neg_lo:[0,0,1] neg_hi:[0,0,1]
    v_pk_fma_f32 v[108:109], v[168:169], s[40:41], v[100:101] op_sel:[0,1,1] op_sel_hi:[1,1,1] neg_lo:[1,0,1] neg_hi:[1,0,1]
    v_pk_fma_f32 v[128:129], v[172:173], s[40:41], v[120:121] op_sel:[0,1,1] op_sel_hi:[1,1,1] neg_lo:[1,0,1] neg_hi:[1,0,1]
    v_pk_fma_f32 v[106:107], v[170:171], s[40:41], v[100:101] op_sel:[0,1,0] op_sel_hi:[1,1,0] neg_lo:[0,0,1] neg_hi:[0,0,1]
    v_pk_fma_f32 v[126:127], v[174:175], s[40:41], v[120:121] op_sel:[0,1,0] op_sel_hi:[1,1,0] neg_lo:[0,0,1] neg_hi:[0,0,1]
    v_pk_fma_f32 v[110:111], v[170:171], s[40:41], v[100:101] op_sel:[0,1,1] op_sel_hi:[1,1,1] neg_lo:[1,0,1] neg_hi:[1,0,1]
    v_pk_fma_f32 v[130:131], v[174:175], s[40:41], v[120:121] op_sel:[0,1,1] op_sel_hi:[1,1,1] neg_lo:[1,0,1] neg_hi:[1,0,1]
    v_exp_f32 v40, v40
    v_exp_f32 v60, v60
    v_exp_f32 v104, v104
    v_exp_f32 v124, v124
    v_exp_f32 v41, v41
    v_exp_f32 v61, v61
    v_exp_f32 v105, v105
    v_exp_f32 v125, v125
    v_exp_f32 v42, v42
    v_exp_f32 v62, v62
    v_exp_f32 v106, v106
    v_exp_f32 v126, v126
    v_exp_f32 v43, v43
    v_exp_f32 v63, v63
    v_exp_f32 v107, v107
    v_exp_f32 v127, v127
    v_exp_f32 v44, v44
    v_exp_f32 v64, v64
    v_exp_f32 v108, v108
    v_exp_f32 v128, v128
    v_exp_f32 v45, v45
    v_exp_f32 v65, v65
    v_exp_f32 v109, v109
    v_exp_f32 v129, v129
    v_exp_f32 v46, v46
    v_exp_f32 v66, v66
    v_exp_f32 v110, v110
    v_exp_f32 v130, v130
    v_exp_f32 v47, v47
    v_exp_f32 v67, v67
    v_exp_f32 v111, v111
    v_exp_f32 v131, v131
    v_pk_add_f32 v[36:37], v[40:41], v[42:43]
    v_pk_add_f32 v[56:57], v[60:61], v[62:63]
    v_pk_add_f32 v[100:101], v[104:105], v[106:107]
    v_pk_add_f32 v[120:121], v[124:125], v[126:127]
    v_pk_add_f32 v[38:39], v[44:45], v[46:47]
    v_pk_add_f32 v[58:59], v[64:65], v[66:67]
    v_pk_add_f32 v[102:103], v[108:109], v[110:111]
    v_pk_add_f32 v[122:123], v[128:129], v[130:131]
    v_add_f32 v36, v36, v37
    v_add_f32 v56, v56, v57
    v_add_f32 v100, v100, v101
    v_add_f32 v120, v120, v121
    v_add_f32 v37, v38, v39
    v_add_f32 v57, v58, v59
    v_add_f32 v101, v102, v103
    v_add_f32 v121, v122, v123
    v_permlane32_swap_b32 v36, v37
    v_permlane32_swap_b32 v56, v57
    v_permlane32_swap_b32 v100, v101
    v_permlane32_swap_b32 v120, v121
    v_add_f32 v36, v36, v37
    v_add_f32 v56, v56, v57
    v_add_f32 v100, v100, v101
    v_add_f32 v120, v120, v121
    s_nop 0
    v_permlane16_swap_b32 v36, v100
    v_permlane16_swap_b32 v56, v120
    v_add_f32 v36, v36, v100
    v_add_f32 v56, v56, v120
    v_rcp_f32 v36, v36
    v_rcp_f32 v56, v56
    s_nop 0
    s_nop 0
    v_mov_b32 v100, v36
    v_mov_b32 v120, v56
    s_nop 0
    v_permlane16_swap_b32 v36, v100
    v_permlane16_swap_b32 v56, v120
    v_mov_b32 v37, v36
    v_mov_b32 v57, v56
    v_mov_b32 v101, v100
    v_mov_b32 v121, v120
    v_permlane32_swap_b32 v36, v37
    v_permlane32_swap_b32 v56, v57
    v_permlane32_swap_b32 v100, v101
    v_permlane32_swap_b32 v120, v121
    v_pk_mul_f32 v[40:41], v[40:41], v[36:37] op_sel_hi:[1,0]
    v_pk_mul_f32 v[60:61], v[60:61], v[56:57] op_sel_hi:[1,0]
    v_pk_mul_f32 v[44:45], v[44:45], v[36:37] op_sel:[0,1] op_sel_hi:[1,1]
    v_pk_mul_f32 v[64:65], v[64:65], v[56:57] op_sel:[0,1] op_sel_hi:[1,1]
    v_pk_mul_f32 v[42:43], v[42:43], v[36:37] op_sel_hi:[1,0]
    v_pk_mul_f32 v[62:63], v[62:63], v[56:57] op_sel_hi:[1,0]
    v_pk_mul_f32 v[46:47], v[46:47], v[36:37] op_sel:[0,1] op_sel_hi:[1,1]
    v_pk_mul_f32 v[66:67], v[66:67], v[56:57] op_sel:[0,1] op_sel_hi:[1,1]
    v_pk_mul_f32 v[104:105], v[104:105], v[100:101] op_sel_hi:[1,0]
    v_pk_mul_f32 v[124:125], v[124:125], v[120:121] op_sel_hi:[1,0]
    v_pk_mul_f32 v[108:109], v[108:109], v[100:101] op_sel:[0,1] op_sel_hi:[1,1]
    v_pk_mul_f32 v[128:129], v[128:129], v[120:121] op_sel:[0,1] op_sel_hi:[1,1]
    v_pk_mul_f32 v[106:107], v[106:107], v[100:101] op_sel_hi:[1,0]
    v_pk_mul_f32 v[126:127], v[126:127], v[120:121] op_sel_hi:[1,0]
    v_pk_mul_f32 v[110:111], v[110:111], v[100:101] op_sel:[0,1] op_sel_hi:[1,1]
    v_pk_mul_f32 v[130:131], v[130:131], v[120:121] op_sel:[0,1] op_sel_hi:[1,1]
    v_cvt_pk_bf16_f32 v208, v40, v41
    v_cvt_pk_bf16_f32 v216, v60, v61
    v_cvt_pk_bf16_f32 v209, v42, v43
    v_cvt_pk_bf16_f32 v217, v62, v63
    v_cvt_pk_bf16_f32 v210, v44, v45
    v_cvt_pk_bf16_f32 v218, v64, v65
    v_cvt_pk_bf16_f32 v211, v46, v47
    v_cvt_pk_bf16_f32 v219, v66, v67
    v_cvt_pk_bf16_f32 v212, v104, v105
    v_cvt_pk_bf16_f32 v220, v124, v125
    v_cvt_pk_bf16_f32 v213, v106, v107
    v_cvt_pk_bf16_f32 v221, v126, v127
    v_cvt_pk_bf16_f32 v214, v108, v109
    v_cvt_pk_bf16_f32 v222, v128, v129
    v_cvt_pk_bf16_f32 v215, v110, v111
    v_cvt_pk_bf16_f32 v223, v130, v131
    s_lshr_b32 s37, s32, 1
    s_lshl_b32 s37, s37, 11
    s_and_b32 s38, s32, 1
    s_lshl_b32 s38, s38, 3
    s_add_u32 s37, s37, s38
    s_add_u32 s37, s37, 0x10000
    v_add_u32 v176, s37, v5
    v_add_u32 v177, 0x10000, v5
    v_lshl_add_u32 v178, v4, 6, v28
    s_lshl_b32 s37, s39, 9
    s_lshl_b32 s38, s39, 6
    s_add_u32 s38, s38, 0x100000
    s_mov_b32 s43, 0x3f80
    s_mov_b32 s44, 0x3f800000
    s_lshl_b32 s47, s46, 10
    s_lshl_b32 s39, s36, 10
    s_add_u32 s47, s47, s39
    s_cmp_lg_u32 s62, 0
    s_cbranch_scc1 L_ny_main_kernel
    s_barrier
L_ny_main_kernel:
    s_add_u32 s5, s37, 4096
    buffer_load_dwordx4 v[96:99], v178, s[24:27], s38 offen sc1
    buffer_load_dwordx2 v[128:129], v15, s[24:27], s37 offen offset:0 sc1
    buffer_load_dwordx2 v[130:131], v15, s[24:27], s37 offen offset:512 sc1
    buffer_load_dwordx2 v[132:133], v15, s[24:27], s37 offen offset:1024 sc1
    buffer_load_dwordx2 v[134:135], v15, s[24:27], s37 offen offset:1536 sc1
    buffer_load_dwordx2 v[136:137], v15, s[24:27], s37 offen offset:2048 sc1
    buffer_load_dwordx2 v[138:139], v15, s[24:27], s37 offen offset:2560 sc1
    buffer_load_dwordx2 v[140:141], v15, s[24:27], s37 offen offset:3072 sc1
    buffer_load_dwordx2 v[142:143], v15, s[24:27], s37 offen offset:3584 sc1
    buffer_load_dwordx2 v[144:145], v15, s[24:27], s5 offen offset:0 sc1
    buffer_load_dwordx2 v[146:147], v15, s[24:27], s5 offen offset:512 sc1
    buffer_load_dwordx2 v[148:149], v15, s[24:27], s5 offen offset:1024 sc1
    buffer_load_dwordx2 v[150:151], v15, s[24:27], s5 offen offset:1536 sc1
    buffer_load_dwordx2 v[152:153], v15, s[24:27], s5 offen offset:2048 sc1
    buffer_load_dwordx2 v[154:155], v15, s[24:27], s5 offen offset:2560 sc1
    buffer_load_dwordx2 v[156:157], v15, s[24:27], s5 offen offset:3072 sc1
    buffer_load_dwordx2 v[158:159], v15, s[24:27], s5 offen offset:3584 sc1
    s_waitcnt vmcnt(16)
    v_cmp_eq_u32 vcc, -1, v99
    s_cbranch_vccnz L_zr_main_kernel
L_zo_main_kernel:
    v_add_f32_dpp v96, v96, v96 row_ror:8 row_mask:0xf bank_mask:0xf
    v_add_f32_dpp v97, v97, v97 row_ror:8 row_mask:0xf bank_mask:0xf
    v_add_f32_dpp v98, v98, v98 row_ror:8 row_mask:0xf bank_mask:0xf
    v_add_f32_dpp v99, v99, v99 row_ror:8 row_mask:0xf bank_mask:0xf
    v_add_f32_dpp v96, v96, v96 row_ror:4 row_mask:0xf bank_mask:0xf
    v_add_f32_dpp v97, v97, v97 row_ror:4 row_mask:0xf bank_mask:0xf
    v_add_f32_dpp v98, v98, v98 row_ror:4 row_mask:0xf bank_mask:0xf
    v_add_f32_dpp v99, v99, v99 row_ror:4 row_mask:0xf bank_mask:0xf
    v_add_f32_dpp v96, v96, v96 row_ror:2 row_mask:0xf bank_mask:0xf
    v_add_f32_dpp v97, v97, v97 row_ror:2 row_mask:0xf bank_mask:0xf
    v_add_f32_dpp v98, v98, v98 row_ror:2 row_mask:0xf bank_mask:0xf
    v_add_f32_dpp v99, v99, v99 row_ror:2 row_mask:0xf bank_mask:0xf
    v_add_f32_dpp v96, v96, v96 row_ror:1 row_mask:0xf bank_mask:0xf
    v_add_f32_dpp v97, v97, v97 row_ror:1 row_mask:0xf bank_mask:0xf
    v_add_f32_dpp v98, v98, v98 row_ror:1 row_mask:0xf bank_mask:0xf
    v_add_f32_dpp v99, v99, v99 row_ror:1 row_mask:0xf bank_mask:0xf
L_ks_main_kernel:
    s_waitcnt vmcnt(12)
    v_dot2_f32_bf16 v32, v128, s43, 0
    v_dot2_f32_bf16 v33, v128, s44, 0
    v_dot2_f32_bf16 v34, v129, s43, 0
    v_dot2_f32_bf16 v35, v129, s44, 0
    v_dot2_f32_bf16 v36, v130, s43, 0
    v_dot2_f32_bf16 v37, v130, s44, 0
    v_dot2_f32_bf16 v38, v131, s43, 0
    v_dot2_f32_bf16 v39, v131, s44, 0
    v_max_u32 v40, v128, v130
    v_dot2_f32_bf16 v32, v132, s43, v32
    v_dot2_f32_bf16 v33, v132, s44, v33
    v_dot2_f32_bf16 v34, v133, s43, v34
    v_dot2_f32_bf16 v35, v133, s44, v35
    v_dot2_f32_bf16 v36, v134, s43, v36
    v_dot2_f32_bf16 v37, v134, s44, v37
    v_dot2_f32_bf16 v38, v135, s43, v38
    v_dot2_f32_bf16 v39, v135, s44, v39
    v_max3_u32 v40, v40, v132, v134
    s_waitcnt vmcnt(8)
    v_dot2_f32_bf16 v32, v136, s43, v32
    v_dot2_f32_bf16 v33, v136, s44, v33
    v_dot2_f32_bf16 v34, v137, s43, v34
    v_dot2_f32_bf16 v35, v137, s44, v35
    v_dot2_f32_bf16 v36, v138, s43, v36
    v_dot2_f32_bf16 v37, v138, s44, v37
    v_dot2_f32_bf16 v38, v139, s43, v38
    v_dot2_f32_bf16 v39, v139, s44, v39
    v_max3_u32 v40, v40, v136, v138
    v_dot2_f32_bf16 v32, v140, s43, v32
    v_dot2_f32_bf16 v33, v140, s44, v33
    v_dot2_f32_bf16 v34, v141, s43, v34
    v_dot2_f32_bf16 v35, v141, s44, v35
    v_dot2_f32_bf16 v36, v142, s43, v36
    v_dot2_f32_bf16 v37, v142, s44, v37
    v_dot2_f32_bf16 v38, v143, s43, v38
    v_dot2_f32_bf16 v39, v143, s44, v39
    v_max3_u32 v40, v40, v140, v142
    s_waitcnt vmcnt(4)
    v_dot2_f32_bf16 v32, v144, s43, v32
    v_dot2_f32_bf16 v33, v144, s44, v33
    v_dot2_f32_bf16 v34, v145, s43, v34
    v_dot2_f32_bf16 v35, v145, s44, v35
    v_dot2_f32_bf16 v36, v146, s43, v36
    v_dot2_f32_bf16 v37, v146, s44, v37
    v_dot2_f32_bf16 v38, v147, s43, v38
    v_dot2_f32_bf16 v39, v147, s44, v39
    v_max3_u32 v40, v40, v144, v146
    v_dot2_f32_bf16 v32, v148, s43, v32
    v_dot2_f32_bf16 v33, v148, s44, v33
    v_dot2_f32_bf16 v34, v149, s43, v34
    v_dot2_f32_bf16 v35, v149, s44, v35
    v_dot2_f32_bf16 v36, v150, s43, v36
    v_dot2_f32_bf16 v37, v150, s44, v37
    v_dot2_f32_bf16 v38, v151, s43, v38
    v_dot2_f32_bf16 v39, v151, s44, v39
    v_max3_u32 v40, v40, v148, v150
    s_waitcnt vmcnt(0)
    v_dot2_f32_bf16 v32, v152, s43, v32
    v_dot2_f32_bf16 v33, v152, s44, v33
    v_dot2_f32_bf16 v34, v153, s43, v34
    v_dot2_f32_bf16 v35, v153, s44, v35
    v_dot2_f32_bf16 v36, v154, s43, v36
    v_dot2_f32_bf16 v37, v154, s44, v37
    v_dot2_f32_bf16 v38, v155, s43, v38
    v_dot2_f32_bf16 v39, v155, s44, v39
    v_max3_u32 v40, v40, v152, v154
    v_dot2_f32_bf16 v32, v156, s43, v32
    v_dot2_f32_bf16 v33, v156, s44, v33
    v_dot2_f32_bf16 v34, v157, s43, v34
    v_dot2_f32_bf16 v35, v157, s44, v35
    v_dot2_f32_bf16 v36, v158, s43, v36
    v_dot2_f32_bf16 v37, v158, s44, v37
    v_dot2_f32_bf16 v38, v159, s43, v38
    v_dot2_f32_bf16 v39, v159, s44, v39
    v_max3_u32 v40, v40, v156, v158
    v_cmp_eq_u32 vcc, -1, v40
    s_cbranch_vccnz L_kr_main_kernel
L_ko_main_kernel:
    v_pk_add_f32 v[32:33], v[32:33], v[36:37]
    v_pk_add_f32 v[34:35], v[34:35], v[38:39]
    v_cvt_pk_bf16_f32 v36, v32, v33
    v_cvt_pk_bf16_f32 v37, v34, v35
    v_cvt_pk_bf16_f32 v100, v96, v97
    v_cvt_pk_bf16_f32 v101, v98, v99
    ds_write_b64 v176, v[36:37]
    ds_write_b64 v176, v[100:101] offset:1024
    s_waitcnt lgkmcnt(0)
    s_barrier
    ds_read_b128 v[40:43], v177 offset:0
    ds_read_b128 v[48:51], v177 offset:1024
    ds_read_b128 v[44:47], v177 offset:2048
    ds_read_b128 v[52:55], v177 offset:3072
    s_waitcnt lgkmcnt(0)
    v_mfma_f32_16x16x32_bf16 v[112:115], v[48:51], v[208:211], 0
    v_mfma_f32_16x16x32_bf16 v[116:119], v[52:55], v[212:215], 0
    v_mfma_f32_16x16x32_bf16 v[120:123], v[48:51], v[216:219], 0
    v_mfma_f32_16x16x32_bf16 v[124:127], v[52:55], v[220:223], 0
    v_mfma_f32_16x16x32_bf16 v[96:99], v[40:43], v[208:211], 0
    v_mfma_f32_16x16x32_bf16 v[100:103], v[44:47], v[212:215], 0
    v_mfma_f32_16x16x32_bf16 v[104:107], v[40:43], v[216:219], 0
    v_mfma_f32_16x16x32_bf16 v[108:111], v[44:47], v[220:223], 0
    s_nop 0
    v_add_f32 v112, s42, v112
    v_add_f32 v116, s42, v116
    v_add_f32 v120, s42, v120
    v_add_f32 v124, s42, v124
    v_rcp_f32 v112, v112
    v_rcp_f32 v116, v116
    v_rcp_f32 v120, v120
    v_rcp_f32 v124, v124
    v_pk_mul_f32 v[96:97], v[96:97], v[112:113] op_sel_hi:[1,0]
    v_pk_mul_f32 v[98:99], v[98:99], v[112:113] op_sel_hi:[1,0]
    v_pk_mul_f32 v[100:101], v[100:101], v[116:117] op_sel_hi:[1,0]
    v_pk_mul_f32 v[102:103], v[102:103], v[116:117] op_sel_hi:[1,0]
    v_pk_mul_f32 v[104:105], v[104:105], v[120:121] op_sel_hi:[1,0]
    v_pk_mul_f32 v[106:107], v[106:107], v[120:121] op_sel_hi:[1,0]
    v_pk_mul_f32 v[108:109], v[108:109], v[124:125] op_sel_hi:[1,0]
    v_pk_mul_f32 v[110:111], v[110:111], v[124:125] op_sel_hi:[1,0]
    v_cvt_pk_bf16_f32 v128, v96, v97
    v_cvt_pk_bf16_f32 v129, v98, v99
    v_cvt_pk_bf16_f32 v130, v100, v101
    v_cvt_pk_bf16_f32 v131, v102, v103
    v_cvt_pk_bf16_f32 v132, v104, v105
    v_cvt_pk_bf16_f32 v133, v106, v107
    v_cvt_pk_bf16_f32 v134, v108, v109
    v_cvt_pk_bf16_f32 v135, v110, v111
    s_add_u32 s39, s47, 0x4000
    buffer_store_dwordx4 v[128:131], v5, s[16:19], s47 offen
    buffer_store_dwordx4 v[132:135], v5, s[16:19], s39 offen
    s_mov_b32 s46, s92
    s_mul_i32 s45, s46, 1024
    s_lshl_b32 s47, s46, 10
    s_lshl_b32 s37, s34, 11
    s_add_u32 s47, s47, s37
    v_and_b32 v14, 3, v2
    v_lshrrev_b32 v13, 2, v2
    v_and_b32 v13, 3, v13
    v_lshlrev_b32 v13, 6, v13
    v_lshl_add_u32 v13, v14, 3, v13
    v_lshl_add_u32 v13, v3, 8, v13
    v_add_u32 v13, 0x10000, v13
    v_and_b32 v14, 1, v3
    v_lshl_add_u32 v11, v14, 5, v13
    v_xor_b32 v14, 1, v14
    v_lshl_add_u32 v12, v14, 5, v13
    v_add_u32 v14, 0x10000, v11
    v_add_u32 v13, 0x10000, v12
    v_and_b32 v105, 1, v3
    v_lshlrev_b32 v104, 10, v4
    v_lshl_add_u32 v104, v105, 5, v104
    v_lshrrev_b32 v105, 1, v3
    v_lshl_add_u32 v104, v105, 4, v104
    s_lshl_b32 s38, s46, 10
    s_lshl_b32 s37, s34, 7
    s_add_u32 s38, s38, s37
    s_add_u32 s8, s60, 0x400000
    s_addc_u32 s9, s61, 0
    s_mov_b32 s10, 0x200000
    s_mov_b32 s11, 0x00020000
    s_add_u32 s20, s60, 0x0
    s_addc_u32 s21, s61, 0
    s_cmp_eq_u32 s62, 0
    s_cselect_b32 s20, s64, s20
    s_cselect_b32 s21, s65, s21
    s_mov_b32 s22, 0x200000
    s_mov_b32 s23, 0x00020000
    s_cselect_b64 vcc, -1, 0
    s_cselect_b32 s38, s38, s47
    s_add_u32 s39, s38, s97
    v_cndmask_b32 v104, v8, v104, vcc
    s_add_u32 s16, s60, 0x200000
    s_addc_u32 s17, s61, 0
    s_mov_b32 s18, 0x200000
    s_mov_b32 s19, 0x00020000
    s_add_u32 s52, s60, 0x1220000
    s_addc_u32 s53, s61, 0
    s_mov_b32 s54, 0x20000
    s_mov_b32 s55, 0x00020000
    buffer_load_dwordx4 v[96:99], v104, s[20:23], s38 offen
    buffer_load_dwordx4 v[100:103], v104, s[20:23], s39 offen
    ds_read_b64_tr_b16 v[108:109], v11 offset:32768
    ds_read_b64_tr_b16 v[110:111], v11 offset:33792
    ds_read_b64_tr_b16 v[112:113], v12 offset:32768
    ds_read_b64_tr_b16 v[114:115], v12 offset:33792
    ds_read_b64_tr_b16 v[116:117], v14 offset:0
    ds_read_b64_tr_b16 v[118:119], v14 offset:1024
    ds_read_b64_tr_b16 v[120:121], v13 offset:0
    ds_read_b64_tr_b16 v[122:123], v13 offset:1024
    ds_read_b64_tr_b16 v[124:125], v11 offset:34816
    ds_read_b64_tr_b16 v[126:127], v11 offset:35840
    ds_read_b64_tr_b16 v[128:129], v12 offset:34816
    ds_read_b64_tr_b16 v[130:131], v12 offset:35840
    ds_read_b64_tr_b16 v[132:133], v14 offset:2048
    ds_read_b64_tr_b16 v[134:135], v14 offset:3072
    ds_read_b64_tr_b16 v[136:137], v13 offset:2048
    ds_read_b64_tr_b16 v[138:139], v13 offset:3072
    ds_read_b64_tr_b16 v[140:141], v11 offset:36864
    ds_read_b64_tr_b16 v[142:143], v11 offset:37888
    ds_read_b64_tr_b16 v[144:145], v12 offset:36864
    ds_read_b64_tr_b16 v[146:147], v12 offset:37888
    ds_read_b64_tr_b16 v[148:149], v14 offset:4096
    ds_read_b64_tr_b16 v[150:151], v14 offset:5120
    ds_read_b64_tr_b16 v[152:153], v13 offset:4096
    ds_read_b64_tr_b16 v[154:155], v13 offset:5120
    ds_read_b64_tr_b16 v[156:157], v11 offset:38912
    ds_read_b64_tr_b16 v[158:159], v11 offset:39936
    ds_read_b64_tr_b16 v[160:161], v12 offset:38912
    ds_read_b64_tr_b16 v[162:163], v12 offset:39936
    ds_read_b64_tr_b16 v[164:165], v14 offset:6144
    ds_read_b64_tr_b16 v[166:167], v14 offset:7168
    ds_read_b64_tr_b16 v[168:169], v13 offset:6144
    ds_read_b64_tr_b16 v[170:171], v13 offset:7168
    ds_read_b64_tr_b16 v[172:173], v11 offset:40960
    ds_read_b64_tr_b16 v[174:175], v11 offset:41984
    ds_read_b64_tr_b16 v[176:177], v12 offset:40960
    ds_read_b64_tr_b16 v[178:179], v12 offset:41984
    ds_read_b64_tr_b16 v[180:181], v14 offset:8192
    ds_read_b64_tr_b16 v[182:183], v14 offset:9216
    ds_read_b64_tr_b16 v[184:185], v13 offset:8192
    ds_read_b64_tr_b16 v[186:187], v13 offset:9216
    ds_read_b64_tr_b16 v[188:189], v11 offset:43008
    ds_read_b64_tr_b16 v[190:191], v11 offset:44032
    ds_read_b64_tr_b16 v[192:193], v12 offset:43008
    ds_read_b64_tr_b16 v[194:195], v12 offset:44032
    ds_read_b64_tr_b16 v[196:197], v14 offset:10240
    ds_read_b64_tr_b16 v[198:199], v14 offset:11264
    ds_read_b64_tr_b16 v[200:201], v13 offset:10240
    ds_read_b64_tr_b16 v[202:203], v13 offset:11264
    s_waitcnt vmcnt(0)
    v_permlane16_swap_b32 v96, v98
    v_permlane16_swap_b32 v97, v99
    v_permlane16_swap_b32 v100, v102
    v_permlane16_swap_b32 v101, v103
    v_lshlrev_b32 v80, 16, v96
    v_and_b32 v81, 0xffff0000, v96
    v_lshlrev_b32 v82, 16, v97
    v_and_b32 v83, 0xffff0000, v97
    v_lshlrev_b32 v84, 16, v98
    v_and_b32 v85, 0xffff0000, v98
    v_lshlrev_b32 v86, 16, v99
    v_and_b32 v87, 0xffff0000, v99
    v_lshlrev_b32 v88, 16, v100
    v_and_b32 v89, 0xffff0000, v100
    v_lshlrev_b32 v90, 16, v101
    v_and_b32 v91, 0xffff0000, v101
    v_lshlrev_b32 v92, 16, v102
    v_and_b32 v93, 0xffff0000, v102
    v_lshlrev_b32 v94, 16, v103
    v_and_b32 v95, 0xffff0000, v103
    v_lshlrev_b32 v104, 10, v2
    s_add_u32 s38, s45, 0x0
    buffer_load_dwordx4 v[16:19], v5, s[8:11], s38 offen offset:0 sc1
    buffer_load_dwordx4 v[20:23], v5, s[8:11], s38 offen offset:1024 sc1
    buffer_load_dwordx4 v[24:27], v5, s[8:11], s38 offen offset:2048 sc1
    buffer_load_dwordx4 v[28:31], v5, s[8:11], s38 offen offset:3072 sc1
    s_add_u32 s38, s45, 0x1000
    buffer_load_dwordx4 v[32:35], v5, s[8:11], s38 offen offset:0 sc1
    buffer_load_dwordx4 v[36:39], v5, s[8:11], s38 offen offset:1024 sc1
    buffer_load_dwordx4 v[40:43], v5, s[8:11], s38 offen offset:2048 sc1
    buffer_load_dwordx4 v[44:47], v5, s[8:11], s38 offen offset:3072 sc1
    s_add_u32 s38, s45, 0x2000
    buffer_load_dwordx4 v[48:51], v5, s[8:11], s38 offen offset:0 sc1
    buffer_load_dwordx4 v[52:55], v5, s[8:11], s38 offen offset:1024 sc1
    buffer_load_dwordx4 v[56:59], v5, s[8:11], s38 offen offset:2048 sc1
    buffer_load_dwordx4 v[60:63], v5, s[8:11], s38 offen offset:3072 sc1
    s_waitcnt vmcnt(11)
    v_cmp_eq_u32 vcc, -1, v19
    s_cbranch_vccnz L_rt11_main_kernel
L_ok11_main_kernel:
    s_waitcnt lgkmcnt(15)
    v_mfma_f32_16x16x32_bf16 v[80:83], v[108:111], v[16:19], v[80:83]
    s_add_u32 s38, s45, 0x3000
    buffer_load_dwordx4 v[64:67], v5, s[8:11], s38 offen offset:0 sc1
    ds_read_b64_tr_b16 v[108:109], v11 offset:45056
    ds_read_b64_tr_b16 v[110:111], v11 offset:46080
    v_mfma_f32_16x16x32_bf16 v[84:87], v[112:115], v[16:19], v[84:87]
    s_waitcnt vmcnt(9)
    v_max3_u32 v7, v23, v27, v31
    v_cmp_eq_u32 vcc, -1, v7
    ds_read_b64_tr_b16 v[112:113], v12 offset:45056
    ds_read_b64_tr_b16 v[114:115], v12 offset:46080
    v_mfma_f32_16x16x32_bf16 v[88:91], v[116:119], v[16:19], v[88:91]
    s_cbranch_vccnz L_rt12_main_kernel
L_ok12_main_kernel:
    ds_read_b64_tr_b16 v[116:117], v14 offset:12288
    ds_read_b64_tr_b16 v[118:119], v14 offset:13312
    v_mfma_f32_16x16x32_bf16 v[92:95], v[120:123], v[16:19], v[92:95]
    ds_read_b64_tr_b16 v[120:121], v13 offset:12288
    ds_read_b64_tr_b16 v[122:123], v13 offset:13312
    s_waitcnt lgkmcnt(15)
    v_mfma_f32_16x16x32_bf16 v[80:83], v[124:127], v[20:23], v[80:83]
    buffer_load_dwordx4 v[68:71], v5, s[8:11], s38 offen offset:1024 sc1
    ds_read_b64_tr_b16 v[124:125], v11 offset:47104
    ds_read_b64_tr_b16 v[126:127], v11 offset:48128
    v_mfma_f32_16x16x32_bf16 v[84:87], v[128:131], v[20:23], v[84:87]
    ds_read_b64_tr_b16 v[128:129], v12 offset:47104
    ds_read_b64_tr_b16 v[130:131], v12 offset:48128
    v_mfma_f32_16x16x32_bf16 v[88:91], v[132:135], v[20:23], v[88:91]
    ds_read_b64_tr_b16 v[132:133], v14 offset:14336
    ds_read_b64_tr_b16 v[134:135], v14 offset:15360
    v_mfma_f32_16x16x32_bf16 v[92:95], v[136:139], v[20:23], v[92:95]
    ds_read_b64_tr_b16 v[136:137], v13 offset:14336
    ds_read_b64_tr_b16 v[138:139], v13 offset:15360
    s_waitcnt lgkmcnt(15)
    v_mfma_f32_16x16x32_bf16 v[80:83], v[140:143], v[24:27], v[80:83]
    buffer_load_dwordx4 v[72:75], v5, s[8:11], s38 offen offset:2048 sc1
    ds_read_b64_tr_b16 v[140:141], v11 offset:49152
    ds_read_b64_tr_b16 v[142:143], v11 offset:50176
    v_mfma_f32_16x16x32_bf16 v[84:87], v[144:147], v[24:27], v[84:87]
    ds_read_b64_tr_b16 v[144:145], v12 offset:49152
    ds_read_b64_tr_b16 v[146:147], v12 offset:50176
    v_mfma_f32_16x16x32_bf16 v[88:91], v[148:151], v[24:27], v[88:91]
    ds_read_b64_tr_b16 v[148:149], v14 offset:16384
    ds_read_b64_tr_b16 v[150:151], v14 offset:17408
    v_mfma_f32_16x16x32_bf16 v[92:95], v[152:155], v[24:27], v[92:95]
    ds_read_b64_tr_b16 v[152:153], v13 offset:16384
    ds_read_b64_tr_b16 v[154:155], v13 offset:17408
    s_waitcnt lgkmcnt(15)
    v_mfma_f32_16x16x32_bf16 v[80:83], v[156:159], v[28:31], v[80:83]
    buffer_load_dwordx4 v[76:79], v5, s[8:11], s38 offen offset:3072 sc1
    ds_read_b64_tr_b16 v[156:157], v11 offset:51200
    ds_read_b64_tr_b16 v[158:159], v11 offset:52224
    v_mfma_f32_16x16x32_bf16 v[84:87], v[160:163], v[28:31], v[84:87]
    s_waitcnt vmcnt(9)
    v_max3_u32 v7, v35, v39, v43
    v_cmp_eq_u32 vcc, -1, v7
    ds_read_b64_tr_b16 v[160:161], v12 offset:51200
    ds_read_b64_tr_b16 v[162:163], v12 offset:52224
    v_mfma_f32_16x16x32_bf16 v[88:91], v[164:167], v[28:31], v[88:91]
    s_cbranch_vccnz L_rt13_main_kernel
L_ok13_main_kernel:
    ds_read_b64_tr_b16 v[164:165], v14 offset:18432
    ds_read_b64_tr_b16 v[166:167], v14 offset:19456
    v_mfma_f32_16x16x32_bf16 v[92:95], v[168:171], v[28:31], v[92:95]
    ds_read_b64_tr_b16 v[168:169], v13 offset:18432
    ds_read_b64_tr_b16 v[170:171], v13 offset:19456
    s_waitcnt lgkmcnt(15)
    v_mfma_f32_16x16x32_bf16 v[80:83], v[172:175], v[32:35], v[80:83]
    ds_read_b64_tr_b16 v[172:173], v11 offset:53248
    ds_read_b64_tr_b16 v[174:175], v11 offset:54272
    v_mfma_f32_16x16x32_bf16 v[84:87], v[176:179], v[32:35], v[84:87]
    ds_read_b64_tr_b16 v[176:177], v12 offset:53248
    ds_read_b64_tr_b16 v[178:179], v12 offset:54272
    v_mfma_f32_16x16x32_bf16 v[88:91], v[180:183], v[32:35], v[88:91]
    ds_read_b64_tr_b16 v[180:181], v14 offset:20480
    ds_read_b64_tr_b16 v[182:183], v14 offset:21504
    v_mfma_f32_16x16x32_bf16 v[92:95], v[184:187], v[32:35], v[92:95]
    ds_read_b64_tr_b16 v[184:185], v13 offset:20480
    ds_read_b64_tr_b16 v[186:187], v13 offset:21504
    s_barrier
    s_waitcnt lgkmcnt(15)
    v_mfma_f32_16x16x32_bf16 v[80:83], v[188:191], v[36:39], v[80:83]
    ds_read_b64_tr_b16 v[188:189], v11 offset:55296
    ds_read_b64_tr_b16 v[190:191], v11 offset:56320
    v_mfma_f32_16x16x32_bf16 v[84:87], v[192:195], v[36:39], v[84:87]
    ds_read_b64_tr_b16 v[192:193], v12 offset:55296
    ds_read_b64_tr_b16 v[194:195], v12 offset:56320
    v_mfma_f32_16x16x32_bf16 v[88:91], v[196:199], v[36:39], v[88:91]
    ds_read_b64_tr_b16 v[196:197], v14 offset:22528
    ds_read_b64_tr_b16 v[198:199], v14 offset:23552
    v_mfma_f32_16x16x32_bf16 v[92:95], v[200:203], v[36:39], v[92:95]
    ds_read_b64_tr_b16 v[200:201], v13 offset:22528
    ds_read_b64_tr_b16 v[202:203], v13 offset:23552
    s_waitcnt lgkmcnt(15)
    v_mfma_f32_16x16x32_bf16 v[80:83], v[108:111], v[40:43], v[80:83]
    ds_read_b64_tr_b16 v[108:109], v11 offset:57344
    ds_read_b64_tr_b16 v[110:111], v11 offset:58368
    v_mfma_f32_16x16x32_bf16 v[84:87], v[112:115], v[40:43], v[84:87]
    s_waitcnt vmcnt(6)
    v_max3_u32 v7, v47, v51, v55
    v_cmp_eq_u32 vcc, -1, v7
    ds_read_b64_tr_b16 v[112:113], v12 offset:57344
    ds_read_b64_tr_b16 v[114:115], v12 offset:58368
    v_mfma_f32_16x16x32_bf16 v[88:91], v[116:119], v[40:43], v[88:91]
    s_cbranch_vccnz L_rt14_main_kernel
L_ok14_main_kernel:
    ds_read_b64_tr_b16 v[116:117], v14 offset:24576
    ds_read_b64_tr_b16 v[118:119], v14 offset:25600
    v_mfma_f32_16x16x32_bf16 v[92:95], v[120:123], v[40:43], v[92:95]
    ds_read_b64_tr_b16 v[120:121], v13 offset:24576
    ds_read_b64_tr_b16 v[122:123], v13 offset:25600
    s_waitcnt lgkmcnt(15)
    v_mfma_f32_16x16x32_bf16 v[80:83], v[124:127], v[44:47], v[80:83]
    ds_read_b64_tr_b16 v[124:125], v11 offset:59392
    ds_read_b64_tr_b16 v[126:127], v11 offset:60416
    v_mfma_f32_16x16x32_bf16 v[84:87], v[128:131], v[44:47], v[84:87]
    ds_read_b64_tr_b16 v[128:129], v12 offset:59392
    ds_read_b64_tr_b16 v[130:131], v12 offset:60416
    v_mfma_f32_16x16x32_bf16 v[88:91], v[132:135], v[44:47], v[88:91]
    ds_read_b64_tr_b16 v[132:133], v14 offset:26624
    ds_read_b64_tr_b16 v[134:135], v14 offset:27648
    v_mfma_f32_16x16x32_bf16 v[92:95], v[136:139], v[44:47], v[92:95]
    ds_read_b64_tr_b16 v[136:137], v13 offset:26624
    ds_read_b64_tr_b16 v[138:139], v13 offset:27648
    s_waitcnt lgkmcnt(15)
    v_mfma_f32_16x16x32_bf16 v[80:83], v[140:143], v[48:51], v[80:83]
    ds_read_b64_tr_b16 v[140:141], v11 offset:61440
    ds_read_b64_tr_b16 v[142:143], v11 offset:62464
    v_mfma_f32_16x16x32_bf16 v[84:87], v[144:147], v[48:51], v[84:87]
    ds_read_b64_tr_b16 v[144:145], v12 offset:61440
    ds_read_b64_tr_b16 v[146:147], v12 offset:62464
    v_mfma_f32_16x16x32_bf16 v[88:91], v[148:151], v[48:51], v[88:91]
    ds_read_b64_tr_b16 v[148:149], v14 offset:28672
    ds_read_b64_tr_b16 v[150:151], v14 offset:29696
    v_mfma_f32_16x16x32_bf16 v[92:95], v[152:155], v[48:51], v[92:95]
    ds_read_b64_tr_b16 v[152:153], v13 offset:28672
    ds_read_b64_tr_b16 v[154:155], v13 offset:29696
    s_waitcnt lgkmcnt(15)
    v_mfma_f32_16x16x32_bf16 v[80:83], v[156:159], v[52:55], v[80:83]
    ds_read_b64_tr_b16 v[156:157], v11 offset:63488
    ds_read_b64_tr_b16 v[158:159], v11 offset:64512
    v_mfma_f32_16x16x32_bf16 v[84:87], v[160:163], v[52:55], v[84:87]
    s_waitcnt vmcnt(3)
    v_max3_u32 v7, v59, v63, v67
    v_cmp_eq_u32 vcc, -1, v7
    ds_read_b64_tr_b16 v[160:161], v12 offset:63488
    ds_read_b64_tr_b16 v[162:163], v12 offset:64512
    v_mfma_f32_16x16x32_bf16 v[88:91], v[164:167], v[52:55], v[88:91]
    s_cbranch_vccnz L_rt15_main_kernel
L_ok15_main_kernel:
    ds_read_b64_tr_b16 v[164:165], v14 offset:30720
    ds_read_b64_tr_b16 v[166:167], v14 offset:31744
    v_mfma_f32_16x16x32_bf16 v[92:95], v[168:171], v[52:55], v[92:95]
    ds_read_b64_tr_b16 v[168:169], v13 offset:30720
    ds_read_b64_tr_b16 v[170:171], v13 offset:31744
    s_waitcnt lgkmcnt(15)
    v_mfma_f32_16x16x32_bf16 v[80:83], v[172:175], v[56:59], v[80:83]
    v_mfma_f32_16x16x32_bf16 v[84:87], v[176:179], v[56:59], v[84:87]
    v_mfma_f32_16x16x32_bf16 v[88:91], v[180:183], v[56:59], v[88:91]
    v_mfma_f32_16x16x32_bf16 v[92:95], v[184:187], v[56:59], v[92:95]
    s_waitcnt lgkmcnt(15)
    v_mfma_f32_16x16x32_bf16 v[80:83], v[188:191], v[60:63], v[80:83]
    v_mfma_f32_16x16x32_bf16 v[84:87], v[192:195], v[60:63], v[84:87]
    v_mfma_f32_16x16x32_bf16 v[88:91], v[196:199], v[60:63], v[88:91]
    v_mfma_f32_16x16x32_bf16 v[92:95], v[200:203], v[60:63], v[92:95]
    s_waitcnt lgkmcnt(15)
    v_mfma_f32_16x16x32_bf16 v[80:83], v[108:111], v[64:67], v[80:83]
    v_mfma_f32_16x16x32_bf16 v[84:87], v[112:115], v[64:67], v[84:87]
    s_waitcnt vmcnt(0)
    v_max3_u32 v7, v71, v75, v79
    v_cmp_eq_u32 vcc, -1, v7
    v_mfma_f32_16x16x32_bf16 v[88:91], v[116:119], v[64:67], v[88:91]
    s_cbranch_vccnz L_rt16_main_kernel
L_ok16_main_kernel:
    v_mfma_f32_16x16x32_bf16 v[92:95], v[120:123], v[64:67], v[92:95]
    s_waitcnt lgkmcnt(15)
    v_mfma_f32_16x16x32_bf16 v[80:83], v[124:127], v[68:71], v[80:83]
    v_mfma_f32_16x16x32_bf16 v[84:87], v[128:131], v[68:71], v[84:87]
    v_mfma_f32_16x16x32_bf16 v[88:91], v[132:135], v[68:71], v[88:91]
    v_mfma_f32_16x16x32_bf16 v[92:95], v[136:139], v[68:71], v[92:95]
    s_waitcnt lgkmcnt(8)
    v_mfma_f32_16x16x32_bf16 v[80:83], v[140:143], v[72:75], v[80:83]
    v_mfma_f32_16x16x32_bf16 v[84:87], v[144:147], v[72:75], v[84:87]
    v_mfma_f32_16x16x32_bf16 v[88:91], v[148:151], v[72:75], v[88:91]
    v_mfma_f32_16x16x32_bf16 v[92:95], v[152:155], v[72:75], v[92:95]
    s_waitcnt lgkmcnt(0)
    v_mfma_f32_16x16x32_bf16 v[80:83], v[156:159], v[76:79], v[80:83]
    v_mfma_f32_16x16x32_bf16 v[84:87], v[160:163], v[76:79], v[84:87]
    v_mfma_f32_16x16x32_bf16 v[88:91], v[164:167], v[76:79], v[88:91]
    v_mfma_f32_16x16x32_bf16 v[92:95], v[168:171], v[76:79], v[92:95]
    s_nop 4
    v_cvt_pk_bf16_f32 v48, v80, v81
    v_cvt_pk_bf16_f32 v49, v82, v83
    v_cvt_pk_bf16_f32 v50, v84, v85
    v_cvt_pk_bf16_f32 v51, v86, v87
    v_cvt_pk_bf16_f32 v52, v88, v89
    v_cvt_pk_bf16_f32 v53, v90, v91
    v_cvt_pk_bf16_f32 v54, v92, v93
    v_cvt_pk_bf16_f32 v55, v94, v95
    s_barrier
    v_permlane16_swap_b32 v48, v50
    v_permlane16_swap_b32 v49, v51
    v_permlane16_swap_b32 v52, v54
    v_permlane16_swap_b32 v53, v55
    buffer_store_dwordx4 v[48:51], v8, s[16:19], s47 offen offset:0
    buffer_store_dwordx4 v[52:55], v8, s[16:19], s47 offen offset:1024
    v_dot2_f32_bf16 v56, v48, s40, 0
    v_dot2_f32_bf16 v57, v48, v48, 0
    v_dot2_f32_bf16 v56, v49, s40, v56
    v_dot2_f32_bf16 v57, v49, v49, v57
    v_dot2_f32_bf16 v56, v50, s40, v56
    v_dot2_f32_bf16 v57, v50, v50, v57
    v_dot2_f32_bf16 v56, v51, s40, v56
    v_dot2_f32_bf16 v57, v51, v51, v57
    v_dot2_f32_bf16 v56, v52, s40, v56
    v_dot2_f32_bf16 v57, v52, v52, v57
    v_dot2_f32_bf16 v56, v53, s40, v56
    v_dot2_f32_bf16 v57, v53, v53, v57
    v_dot2_f32_bf16 v56, v54, s40, v56
    v_dot2_f32_bf16 v57, v54, v54, v57
    v_dot2_f32_bf16 v56, v55, s40, v56
    v_dot2_f32_bf16 v57, v55, v55, v57
    s_nop 1
    v_mov_b32 v58, v56
    v_mov_b32 v59, v57
    s_nop 0
    v_permlane32_swap_b32 v56, v58
    v_permlane32_swap_b32 v57, v59
    v_add_f32 v56, v56, v58
    v_add_f32 v57, v57, v59
    v_mov_b32 v58, v56
    v_mov_b32 v59, v57
    s_nop 0
    v_permlane16_swap_b32 v56, v58
    v_permlane16_swap_b32 v57, v59
    v_add_f32 v56, v56, v58
    v_add_f32 v57, v57, v59
    v_add_u32 v58, s46, v4
    v_lshlrev_b32 v58, 3, v58
    s_lshl_b32 s37, s34, 14
    s_mov_b64 exec, 0xffff
    buffer_store_dwordx2 v[56:57], v58, s[52:55], s37 offen
    s_mov_b64 exec, -1
    s_mul_i32 s45, s46, 1024
    v_and_b32 v14, 3, v2
    v_lshrrev_b32 v13, 2, v2
    v_and_b32 v13, 3, v13
    v_lshlrev_b32 v13, 6, v13
    v_lshl_add_u32 v13, v14, 3, v13
    v_lshl_add_u32 v13, v3, 9, v13
    v_and_b32 v14, 1, v3
    v_lshl_add_u32 v11, v14, 5, v13
    v_xor_b32 v14, 1, v14
    v_lshl_add_u32 v12, v14, 5, v13
    v_add_u32 v96, s46, v4
    v_lshlrev_b32 v96, 3, v96
    v_lshl_add_u32 v96, v3, 15, v96
    v_lshlrev_b32 v104, 4, v3
    v_add_u32 v104, 0x27800, v104
    s_add_u32 s8, s60, 0x200000
    s_addc_u32 s9, s61, 0
    s_mov_b32 s10, 0x200000
    s_mov_b32 s11, 0x00020000
    s_add_u32 s16, s60, 0x800000
    s_addc_u32 s17, s61, 0
    s_mov_b32 s18, 0x200000
    s_mov_b32 s19, 0x00020000
    s_add_u32 s48, s60, 0x1220000
    s_addc_u32 s49, s61, 0
    s_mov_b32 s50, 0x20000
    s_mov_b32 s51, 0x00020000
    ds_read_b64_tr_b16 v[124:125], v11 offset:0
    ds_read_b64_tr_b16 v[126:127], v11 offset:256
    ds_read_b64_tr_b16 v[128:129], v12 offset:0
    ds_read_b64_tr_b16 v[130:131], v12 offset:256
    ds_read_b64_tr_b16 v[132:133], v11 offset:32768
    ds_read_b64_tr_b16 v[134:135], v11 offset:33024
    ds_read_b64_tr_b16 v[136:137], v12 offset:32768
    ds_read_b64_tr_b16 v[138:139], v12 offset:33024
    ds_read_b64_tr_b16 v[140:141], v11 offset:2048
    ds_read_b64_tr_b16 v[142:143], v11 offset:2304
    ds_read_b64_tr_b16 v[144:145], v12 offset:2048
    ds_read_b64_tr_b16 v[146:147], v12 offset:2304
    ds_read_b64_tr_b16 v[148:149], v11 offset:34816
    ds_read_b64_tr_b16 v[150:151], v11 offset:35072
    ds_read_b64_tr_b16 v[152:153], v12 offset:34816
    ds_read_b64_tr_b16 v[154:155], v12 offset:35072
    ds_read_b64_tr_b16 v[156:157], v11 offset:4096
    ds_read_b64_tr_b16 v[158:159], v11 offset:4352
    ds_read_b64_tr_b16 v[160:161], v12 offset:4096
    ds_read_b64_tr_b16 v[162:163], v12 offset:4352
    ds_read_b64_tr_b16 v[164:165], v11 offset:36864
    ds_read_b64_tr_b16 v[166:167], v11 offset:37120
    ds_read_b64_tr_b16 v[168:169], v12 offset:36864
    ds_read_b64_tr_b16 v[170:171], v12 offset:37120
    ds_read_b64_tr_b16 v[172:173], v11 offset:6144
    ds_read_b64_tr_b16 v[174:175], v11 offset:6400
    ds_read_b64_tr_b16 v[176:177], v12 offset:6144
    ds_read_b64_tr_b16 v[178:179], v12 offset:6400
    ds_read_b64_tr_b16 v[180:181], v11 offset:38912
    ds_read_b64_tr_b16 v[182:183], v11 offset:39168
    ds_read_b64_tr_b16 v[184:185], v12 offset:38912
    ds_read_b64_tr_b16 v[186:187], v12 offset:39168
    ds_read_b64_tr_b16 v[188:189], v11 offset:8192
    ds_read_b64_tr_b16 v[190:191], v11 offset:8448
    ds_read_b64_tr_b16 v[192:193], v12 offset:8192
    ds_read_b64_tr_b16 v[194:195], v12 offset:8448
    ds_read_b64_tr_b16 v[196:197], v11 offset:40960
    ds_read_b64_tr_b16 v[198:199], v11 offset:41216
    ds_read_b64_tr_b16 v[200:201], v12 offset:40960
    ds_read_b64_tr_b16 v[202:203], v12 offset:41216
    ds_read_b64_tr_b16 v[204:205], v11 offset:10240
    ds_read_b64_tr_b16 v[206:207], v11 offset:10496
    ds_read_b64_tr_b16 v[208:209], v12 offset:10240
    ds_read_b64_tr_b16 v[210:211], v12 offset:10496
    ds_read_b64_tr_b16 v[212:213], v11 offset:43008
    ds_read_b64_tr_b16 v[214:215], v11 offset:43264
    ds_read_b64_tr_b16 v[216:217], v12 offset:43008
    ds_read_b64_tr_b16 v[218:219], v12 offset:43264
    buffer_load_dwordx2 v[100:101], v96, s[48:51], 0 offen offset:0 sc1
    buffer_load_dwordx2 v[102:103], v96, s[48:51], s96 offen offset:0 sc1
    s_add_u32 s38, s45, 0x0
    buffer_load_dwordx4 v[16:19], v5, s[8:11], s38 offen offset:0 sc1
    buffer_load_dwordx4 v[20:23], v5, s[8:11], s38 offen offset:1024 sc1
    buffer_load_dwordx4 v[24:27], v5, s[8:11], s38 offen offset:2048 sc1
    buffer_load_dwordx4 v[28:31], v5, s[8:11], s38 offen offset:3072 sc1
    s_add_u32 s38, s45, 0x1000
    buffer_load_dwordx4 v[32:35], v5, s[8:11], s38 offen offset:0 sc1
    buffer_load_dwordx4 v[36:39], v5, s[8:11], s38 offen offset:1024 sc1
    buffer_load_dwordx4 v[40:43], v5, s[8:11], s38 offen offset:2048 sc1
    buffer_load_dwordx4 v[44:47], v5, s[8:11], s38 offen offset:3072 sc1
    s_add_u32 s38, s45, 0x2000
    buffer_load_dwordx4 v[48:51], v5, s[8:11], s38 offen offset:0 sc1
    buffer_load_dwordx4 v[52:55], v5, s[8:11], s38 offen offset:1024 sc1
    buffer_load_dwordx4 v[56:59], v5, s[8:11], s38 offen offset:2048 sc1
    buffer_load_dwordx4 v[60:63], v5, s[8:11], s38 offen offset:3072 sc1
    s_waitcnt vmcnt(12)
    v_max_u32 v7, v101, v103
    v_cmp_eq_u32 vcc, -1, v7
    s_cbranch_vccnz L_pl17_main_kernel
L_go17_main_kernel:
    s_waitcnt vmcnt(11)
    v_cmp_eq_u32 vcc, -1, v19
    s_cbranch_vccnz L_rt18_main_kernel
L_ok18_main_kernel:
    s_waitcnt lgkmcnt(15)
    v_mfma_f32_16x16x32_bf16 v[80:83], v[124:127], v[16:19], 0
    s_add_u32 s38, s45, 0x3000
    buffer_load_dwordx4 v[64:67], v5, s[8:11], s38 offen offset:0 sc1
    ds_read_b64_tr_b16 v[124:125], v11 offset:12288
    ds_read_b64_tr_b16 v[126:127], v11 offset:12544
    v_mfma_f32_16x16x32_bf16 v[84:87], v[128:131], v[16:19], 0
    s_waitcnt vmcnt(9)
    v_max3_u32 v7, v23, v27, v31
    v_cmp_eq_u32 vcc, -1, v7
    ds_read_b64_tr_b16 v[128:129], v12 offset:12288
    ds_read_b64_tr_b16 v[130:131], v12 offset:12544
    v_mfma_f32_16x16x32_bf16 v[88:91], v[132:135], v[16:19], 0
    s_cbranch_vccnz L_rt19_main_kernel
L_ok19_main_kernel:
    ds_read_b64_tr_b16 v[132:133], v11 offset:45056
    ds_read_b64_tr_b16 v[134:135], v11 offset:45312
    v_mfma_f32_16x16x32_bf16 v[92:95], v[136:139], v[16:19], 0
    ds_read_b64_tr_b16 v[136:137], v12 offset:45056
    ds_read_b64_tr_b16 v[138:139], v12 offset:45312
    s_waitcnt lgkmcnt(15)
    v_mfma_f32_16x16x32_bf16 v[80:83], v[140:143], v[20:23], v[80:83]
    buffer_load_dwordx4 v[68:71], v5, s[8:11], s38 offen offset:1024 sc1
    ds_read_b64_tr_b16 v[140:141], v11 offset:14336
    ds_read_b64_tr_b16 v[142:143], v11 offset:14592
    v_mfma_f32_16x16x32_bf16 v[84:87], v[144:147], v[20:23], v[84:87]
    ds_read_b64_tr_b16 v[144:145], v12 offset:14336
    ds_read_b64_tr_b16 v[146:147], v12 offset:14592
    v_mfma_f32_16x16x32_bf16 v[88:91], v[148:151], v[20:23], v[88:91]
    ds_read_b64_tr_b16 v[148:149], v11 offset:47104
    ds_read_b64_tr_b16 v[150:151], v11 offset:47360
    v_mfma_f32_16x16x32_bf16 v[92:95], v[152:155], v[20:23], v[92:95]
    ds_read_b64_tr_b16 v[152:153], v12 offset:47104
    ds_read_b64_tr_b16 v[154:155], v12 offset:47360
    s_waitcnt lgkmcnt(15)
    v_mfma_f32_16x16x32_bf16 v[80:83], v[156:159], v[24:27], v[80:83]
    buffer_load_dwordx4 v[72:75], v5, s[8:11], s38 offen offset:2048 sc1
    ds_read_b64_tr_b16 v[156:157], v11 offset:16384
    ds_read_b64_tr_b16 v[158:159], v11 offset:16640
    v_mfma_f32_16x16x32_bf16 v[84:87], v[160:163], v[24:27], v[84:87]
    ds_read_b64_tr_b16 v[160:161], v12 offset:16384
    ds_read_b64_tr_b16 v[162:163], v12 offset:16640
    v_mfma_f32_16x16x32_bf16 v[88:91], v[164:167], v[24:27], v[88:91]
    ds_read_b64_tr_b16 v[164:165], v11 offset:49152
    ds_read_b64_tr_b16 v[166:167], v11 offset:49408
    v_mfma_f32_16x16x32_bf16 v[92:95], v[168:171], v[24:27], v[92:95]
    ds_read_b64_tr_b16 v[168:169], v12 offset:49152
    ds_read_b64_tr_b16 v[170:171], v12 offset:49408
    s_waitcnt lgkmcnt(15)
    v_mfma_f32_16x16x32_bf16 v[80:83], v[172:175], v[28:31], v[80:83]
    buffer_load_dwordx4 v[76:79], v5, s[8:11], s38 offen offset:3072 sc1
    ds_read_b64_tr_b16 v[172:173], v11 offset:18432
    ds_read_b64_tr_b16 v[174:175], v11 offset:18688
    v_mfma_f32_16x16x32_bf16 v[84:87], v[176:179], v[28:31], v[84:87]
    s_waitcnt vmcnt(9)
    v_max3_u32 v7, v35, v39, v43
    v_cmp_eq_u32 vcc, -1, v7
    ds_read_b64_tr_b16 v[176:177], v12 offset:18432
    ds_read_b64_tr_b16 v[178:179], v12 offset:18688
    v_mfma_f32_16x16x32_bf16 v[88:91], v[180:183], v[28:31], v[88:91]
    s_cbranch_vccnz L_rt20_main_kernel
L_ok20_main_kernel:
    ds_read_b64_tr_b16 v[180:181], v11 offset:51200
    ds_read_b64_tr_b16 v[182:183], v11 offset:51456
    v_mfma_f32_16x16x32_bf16 v[92:95], v[184:187], v[28:31], v[92:95]
    ds_read_b64_tr_b16 v[184:185], v12 offset:51200
    ds_read_b64_tr_b16 v[186:187], v12 offset:51456
    s_waitcnt lgkmcnt(15)
    v_mfma_f32_16x16x32_bf16 v[80:83], v[188:191], v[32:35], v[80:83]
    v_add_f32 v100, v100, v102
    v_add_f32 v101, v101, v103
    ds_read_b64_tr_b16 v[188:189], v11 offset:20480
    ds_read_b64_tr_b16 v[190:191], v11 offset:20736
    v_mfma_f32_16x16x32_bf16 v[84:87], v[192:195], v[32:35], v[84:87]
    v_mov_b32 v102, v100
    v_mov_b32 v103, v101
    ds_read_b64_tr_b16 v[192:193], v12 offset:20480
    ds_read_b64_tr_b16 v[194:195], v12 offset:20736
    v_mfma_f32_16x16x32_bf16 v[88:91], v[196:199], v[32:35], v[88:91]
    v_permlane32_swap_b32 v100, v102
    v_permlane32_swap_b32 v101, v103
    ds_read_b64_tr_b16 v[196:197], v11 offset:53248
    ds_read_b64_tr_b16 v[198:199], v11 offset:53504
    v_mfma_f32_16x16x32_bf16 v[92:95], v[200:203], v[32:35], v[92:95]
    v_add_f32 v100, v100, v102
    ds_read_b64_tr_b16 v[200:201], v12 offset:53248
    ds_read_b64_tr_b16 v[202:203], v12 offset:53504
    s_barrier
    ds_read_b128 v[108:111], v104 offset:0
    ds_read_b128 v[112:115], v104 offset:64
    ds_read_b128 v[116:119], v104 offset:128
    ds_read_b128 v[120:123], v104 offset:192
    s_waitcnt lgkmcnt(15)
    v_mfma_f32_16x16x32_bf16 v[80:83], v[204:207], v[36:39], v[80:83]
    v_add_f32 v101, v101, v103
    v_mov_b32 v102, v100
    ds_read_b64_tr_b16 v[204:205], v11 offset:22528
    ds_read_b64_tr_b16 v[206:207], v11 offset:22784
    v_mfma_f32_16x16x32_bf16 v[84:87], v[208:211], v[36:39], v[84:87]
    v_mov_b32 v103, v101
    v_permlane16_swap_b32 v100, v102
    ds_read_b64_tr_b16 v[208:209], v12 offset:22528
    ds_read_b64_tr_b16 v[210:211], v12 offset:22784
    v_mfma_f32_16x16x32_bf16 v[88:91], v[212:215], v[36:39], v[88:91]
    v_permlane16_swap_b32 v101, v103
    v_add_f32 v100, v100, v102
    ds_read_b64_tr_b16 v[212:213], v11 offset:55296
    ds_read_b64_tr_b16 v[214:215], v11 offset:55552
    v_mfma_f32_16x16x32_bf16 v[92:95], v[216:219], v[36:39], v[92:95]
    v_add_f32 v101, v101, v103
    v_mul_f32 v103, 0xbb000000, v100
    ds_read_b64_tr_b16 v[216:217], v12 offset:55296
    ds_read_b64_tr_b16 v[218:219], v12 offset:55552
    s_waitcnt lgkmcnt(15)
    v_mfma_f32_16x16x32_bf16 v[80:83], v[124:127], v[40:43], v[80:83]
    v_mul_f32 v101, 0x3b000000, v101
    v_fma_f32 v101, -v103, v103, v101
    ds_read_b64_tr_b16 v[124:125], v11 offset:24576
    ds_read_b64_tr_b16 v[126:127], v11 offset:24832
    v_mfma_f32_16x16x32_bf16 v[84:87], v[128:131], v[40:43], v[84:87]
    v_max_f32 v101, 0, v101
    v_add_f32 v102, 0x3727c5ac, v101
    s_waitcnt vmcnt(6)
    v_max3_u32 v7, v47, v51, v55
    v_cmp_eq_u32 vcc, -1, v7
    ds_read_b64_tr_b16 v[128:129], v12 offset:24576
    ds_read_b64_tr_b16 v[130:131], v12 offset:24832
    v_mfma_f32_16x16x32_bf16 v[88:91], v[132:135], v[40:43], v[88:91]
    v_rsq_f32 v100, v102
    s_nop 0
    v_mul_f32 v102, v100, v100
    s_cbranch_vccnz L_rt21_main_kernel
L_ok21_main_kernel:
    ds_read_b64_tr_b16 v[132:133], v11 offset:57344
    ds_read_b64_tr_b16 v[134:135], v11 offset:57600
    v_mfma_f32_16x16x32_bf16 v[92:95], v[136:139], v[40:43], v[92:95]
    v_mul_f32 v102, v102, v101
    ds_read_b64_tr_b16 v[136:137], v12 offset:57344
    ds_read_b64_tr_b16 v[138:139], v12 offset:57600
    s_waitcnt lgkmcnt(15)
    v_mfma_f32_16x16x32_bf16 v[80:83], v[140:143], v[44:47], v[80:83]
    v_add_f32 v102, 0x3727c5ac, v102
    v_rsq_f32 v102, v102
    ds_read_b64_tr_b16 v[140:141], v11 offset:26624
    ds_read_b64_tr_b16 v[142:143], v11 offset:26880
    v_mfma_f32_16x16x32_bf16 v[84:87], v[144:147], v[44:47], v[84:87]
    v_mul_f32 v100, v100, v102
    v_rcp_f32 v102, v100
    ds_read_b64_tr_b16 v[144:145], v12 offset:26624
    ds_read_b64_tr_b16 v[146:147], v12 offset:26880
    v_mfma_f32_16x16x32_bf16 v[88:91], v[148:151], v[44:47], v[88:91]
    v_mul_f32 v101, s99, v100
    v_mul_f32 v100, v100, v100
    ds_read_b64_tr_b16 v[148:149], v11 offset:59392
    ds_read_b64_tr_b16 v[150:151], v11 offset:59648
    v_mfma_f32_16x16x32_bf16 v[92:95], v[152:155], v[44:47], v[92:95]
    v_mul_f32 v100, v100, v101
    v_mul_f32 v100, 0x3d372713, v100
    ds_read_b64_tr_b16 v[152:153], v12 offset:59392
    ds_read_b64_tr_b16 v[154:155], v12 offset:59648
    s_waitcnt lgkmcnt(15)
    v_mfma_f32_16x16x32_bf16 v[80:83], v[156:159], v[48:51], v[80:83]
    ds_read_b64_tr_b16 v[156:157], v11 offset:28672
    ds_read_b64_tr_b16 v[158:159], v11 offset:28928
    v_mfma_f32_16x16x32_bf16 v[84:87], v[160:163], v[48:51], v[84:87]
    ds_read_b64_tr_b16 v[160:161], v12 offset:28672
    ds_read_b64_tr_b16 v[162:163], v12 offset:28928
    v_mfma_f32_16x16x32_bf16 v[88:91], v[164:167], v[48:51], v[88:91]
    s_nop 1
    v_pk_fma_f32 v[80:81], v[108:109], v[102:103], v[80:81] op_sel:[0,1,0] op_sel_hi:[1,1,1]
    v_pk_fma_f32 v[82:83], v[110:111], v[102:103], v[82:83] op_sel:[0,1,0] op_sel_hi:[1,1,1]
    ds_read_b64_tr_b16 v[164:165], v11 offset:61440
    ds_read_b64_tr_b16 v[166:167], v11 offset:61696
    v_mfma_f32_16x16x32_bf16 v[92:95], v[168:171], v[48:51], v[92:95]
    v_pk_fma_f32 v[84:85], v[112:113], v[102:103], v[84:85] op_sel:[0,1,0] op_sel_hi:[1,1,1]
    v_pk_fma_f32 v[86:87], v[114:115], v[102:103], v[86:87] op_sel:[0,1,0] op_sel_hi:[1,1,1]
    ds_read_b64_tr_b16 v[168:169], v12 offset:61440
    ds_read_b64_tr_b16 v[170:171], v12 offset:61696
    s_waitcnt lgkmcnt(15)
    v_mfma_f32_16x16x32_bf16 v[80:83], v[172:175], v[52:55], v[80:83]
    v_pk_fma_f32 v[88:89], v[116:117], v[102:103], v[88:89] op_sel:[0,1,0] op_sel_hi:[1,1,1]
    v_pk_fma_f32 v[90:91], v[118:119], v[102:103], v[90:91] op_sel:[0,1,0] op_sel_hi:[1,1,1]
    ds_read_b64_tr_b16 v[172:173], v11 offset:30720
    ds_read_b64_tr_b16 v[174:175], v11 offset:30976
    v_mfma_f32_16x16x32_bf16 v[84:87], v[176:179], v[52:55], v[84:87]
    v_pk_fma_f32 v[92:93], v[120:121], v[102:103], v[92:93] op_sel:[0,1,0] op_sel_hi:[1,1,1]
    v_pk_fma_f32 v[94:95], v[122:123], v[102:103], v[94:95] op_sel:[0,1,0] op_sel_hi:[1,1,1]
    s_waitcnt vmcnt(3)
    v_max3_u32 v7, v59, v63, v67
    v_cmp_eq_u32 vcc, -1, v7
    ds_read_b64_tr_b16 v[176:177], v12 offset:30720
    ds_read_b64_tr_b16 v[178:179], v12 offset:30976
    v_mfma_f32_16x16x32_bf16 v[88:91], v[180:183], v[52:55], v[88:91]
    s_cbranch_vccnz L_rt22_main_kernel
L_ok22_main_kernel:
    ds_read_b64_tr_b16 v[180:181], v11 offset:63488
    ds_read_b64_tr_b16 v[182:183], v11 offset:63744
    v_mfma_f32_16x16x32_bf16 v[92:95], v[184:187], v[52:55], v[92:95]
    ds_read_b64_tr_b16 v[184:185], v12 offset:63488
    ds_read_b64_tr_b16 v[186:187], v12 offset:63744
    s_waitcnt lgkmcnt(15)
    v_mfma_f32_16x16x32_bf16 v[80:83], v[188:191], v[56:59], v[80:83]
    v_mfma_f32_16x16x32_bf16 v[84:87], v[192:195], v[56:59], v[84:87]
    v_mfma_f32_16x16x32_bf16 v[88:91], v[196:199], v[56:59], v[88:91]
    v_mfma_f32_16x16x32_bf16 v[92:95], v[200:203], v[56:59], v[92:95]
    s_waitcnt lgkmcnt(15)
    v_mfma_f32_16x16x32_bf16 v[80:83], v[204:207], v[60:63], v[80:83]
    v_mfma_f32_16x16x32_bf16 v[84:87], v[208:211], v[60:63], v[84:87]
    v_mfma_f32_16x16x32_bf16 v[88:91], v[212:215], v[60:63], v[88:91]
    v_mfma_f32_16x16x32_bf16 v[92:95], v[216:219], v[60:63], v[92:95]
    s_waitcnt lgkmcnt(15)
    v_mfma_f32_16x16x32_bf16 v[80:83], v[124:127], v[64:67], v[80:83]
    v_mfma_f32_16x16x32_bf16 v[84:87], v[128:131], v[64:67], v[84:87]
    s_waitcnt vmcnt(0)
    v_max3_u32 v7, v71, v75, v79
    v_cmp_eq_u32 vcc, -1, v7
    v_mfma_f32_16x16x32_bf16 v[88:91], v[132:135], v[64:67], v[88:91]
    s_cbranch_vccnz L_rt23_main_kernel
L_ok23_main_kernel:
    v_mfma_f32_16x16x32_bf16 v[92:95], v[136:139], v[64:67], v[92:95]
    s_waitcnt lgkmcnt(15)
    v_mfma_f32_16x16x32_bf16 v[80:83], v[140:143], v[68:71], v[80:83]
    v_mfma_f32_16x16x32_bf16 v[84:87], v[144:147], v[68:71], v[84:87]
    v_mfma_f32_16x16x32_bf16 v[88:91], v[148:151], v[68:71], v[88:91]
    v_mfma_f32_16x16x32_bf16 v[92:95], v[152:155], v[68:71], v[92:95]
    s_waitcnt lgkmcnt(8)
    v_mfma_f32_16x16x32_bf16 v[80:83], v[156:159], v[72:75], v[80:83]
    v_mfma_f32_16x16x32_bf16 v[84:87], v[160:163], v[72:75], v[84:87]
    v_mfma_f32_16x16x32_bf16 v[88:91], v[164:167], v[72:75], v[88:91]
    v_mfma_f32_16x16x32_bf16 v[92:95], v[168:171], v[72:75], v[92:95]
    s_waitcnt lgkmcnt(0)
    v_mfma_f32_16x16x32_bf16 v[80:83], v[172:175], v[76:79], v[80:83]
    v_mfma_f32_16x16x32_bf16 v[84:87], v[176:179], v[76:79], v[84:87]
    v_mfma_f32_16x16x32_bf16 v[88:91], v[180:183], v[76:79], v[88:91]
    v_mfma_f32_16x16x32_bf16 v[92:95], v[184:187], v[76:79], v[92:95]
    s_barrier
    s_nop 3
    v_pk_mul_f32 v[16:17], v[80:81], v[80:81]
    v_pk_mul_f32 v[20:21], v[84:85], v[84:85]
    v_pk_mul_f32 v[24:25], v[88:89], v[88:89]
    v_pk_mul_f32 v[28:29], v[92:93], v[92:93]
    v_pk_mul_f32 v[18:19], v[82:83], v[82:83]
    v_pk_mul_f32 v[22:23], v[86:87], v[86:87]
    v_pk_mul_f32 v[26:27], v[90:91], v[90:91]
    v_pk_mul_f32 v[30:31], v[94:95], v[94:95]
    v_pk_fma_f32 v[16:17], v[16:17], v[100:101], v[100:101] op_sel:[0,0,1] op_sel_hi:[1,0,1]
    v_pk_fma_f32 v[20:21], v[20:21], v[100:101], v[100:101] op_sel:[0,0,1] op_sel_hi:[1,0,1]
    v_pk_fma_f32 v[24:25], v[24:25], v[100:101], v[100:101] op_sel:[0,0,1] op_sel_hi:[1,0,1]
    v_pk_fma_f32 v[28:29], v[28:29], v[100:101], v[100:101] op_sel:[0,0,1] op_sel_hi:[1,0,1]
    v_pk_fma_f32 v[18:19], v[18:19], v[100:101], v[100:101] op_sel:[0,0,1] op_sel_hi:[1,0,1]
    v_pk_fma_f32 v[22:23], v[22:23], v[100:101], v[100:101] op_sel:[0,0,1] op_sel_hi:[1,0,1]
    v_pk_fma_f32 v[26:27], v[26:27], v[100:101], v[100:101] op_sel:[0,0,1] op_sel_hi:[1,0,1]
    v_pk_fma_f32 v[30:31], v[30:31], v[100:101], v[100:101] op_sel:[0,0,1] op_sel_hi:[1,0,1]
    v_pk_mul_f32 v[16:17], v[16:17], v[80:81]
    v_pk_mul_f32 v[20:21], v[20:21], v[84:85]
    v_pk_mul_f32 v[24:25], v[24:25], v[88:89]
    v_pk_mul_f32 v[28:29], v[28:29], v[92:93]
    v_pk_mul_f32 v[18:19], v[18:19], v[82:83]
    v_pk_mul_f32 v[22:23], v[22:23], v[86:87]
    v_pk_mul_f32 v[26:27], v[26:27], v[90:91]
    v_pk_mul_f32 v[30:31], v[30:31], v[94:95]
    v_exp_f32 v16, v16
    v_exp_f32 v20, v20
    v_exp_f32 v24, v24
    v_exp_f32 v28, v28
    v_exp_f32 v17, v17
    v_exp_f32 v21, v21
    v_exp_f32 v25, v25
    v_exp_f32 v29, v29
    v_exp_f32 v18, v18
    v_exp_f32 v22, v22
    v_exp_f32 v26, v26
    v_exp_f32 v30, v30
    v_exp_f32 v19, v19
    v_exp_f32 v23, v23
    v_exp_f32 v27, v27
    v_exp_f32 v31, v31
    v_pk_fma_f32 v[16:17], v[16:17], v[102:103], v[102:103] op_sel_hi:[1,0,0]
    v_pk_fma_f32 v[20:21], v[20:21], v[102:103], v[102:103] op_sel_hi:[1,0,0]
    v_pk_fma_f32 v[24:25], v[24:25], v[102:103], v[102:103] op_sel_hi:[1,0,0]
    v_pk_fma_f32 v[28:29], v[28:29], v[102:103], v[102:103] op_sel_hi:[1,0,0]
    v_pk_fma_f32 v[18:19], v[18:19], v[102:103], v[102:103] op_sel_hi:[1,0,0]
    v_pk_fma_f32 v[22:23], v[22:23], v[102:103], v[102:103] op_sel_hi:[1,0,0]
    v_pk_fma_f32 v[26:27], v[26:27], v[102:103], v[102:103] op_sel_hi:[1,0,0]
    v_pk_fma_f32 v[30:31], v[30:31], v[102:103], v[102:103] op_sel_hi:[1,0,0]
    v_rcp_f32 v16, v16
    v_rcp_f32 v20, v20
    v_rcp_f32 v24, v24
    v_rcp_f32 v28, v28
    v_rcp_f32 v17, v17
    v_rcp_f32 v21, v21
    v_rcp_f32 v25, v25
    v_rcp_f32 v29, v29
    v_rcp_f32 v18, v18
    v_rcp_f32 v22, v22
    v_rcp_f32 v26, v26
    v_rcp_f32 v30, v30
    v_rcp_f32 v19, v19
    v_rcp_f32 v23, v23
    v_rcp_f32 v27, v27
    v_rcp_f32 v31, v31
    v_pk_mul_f32 v[16:17], v[16:17], v[80:81]
    v_pk_mul_f32 v[20:21], v[20:21], v[84:85]
    v_pk_mul_f32 v[24:25], v[24:25], v[88:89]
    v_pk_mul_f32 v[28:29], v[28:29], v[92:93]
    v_pk_mul_f32 v[18:19], v[18:19], v[82:83]
    v_pk_mul_f32 v[22:23], v[22:23], v[86:87]
    v_pk_mul_f32 v[26:27], v[26:27], v[90:91]
    v_pk_mul_f32 v[30:31], v[30:31], v[94:95]
    v_cvt_pk_bf16_f32 v48, v16, v17
    v_cvt_pk_bf16_f32 v50, v20, v21
    v_cvt_pk_bf16_f32 v52, v24, v25
    v_cvt_pk_bf16_f32 v54, v28, v29
    v_cvt_pk_bf16_f32 v49, v18, v19
    v_cvt_pk_bf16_f32 v51, v22, v23
    v_cvt_pk_bf16_f32 v53, v26, v27
    v_cvt_pk_bf16_f32 v55, v30, v31
    v_permlane16_swap_b32 v48, v50
    v_permlane16_swap_b32 v49, v51
    v_permlane16_swap_b32 v52, v54
    v_permlane16_swap_b32 v53, v55
    s_add_u32 s37, s46, 16
    s_and_b32 s37, s37, 0xe0
    s_cmp_eq_u32 s37, 0
    s_cbranch_scc1 L_hb_main_kernel
    buffer_store_dwordx4 v[48:51], v8, s[16:19], s47 offen offset:0
    buffer_store_dwordx4 v[52:55], v8, s[16:19], s47 offen offset:1024
    s_branch L_hc_main_kernel
L_hb_main_kernel:
    buffer_store_dwordx4 v[48:51], v8, s[16:19], s47 offen offset:0 sc1
    buffer_store_dwordx4 v[52:55], v8, s[16:19], s47 offen offset:1024 sc1
L_hc_main_kernel:
    v_and_b32 v14, 3, v2
    v_lshrrev_b32 v13, 2, v2
    v_and_b32 v13, 3, v13
    v_lshlrev_b32 v13, 6, v13
    v_lshl_add_u32 v13, v14, 3, v13
    v_lshl_add_u32 v13, v3, 9, v13
    v_add_u32 v13, 0x10000, v13
    v_and_b32 v14, 1, v3
    v_lshl_add_u32 v11, v14, 5, v13
    v_xor_b32 v14, 1, v14
    v_lshl_add_u32 v12, v14, 5, v13
    v_add_u32 v104, s46, v4
    v_lshlrev_b32 v104, 3, v104
    v_lshl_add_u32 v104, v3, 15, v104
    s_add_i32 s37, s46, -1
    v_add_u32 v112, s37, v4
    v_ashrrev_i32 v113, 4, v112
    v_lshlrev_b32 v113, 14, v113
    v_and_b32 v112, 15, v112
    v_lshl_add_u32 v113, v112, 4, v113
    v_lshl_add_u32 v113, v3, 8, v113
    s_add_i32 s37, s46, 1
    v_add_u32 v112, s37, v4
    v_ashrrev_i32 v114, 4, v112
    v_lshlrev_b32 v114, 14, v114
    v_and_b32 v112, 15, v112
    v_lshl_add_u32 v114, v112, 4, v114
    v_lshl_add_u32 v114, v3, 8, v114
    v_add_u32 v114, 0x1000, v114
    s_add_i32 s37, s46, -2
    v_add_u32 v112, s37, v4
    v_ashrrev_i32 v115, 4, v112
    v_lshlrev_b32 v115, 14, v115
    v_and_b32 v112, 15, v112
    v_lshl_add_u32 v115, v112, 4, v115
    v_lshl_add_u32 v115, v3, 8, v115
    v_add_u32 v115, 0x2000, v115
    s_add_i32 s37, s46, 2
    v_add_u32 v112, s37, v4
    v_ashrrev_i32 v116, 4, v112
    v_lshlrev_b32 v116, 14, v116
    v_and_b32 v112, 15, v112
    v_lshl_add_u32 v116, v112, 4, v116
    v_lshl_add_u32 v116, v3, 8, v116
    v_add_u32 v116, 0x3000, v116
    v_and_b32 v117, 7, v2
    v_lshlrev_b32 v117, 11, v117
    s_lshl_b32 s37, s46, 10
    s_add_u32 s37, s37, 1024
    v_add_u32 v117, s37, v117
    v_and_b32 v112, 2, v2
    v_lshlrev_b32 v112, 14, v112
    v_subrev_u32 v112, 0x4000, v112
    v_cmp_lt_u32 vcc, 7, v2
    s_nop 1
    v_cndmask_b32 v112, 0, v112, vcc
    v_add_u32 v117, v117, v112
    s_add_u32 s8, s60, 0x800000
    s_addc_u32 s9, s61, 0
    s_mov_b32 s10, 0x200000
    s_mov_b32 s11, 0x00020000
    s_add_u32 s16, s60, 0xa00000
    s_addc_u32 s17, s61, 0
    s_mov_b32 s18, 0x200000
    s_mov_b32 s19, 0x00020000
    s_add_u32 s20, s60, 0x200000
    s_addc_u32 s21, s61, 0
    s_mov_b32 s22, 0x200000
    s_mov_b32 s23, 0x00020000
    s_add_u32 s48, s60, 0x1220000
    s_addc_u32 s49, s61, 0
    s_mov_b32 s50, 0x20000
    s_mov_b32 s51, 0x00020000
    s_add_u32 s52, s60, 0x1240000
    s_addc_u32 s53, s61, 0
    s_mov_b32 s54, 0x20000
    s_mov_b32 s55, 0x00020000
    buffer_load_dwordx4 v[96:99], v8, s[20:23], s47 offen offset:0
    buffer_load_dwordx4 v[100:103], v8, s[20:23], s47 offen offset:1024
    buffer_load_dwordx2 v[108:109], v104, s[48:51], 0 offen offset:0 sc1
    buffer_load_dwordx2 v[110:111], v104, s[48:51], s96 offen offset:0 sc1
    ds_read_b64_tr_b16 v[120:121], v11 offset:0
    ds_read_b64_tr_b16 v[122:123], v11 offset:256
    ds_read_b64_tr_b16 v[124:125], v12 offset:0
    ds_read_b64_tr_b16 v[126:127], v12 offset:256
    ds_read_b64_tr_b16 v[128:129], v11 offset:16384
    ds_read_b64_tr_b16 v[130:131], v11 offset:16640
    ds_read_b64_tr_b16 v[132:133], v12 offset:16384
    ds_read_b64_tr_b16 v[134:135], v12 offset:16640
    ds_read_b64_tr_b16 v[136:137], v11 offset:2048
    ds_read_b64_tr_b16 v[138:139], v11 offset:2304
    ds_read_b64_tr_b16 v[140:141], v12 offset:2048
    ds_read_b64_tr_b16 v[142:143], v12 offset:2304
    ds_read_b64_tr_b16 v[144:145], v11 offset:18432
    ds_read_b64_tr_b16 v[146:147], v11 offset:18688
    ds_read_b64_tr_b16 v[148:149], v12 offset:18432
    ds_read_b64_tr_b16 v[150:151], v12 offset:18688
    ds_read_b64_tr_b16 v[152:153], v11 offset:4096
    ds_read_b64_tr_b16 v[154:155], v11 offset:4352
    ds_read_b64_tr_b16 v[156:157], v12 offset:4096
    ds_read_b64_tr_b16 v[158:159], v12 offset:4352
    ds_read_b64_tr_b16 v[160:161], v11 offset:20480
    ds_read_b64_tr_b16 v[162:163], v11 offset:20736
    ds_read_b64_tr_b16 v[164:165], v12 offset:20480
    ds_read_b64_tr_b16 v[166:167], v12 offset:20736
    ds_read_b64_tr_b16 v[168:169], v11 offset:6144
    ds_read_b64_tr_b16 v[170:171], v11 offset:6400
    ds_read_b64_tr_b16 v[172:173], v12 offset:6144
    ds_read_b64_tr_b16 v[174:175], v12 offset:6400
    ds_read_b64_tr_b16 v[176:177], v11 offset:22528
    ds_read_b64_tr_b16 v[178:179], v11 offset:22784
    ds_read_b64_tr_b16 v[180:181], v12 offset:22528
    ds_read_b64_tr_b16 v[182:183], v12 offset:22784
    ds_read_b64_tr_b16 v[184:185], v11 offset:8192
    ds_read_b64_tr_b16 v[186:187], v11 offset:8448
    ds_read_b64_tr_b16 v[188:189], v12 offset:8192
    ds_read_b64_tr_b16 v[190:191], v12 offset:8448
    ds_read_b64_tr_b16 v[192:193], v11 offset:24576
    ds_read_b64_tr_b16 v[194:195], v11 offset:24832
    ds_read_b64_tr_b16 v[196:197], v12 offset:24576
    ds_read_b64_tr_b16 v[198:199], v12 offset:24832
    ds_read_b64_tr_b16 v[200:201], v11 offset:10240
    ds_read_b64_tr_b16 v[202:203], v11 offset:10496
    ds_read_b64_tr_b16 v[204:205], v12 offset:10240
    ds_read_b64_tr_b16 v[206:207], v12 offset:10496
    ds_read_b64_tr_b16 v[208:209], v11 offset:26624
    ds_read_b64_tr_b16 v[210:211], v11 offset:26880
    ds_read_b64_tr_b16 v[212:213], v12 offset:26624
    ds_read_b64_tr_b16 v[214:215], v12 offset:26880
    s_waitcnt vmcnt(0)
    v_add_f32 v108, v108, v110
    v_permlane16_swap_b32 v96, v98
    v_add_f32 v109, v109, v111
    v_permlane16_swap_b32 v97, v99
    v_mov_b32 v110, v108
    v_permlane16_swap_b32 v100, v102
    v_mov_b32 v111, v109
    v_permlane16_swap_b32 v101, v103
    v_permlane32_swap_b32 v108, v110
    v_permlane32_swap_b32 v109, v111
    v_add_f32 v108, v108, v110
    v_add_f32 v109, v109, v111
    v_mov_b32 v110, v108
    v_mov_b32 v111, v109
    s_nop 0
    v_permlane16_swap_b32 v108, v110
    v_permlane16_swap_b32 v109, v111
    v_add_f32 v108, v108, v110
    v_add_f32 v109, v109, v111
    v_mul_f32 v108, 0x3b000000, v108
    v_mul_f32 v109, 0x3b000000, v109
    v_fma_f32 v109, -v108, v108, v109
    v_max_f32 v109, 0, v109
    v_add_f32 v110, 0x3727c5ac, v109
    v_rsq_f32 v110, v110
    s_nop 0
    v_mul_f32 v109, v108, v110
    v_sub_f32 v109, 0, v109
    v_mov_b32 v108, v110
    v_lshlrev_b32 v80, 16, v96
    v_lshlrev_b32 v84, 16, v98
    v_lshlrev_b32 v88, 16, v100
    v_lshlrev_b32 v92, 16, v102
    v_and_b32 v81, 0xffff0000, v96
    v_and_b32 v85, 0xffff0000, v98
    v_and_b32 v89, 0xffff0000, v100
    v_and_b32 v93, 0xffff0000, v102
    v_lshlrev_b32 v82, 16, v97
    v_lshlrev_b32 v86, 16, v99
    v_lshlrev_b32 v90, 16, v101
    v_lshlrev_b32 v94, 16, v103
    v_and_b32 v83, 0xffff0000, v97
    v_and_b32 v87, 0xffff0000, v99
    v_and_b32 v91, 0xffff0000, v101
    v_and_b32 v95, 0xffff0000, v103
    v_pk_fma_f32 v[80:81], v[80:81], v[108:109], v[108:109] op_sel:[0,0,1] op_sel_hi:[1,0,1]
    v_pk_fma_f32 v[84:85], v[84:85], v[108:109], v[108:109] op_sel:[0,0,1] op_sel_hi:[1,0,1]
    v_pk_fma_f32 v[88:89], v[88:89], v[108:109], v[108:109] op_sel:[0,0,1] op_sel_hi:[1,0,1]
    v_pk_fma_f32 v[92:93], v[92:93], v[108:109], v[108:109] op_sel:[0,0,1] op_sel_hi:[1,0,1]
    v_pk_fma_f32 v[82:83], v[82:83], v[108:109], v[108:109] op_sel:[0,0,1] op_sel_hi:[1,0,1]
    v_pk_fma_f32 v[86:87], v[86:87], v[108:109], v[108:109] op_sel:[0,0,1] op_sel_hi:[1,0,1]
    v_pk_fma_f32 v[90:91], v[90:91], v[108:109], v[108:109] op_sel:[0,0,1] op_sel_hi:[1,0,1]
    v_pk_fma_f32 v[94:95], v[94:95], v[108:109], v[108:109] op_sel:[0,0,1] op_sel_hi:[1,0,1]
    buffer_load_dwordx4 v[16:19], v113, s[8:11], 0 offen offset:0 sc1
    buffer_load_dwordx4 v[20:23], v113, s[8:11], 0 offen offset:1024 sc1
    buffer_load_dwordx4 v[24:27], v113, s[8:11], 0 offen offset:2048 sc1
    buffer_load_dwordx4 v[28:31], v113, s[8:11], 0 offen offset:3072 sc1
    buffer_load_dwordx4 v[32:35], v114, s[8:11], 0 offen offset:0 sc1
    buffer_load_dwordx4 v[36:39], v114, s[8:11], 0 offen offset:1024 sc1
    buffer_load_dwordx4 v[40:43], v114, s[8:11], 0 offen offset:2048 sc1
    buffer_load_dwordx4 v[44:47], v114, s[8:11], 0 offen offset:3072 sc1
    buffer_load_dwordx4 v[48:51], v115, s[8:11], 0 offen offset:0 sc1
    buffer_load_dwordx4 v[52:55], v115, s[8:11], 0 offen offset:1024 sc1
    buffer_load_dwordx4 v[56:59], v115, s[8:11], 0 offen offset:2048 sc1
    buffer_load_dwordx4 v[60:63], v115, s[8:11], 0 offen offset:3072 sc1
    s_waitcnt vmcnt(11)
    v_cmp_eq_u32 vcc, -1, v19
    s_cbranch_vccnz L_rt25_main_kernel
L_ok25_main_kernel:
    s_waitcnt lgkmcnt(15)
    v_mfma_f32_16x16x32_bf16 v[80:83], v[120:123], v[16:19], v[80:83]
    buffer_load_dwordx4 v[64:67], v116, s[8:11], 0 offen offset:0 sc1
    ds_read_b64_tr_b16 v[120:121], v11 offset:12288
    ds_read_b64_tr_b16 v[122:123], v11 offset:12544
    v_mfma_f32_16x16x32_bf16 v[84:87], v[124:127], v[16:19], v[84:87]
    s_waitcnt vmcnt(9)
    v_max3_u32 v7, v23, v27, v31
    v_cmp_eq_u32 vcc, -1, v7
    ds_read_b64_tr_b16 v[124:125], v12 offset:12288
    ds_read_b64_tr_b16 v[126:127], v12 offset:12544
    v_mfma_f32_16x16x32_bf16 v[88:91], v[128:131], v[16:19], v[88:91]
    s_cbranch_vccnz L_rt26_main_kernel
L_ok26_main_kernel:
    ds_read_b64_tr_b16 v[128:129], v11 offset:28672
    ds_read_b64_tr_b16 v[130:131], v11 offset:28928
    v_mfma_f32_16x16x32_bf16 v[92:95], v[132:135], v[16:19], v[92:95]
    ds_read_b64_tr_b16 v[132:133], v12 offset:28672
    ds_read_b64_tr_b16 v[134:135], v12 offset:28928
    s_waitcnt lgkmcnt(15)
    v_mfma_f32_16x16x32_bf16 v[80:83], v[136:139], v[20:23], v[80:83]
    buffer_load_dwordx4 v[68:71], v116, s[8:11], 0 offen offset:1024 sc1
    ds_read_b64_tr_b16 v[136:137], v11 offset:14336
    ds_read_b64_tr_b16 v[138:139], v11 offset:14592
    v_mfma_f32_16x16x32_bf16 v[84:87], v[140:143], v[20:23], v[84:87]
    ds_read_b64_tr_b16 v[140:141], v12 offset:14336
    ds_read_b64_tr_b16 v[142:143], v12 offset:14592
    v_mfma_f32_16x16x32_bf16 v[88:91], v[144:147], v[20:23], v[88:91]
    ds_read_b64_tr_b16 v[144:145], v11 offset:30720
    ds_read_b64_tr_b16 v[146:147], v11 offset:30976
    v_mfma_f32_16x16x32_bf16 v[92:95], v[148:151], v[20:23], v[92:95]
    ds_read_b64_tr_b16 v[148:149], v12 offset:30720
    ds_read_b64_tr_b16 v[150:151], v12 offset:30976
    s_waitcnt lgkmcnt(15)
    v_mfma_f32_16x16x32_bf16 v[80:83], v[152:155], v[24:27], v[80:83]
    buffer_load_dwordx4 v[72:75], v116, s[8:11], 0 offen offset:2048 sc1
    ds_read_b64_tr_b16 v[152:153], v11 offset:32768
    ds_read_b64_tr_b16 v[154:155], v11 offset:33024
    v_mfma_f32_16x16x32_bf16 v[84:87], v[156:159], v[24:27], v[84:87]
    ds_read_b64_tr_b16 v[156:157], v12 offset:32768
    ds_read_b64_tr_b16 v[158:159], v12 offset:33024
    v_mfma_f32_16x16x32_bf16 v[88:91], v[160:163], v[24:27], v[88:91]
    ds_read_b64_tr_b16 v[160:161], v11 offset:49152
    ds_read_b64_tr_b16 v[162:163], v11 offset:49408
    v_mfma_f32_16x16x32_bf16 v[92:95], v[164:167], v[24:27], v[92:95]
    ds_read_b64_tr_b16 v[164:165], v12 offset:49152
    ds_read_b64_tr_b16 v[166:167], v12 offset:49408
    s_waitcnt lgkmcnt(15)
    v_mfma_f32_16x16x32_bf16 v[80:83], v[168:171], v[28:31], v[80:83]
    buffer_load_dwordx4 v[76:79], v116, s[8:11], 0 offen offset:3072 sc1
    ds_read_b64_tr_b16 v[168:169], v11 offset:34816
    ds_read_b64_tr_b16 v[170:171], v11 offset:35072
    v_mfma_f32_16x16x32_bf16 v[84:87], v[172:175], v[28:31], v[84:87]
    s_waitcnt vmcnt(9)
    v_max3_u32 v7, v35, v39, v43
    v_cmp_eq_u32 vcc, -1, v7
    ds_read_b64_tr_b16 v[172:173], v12 offset:34816
    ds_read_b64_tr_b16 v[174:175], v12 offset:35072
    v_mfma_f32_16x16x32_bf16 v[88:91], v[176:179], v[28:31], v[88:91]
    s_cbranch_vccnz L_rt27_main_kernel
L_ok27_main_kernel:
    ds_read_b64_tr_b16 v[176:177], v11 offset:51200
    ds_read_b64_tr_b16 v[178:179], v11 offset:51456
    v_mfma_f32_16x16x32_bf16 v[92:95], v[180:183], v[28:31], v[92:95]
    ds_read_b64_tr_b16 v[180:181], v12 offset:51200
    ds_read_b64_tr_b16 v[182:183], v12 offset:51456
    s_waitcnt lgkmcnt(15)
    v_mfma_f32_16x16x32_bf16 v[80:83], v[184:187], v[32:35], v[80:83]
    ds_read_b64_tr_b16 v[184:185], v11 offset:36864
    ds_read_b64_tr_b16 v[186:187], v11 offset:37120
    v_mfma_f32_16x16x32_bf16 v[84:87], v[188:191], v[32:35], v[84:87]
    ds_read_b64_tr_b16 v[188:189], v12 offset:36864
    ds_read_b64_tr_b16 v[190:191], v12 offset:37120
    v_mfma_f32_16x16x32_bf16 v[88:91], v[192:195], v[32:35], v[88:91]
    ds_read_b64_tr_b16 v[192:193], v11 offset:53248
    ds_read_b64_tr_b16 v[194:195], v11 offset:53504
    v_mfma_f32_16x16x32_bf16 v[92:95], v[196:199], v[32:35], v[92:95]
    ds_read_b64_tr_b16 v[196:197], v12 offset:53248
    ds_read_b64_tr_b16 v[198:199], v12 offset:53504
    s_waitcnt lgkmcnt(15)
    v_mfma_f32_16x16x32_bf16 v[80:83], v[200:203], v[36:39], v[80:83]
    ds_read_b64_tr_b16 v[200:201], v11 offset:38912
    ds_read_b64_tr_b16 v[202:203], v11 offset:39168
    v_mfma_f32_16x16x32_bf16 v[84:87], v[204:207], v[36:39], v[84:87]
    ds_read_b64_tr_b16 v[204:205], v12 offset:38912
    ds_read_b64_tr_b16 v[206:207], v12 offset:39168
    v_mfma_f32_16x16x32_bf16 v[88:91], v[208:211], v[36:39], v[88:91]
    ds_read_b64_tr_b16 v[208:209], v11 offset:55296
    ds_read_b64_tr_b16 v[210:211], v11 offset:55552
    v_mfma_f32_16x16x32_bf16 v[92:95], v[212:215], v[36:39], v[92:95]
    ds_read_b64_tr_b16 v[212:213], v12 offset:55296
    ds_read_b64_tr_b16 v[214:215], v12 offset:55552
    s_waitcnt lgkmcnt(15)
    v_mfma_f32_16x16x32_bf16 v[80:83], v[120:123], v[40:43], v[80:83]
    ds_read_b64_tr_b16 v[120:121], v11 offset:40960
    ds_read_b64_tr_b16 v[122:123], v11 offset:41216
    v_mfma_f32_16x16x32_bf16 v[84:87], v[124:127], v[40:43], v[84:87]
    s_waitcnt vmcnt(6)
    v_max3_u32 v7, v47, v51, v55
    v_cmp_eq_u32 vcc, -1, v7
    ds_read_b64_tr_b16 v[124:125], v12 offset:40960
    ds_read_b64_tr_b16 v[126:127], v12 offset:41216
    v_mfma_f32_16x16x32_bf16 v[88:91], v[128:131], v[40:43], v[88:91]
    s_cbranch_vccnz L_rt28_main_kernel
L_ok28_main_kernel:
    ds_read_b64_tr_b16 v[128:129], v11 offset:57344
    ds_read_b64_tr_b16 v[130:131], v11 offset:57600
    v_mfma_f32_16x16x32_bf16 v[92:95], v[132:135], v[40:43], v[92:95]
    ds_read_b64_tr_b16 v[132:133], v12 offset:57344
    ds_read_b64_tr_b16 v[134:135], v12 offset:57600
    s_waitcnt lgkmcnt(15)
    v_mfma_f32_16x16x32_bf16 v[80:83], v[136:139], v[44:47], v[80:83]
    ds_read_b64_tr_b16 v[136:137], v11 offset:43008
    ds_read_b64_tr_b16 v[138:139], v11 offset:43264
    v_mfma_f32_16x16x32_bf16 v[84:87], v[140:143], v[44:47], v[84:87]
    ds_read_b64_tr_b16 v[140:141], v12 offset:43008
    ds_read_b64_tr_b16 v[142:143], v12 offset:43264
    v_mfma_f32_16x16x32_bf16 v[88:91], v[144:147], v[44:47], v[88:91]
    ds_read_b64_tr_b16 v[144:145], v11 offset:59392
    ds_read_b64_tr_b16 v[146:147], v11 offset:59648
    v_mfma_f32_16x16x32_bf16 v[92:95], v[148:151], v[44:47], v[92:95]
    ds_read_b64_tr_b16 v[148:149], v12 offset:59392
    ds_read_b64_tr_b16 v[150:151], v12 offset:59648
    s_waitcnt lgkmcnt(15)
    v_mfma_f32_16x16x32_bf16 v[80:83], v[152:155], v[48:51], v[80:83]
    ds_read_b64_tr_b16 v[152:153], v11 offset:45056
    ds_read_b64_tr_b16 v[154:155], v11 offset:45312
    v_mfma_f32_16x16x32_bf16 v[84:87], v[156:159], v[48:51], v[84:87]
    ds_read_b64_tr_b16 v[156:157], v12 offset:45056
    ds_read_b64_tr_b16 v[158:159], v12 offset:45312
    v_mfma_f32_16x16x32_bf16 v[88:91], v[160:163], v[48:51], v[88:91]
    ds_read_b64_tr_b16 v[160:161], v11 offset:61440
    ds_read_b64_tr_b16 v[162:163], v11 offset:61696
    v_mfma_f32_16x16x32_bf16 v[92:95], v[164:167], v[48:51], v[92:95]
    ds_read_b64_tr_b16 v[164:165], v12 offset:61440
    ds_read_b64_tr_b16 v[166:167], v12 offset:61696
    s_waitcnt lgkmcnt(15)
    v_mfma_f32_16x16x32_bf16 v[80:83], v[168:171], v[52:55], v[80:83]
    ds_read_b64_tr_b16 v[168:169], v11 offset:47104
    ds_read_b64_tr_b16 v[170:171], v11 offset:47360
    v_mfma_f32_16x16x32_bf16 v[84:87], v[172:175], v[52:55], v[84:87]
    s_waitcnt vmcnt(3)
    v_max3_u32 v7, v59, v63, v67
    v_cmp_eq_u32 vcc, -1, v7
    ds_read_b64_tr_b16 v[172:173], v12 offset:47104
    ds_read_b64_tr_b16 v[174:175], v12 offset:47360
    v_mfma_f32_16x16x32_bf16 v[88:91], v[176:179], v[52:55], v[88:91]
    s_cbranch_vccnz L_rt29_main_kernel
L_ok29_main_kernel:
    ds_read_b64_tr_b16 v[176:177], v11 offset:63488
    ds_read_b64_tr_b16 v[178:179], v11 offset:63744
    v_mfma_f32_16x16x32_bf16 v[92:95], v[180:183], v[52:55], v[92:95]
    ds_read_b64_tr_b16 v[180:181], v12 offset:63488
    ds_read_b64_tr_b16 v[182:183], v12 offset:63744
    s_waitcnt lgkmcnt(15)
    v_mfma_f32_16x16x32_bf16 v[80:83], v[184:187], v[56:59], v[80:83]
    v_mfma_f32_16x16x32_bf16 v[84:87], v[188:191], v[56:59], v[84:87]
    v_mfma_f32_16x16x32_bf16 v[88:91], v[192:195], v[56:59], v[88:91]
    v_mfma_f32_16x16x32_bf16 v[92:95], v[196:199], v[56:59], v[92:95]
    s_waitcnt lgkmcnt(15)
    v_mfma_f32_16x16x32_bf16 v[80:83], v[200:203], v[60:63], v[80:83]
    v_mfma_f32_16x16x32_bf16 v[84:87], v[204:207], v[60:63], v[84:87]
    v_mfma_f32_16x16x32_bf16 v[88:91], v[208:211], v[60:63], v[88:91]
    v_mfma_f32_16x16x32_bf16 v[92:95], v[212:215], v[60:63], v[92:95]
    s_waitcnt lgkmcnt(15)
    v_mfma_f32_16x16x32_bf16 v[80:83], v[120:123], v[64:67], v[80:83]
    v_mfma_f32_16x16x32_bf16 v[84:87], v[124:127], v[64:67], v[84:87]
    s_waitcnt vmcnt(0)
    v_max3_u32 v7, v71, v75, v79
    v_cmp_eq_u32 vcc, -1, v7
    v_mfma_f32_16x16x32_bf16 v[88:91], v[128:131], v[64:67], v[88:91]
    s_cbranch_vccnz L_rt30_main_kernel
L_ok30_main_kernel:
    v_mfma_f32_16x16x32_bf16 v[92:95], v[132:135], v[64:67], v[92:95]
    s_waitcnt lgkmcnt(15)
    v_mfma_f32_16x16x32_bf16 v[80:83], v[136:139], v[68:71], v[80:83]
    v_mfma_f32_16x16x32_bf16 v[84:87], v[140:143], v[68:71], v[84:87]
    v_mfma_f32_16x16x32_bf16 v[88:91], v[144:147], v[68:71], v[88:91]
    v_mfma_f32_16x16x32_bf16 v[92:95], v[148:151], v[68:71], v[92:95]
    s_waitcnt lgkmcnt(8)
    v_mfma_f32_16x16x32_bf16 v[80:83], v[152:155], v[72:75], v[80:83]
    v_mfma_f32_16x16x32_bf16 v[84:87], v[156:159], v[72:75], v[84:87]
    v_mfma_f32_16x16x32_bf16 v[88:91], v[160:163], v[72:75], v[88:91]
    v_mfma_f32_16x16x32_bf16 v[92:95], v[164:167], v[72:75], v[92:95]
    s_waitcnt lgkmcnt(0)
    v_mfma_f32_16x16x32_bf16 v[80:83], v[168:171], v[76:79], v[80:83]
    v_mfma_f32_16x16x32_bf16 v[84:87], v[172:175], v[76:79], v[84:87]
    v_mfma_f32_16x16x32_bf16 v[88:91], v[176:179], v[76:79], v[88:91]
    v_mfma_f32_16x16x32_bf16 v[92:95], v[180:183], v[76:79], v[92:95]
    s_nop 4
    v_cvt_pk_bf16_f32 v48, v80, v81
    v_cvt_pk_bf16_f32 v49, v82, v83
    v_cvt_pk_bf16_f32 v50, v84, v85
    v_cvt_pk_bf16_f32 v51, v86, v87
    v_cvt_pk_bf16_f32 v52, v88, v89
    v_cvt_pk_bf16_f32 v53, v90, v91
    v_cvt_pk_bf16_f32 v54, v92, v93
    v_cvt_pk_bf16_f32 v55, v94, v95
    s_barrier
    v_permlane16_swap_b32 v48, v50
    v_permlane16_swap_b32 v49, v51
    v_permlane16_swap_b32 v52, v54
    v_permlane16_swap_b32 v53, v55
    buffer_store_dwordx4 v[48:51], v8, s[16:19], s47 offen offset:0
    buffer_store_dwordx4 v[52:55], v8, s[16:19], s47 offen offset:1024
    v_dot2_f32_bf16 v56, v48, s40, 0
    v_dot2_f32_bf16 v57, v48, v48, 0
    v_dot2_f32_bf16 v56, v49, s40, v56
    v_dot2_f32_bf16 v57, v49, v49, v57
    v_dot2_f32_bf16 v56, v50, s40, v56
    v_dot2_f32_bf16 v57, v50, v50, v57
    v_dot2_f32_bf16 v56, v51, s40, v56
    v_dot2_f32_bf16 v57, v51, v51, v57
    v_dot2_f32_bf16 v56, v52, s40, v56
    v_dot2_f32_bf16 v57, v52, v52, v57
    v_dot2_f32_bf16 v56, v53, s40, v56
    v_dot2_f32_bf16 v57, v53, v53, v57
    v_dot2_f32_bf16 v56, v54, s40, v56
    v_dot2_f32_bf16 v57, v54, v54, v57
    v_dot2_f32_bf16 v56, v55, s40, v56
    v_dot2_f32_bf16 v57, v55, v55, v57
    s_nop 1
    v_mov_b32 v58, v56
    v_mov_b32 v59, v57
    s_nop 0
    v_permlane32_swap_b32 v56, v58
    v_permlane32_swap_b32 v57, v59
    v_add_f32 v56, v56, v58
    v_add_f32 v57, v57, v59
    v_mov_b32 v58, v56
    v_mov_b32 v59, v57
    s_nop 0
    v_permlane16_swap_b32 v56, v58
    v_permlane16_swap_b32 v57, v59
    v_add_f32 v56, v56, v58
    v_add_f32 v57, v57, v59
    v_add_u32 v58, s46, v4
    v_lshlrev_b32 v58, 3, v58
    s_lshl_b32 s37, s34, 14
    s_mov_b64 exec, 0xffff
    buffer_store_dwordx2 v[56:57], v58, s[52:55], s37 offen
    s_mov_b64 exec, -1
    s_mov_b32 s46, s93
    s_mul_i32 s45, s46, 1024
    v_and_b32 v14, 3, v2
    v_lshrrev_b32 v13, 2, v2
    v_and_b32 v13, 3, v13
    v_lshlrev_b32 v13, 6, v13
    v_lshl_add_u32 v13, v14, 3, v13
    v_lshl_add_u32 v13, v3, 9, v13
    v_and_b32 v14, 1, v3
    v_lshl_add_u32 v11, v14, 5, v13
    v_xor_b32 v14, 1, v14
    v_lshl_add_u32 v12, v14, 5, v13
    v_add_u32 v14, 0x20000, v11
    v_add_u32 v13, 0x20000, v12
    s_mul_i32 s47, s46, 2752
    s_lshl_b32 s37, s94, 10
    s_add_u32 s47, s47, s37
    v_add_u32 v15, s46, v4
    v_lshlrev_b32 v15, 3, v15
    v_lshl_add_u32 v15, v3, 15, v15
    v_lshlrev_b32 v24, 4, v3
    v_add_u32 v24, 0x1f800, v24
    s_add_u32 s8, s60, 0xa00000
    s_addc_u32 s9, s61, 0
    s_mov_b32 s10, 0x200000
    s_mov_b32 s11, 0x00020000
    s_add_u32 s16, s60, 0xc00000
    s_addc_u32 s17, s61, 0
    s_mov_b32 s18, 0x560000
    s_mov_b32 s19, 0x00020000
    s_add_u32 s48, s60, 0x1240000
    s_addc_u32 s49, s61, 0
    s_mov_b32 s50, 0x20000
    s_mov_b32 s51, 0x00020000
    ds_read_b64_tr_b16 v[204:205], v14 offset:0
    ds_read_b64_tr_b16 v[206:207], v14 offset:256
    ds_read_b64_tr_b16 v[208:209], v13 offset:0
    ds_read_b64_tr_b16 v[210:211], v13 offset:256
    ds_read_b64_tr_b16 v[212:213], v14 offset:16384
    ds_read_b64_tr_b16 v[214:215], v14 offset:16640
    ds_read_b64_tr_b16 v[216:217], v13 offset:16384
    ds_read_b64_tr_b16 v[218:219], v13 offset:16640
    ds_read_b64_tr_b16 v[220:221], v14 offset:2048
    ds_read_b64_tr_b16 v[222:223], v14 offset:2304
    ds_read_b64_tr_b16 v[224:225], v13 offset:2048
    ds_read_b64_tr_b16 v[226:227], v13 offset:2304
    ds_read_b64_tr_b16 v[228:229], v14 offset:18432
    ds_read_b64_tr_b16 v[230:231], v14 offset:18688
    ds_read_b64_tr_b16 v[232:233], v13 offset:18432
    ds_read_b64_tr_b16 v[234:235], v13 offset:18688
    ds_read_b64_tr_b16 v[236:237], v14 offset:4096
    ds_read_b64_tr_b16 v[238:239], v14 offset:4352
    ds_read_b64_tr_b16 v[240:241], v13 offset:4096
    ds_read_b64_tr_b16 v[242:243], v13 offset:4352
    ds_read_b64_tr_b16 v[244:245], v14 offset:20480
    ds_read_b64_tr_b16 v[246:247], v14 offset:20736
    ds_read_b64_tr_b16 v[248:249], v13 offset:20480
    ds_read_b64_tr_b16 v[250:251], v13 offset:20736
    buffer_load_dwordx2 v[16:17], v15, s[48:51], 0 offen offset:0 sc1
    buffer_load_dwordx2 v[18:19], v15, s[48:51], s96 offen offset:0 sc1
    buffer_load_dwordx2 v[20:21], v15, s[48:51], 0 offen offset:128 sc1
    buffer_load_dwordx2 v[22:23], v15, s[48:51], s96 offen offset:128 sc1
    s_add_u32 s38, s45, 0x0
    buffer_load_dwordx4 v[28:31], v5, s[8:11], s38 offen offset:0 sc1
    s_add_u32 s39, s45, 0x4000
    buffer_load_dwordx4 v[92:95], v5, s[8:11], s39 offen offset:0 sc1
    buffer_load_dwordx4 v[32:35], v5, s[8:11], s38 offen offset:1024 sc1
    buffer_load_dwordx4 v[96:99], v5, s[8:11], s39 offen offset:1024 sc1
    buffer_load_dwordx4 v[36:39], v5, s[8:11], s38 offen offset:2048 sc1
    buffer_load_dwordx4 v[100:103], v5, s[8:11], s39 offen offset:2048 sc1
    buffer_load_dwordx4 v[40:43], v5, s[8:11], s38 offen offset:3072 sc1
    buffer_load_dwordx4 v[104:107], v5, s[8:11], s39 offen offset:3072 sc1
    s_add_u32 s38, s45, 0x1000
    buffer_load_dwordx4 v[44:47], v5, s[8:11], s38 offen offset:0 sc1
    s_add_u32 s39, s45, 0x5000
    buffer_load_dwordx4 v[108:111], v5, s[8:11], s39 offen offset:0 sc1
    buffer_load_dwordx4 v[48:51], v5, s[8:11], s38 offen offset:1024 sc1
    buffer_load_dwordx4 v[112:115], v5, s[8:11], s39 offen offset:1024 sc1
    s_waitcnt vmcnt(12)
    v_max_u32 v7, v17, v19
    v_max3_u32 v7, v7, v21, v23
    v_cmp_eq_u32 vcc, -1, v7
    s_cbranch_vccnz L_pl31_main_kernel
L_go31_main_kernel:
    s_waitcnt vmcnt(10)
    v_max_u32 v7, v31, v95
    v_cmp_eq_u32 vcc, -1, v7
    s_cbranch_vccnz L_rt32_main_kernel
L_ok32_main_kernel:
    s_waitcnt lgkmcnt(15)
    v_mfma_f32_16x16x32_bf16 v[156:159], v[204:207], v[28:31], 0
    v_mfma_f32_16x16x32_bf16 v[160:163], v[204:207], v[92:95], 0
    buffer_load_dwordx4 v[52:55], v5, s[8:11], s38 offen offset:2048 sc1
    buffer_load_dwordx4 v[116:119], v5, s[8:11], s39 offen offset:2048 sc1
    ds_read_b64_tr_b16 v[204:205], v14 offset:6144
    ds_read_b64_tr_b16 v[206:207], v14 offset:6400
    v_mfma_f32_16x16x32_bf16 v[164:167], v[208:211], v[28:31], 0
    v_mfma_f32_16x16x32_bf16 v[168:171], v[208:211], v[92:95], 0
    s_waitcnt vmcnt(8)
    v_max3_u32 v7, v35, v99, v39
    v_max_u32 v7, v7, v103
    v_cmp_eq_u32 vcc, -1, v7
    ds_read_b64_tr_b16 v[208:209], v13 offset:6144
    ds_read_b64_tr_b16 v[210:211], v13 offset:6400
    v_mfma_f32_16x16x32_bf16 v[172:175], v[212:215], v[28:31], 0
    v_mfma_f32_16x16x32_bf16 v[176:179], v[212:215], v[92:95], 0
    s_cbranch_vccnz L_rt33_main_kernel
L_ok33_main_kernel:
    ds_read_b64_tr_b16 v[212:213], v14 offset:22528
    ds_read_b64_tr_b16 v[214:215], v14 offset:22784
    v_mfma_f32_16x16x32_bf16 v[180:183], v[216:219], v[28:31], 0
    v_mfma_f32_16x16x32_bf16 v[184:187], v[216:219], v[92:95], 0
    ds_read_b64_tr_b16 v[216:217], v13 offset:22528
    ds_read_b64_tr_b16 v[218:219], v13 offset:22784
    s_waitcnt lgkmcnt(15)
    v_mfma_f32_16x16x32_bf16 v[156:159], v[220:223], v[32:35], v[156:159]
    v_mfma_f32_16x16x32_bf16 v[160:163], v[220:223], v[96:99], v[160:163]
    buffer_load_dwordx4 v[56:59], v5, s[8:11], s38 offen offset:3072 sc1
    buffer_load_dwordx4 v[120:123], v5, s[8:11], s39 offen offset:3072 sc1
    ds_read_b64_tr_b16 v[220:221], v14 offset:8192
    ds_read_b64_tr_b16 v[222:223], v14 offset:8448
    v_mfma_f32_16x16x32_bf16 v[164:167], v[224:227], v[32:35], v[164:167]
    v_mfma_f32_16x16x32_bf16 v[168:171], v[224:227], v[96:99], v[168:171]
    ds_read_b64_tr_b16 v[224:225], v13 offset:8192
    ds_read_b64_tr_b16 v[226:227], v13 offset:8448
    v_mfma_f32_16x16x32_bf16 v[172:175], v[228:231], v[32:35], v[172:175]
    v_mfma_f32_16x16x32_bf16 v[176:179], v[228:231], v[96:99], v[176:179]
    ds_read_b64_tr_b16 v[228:229], v14 offset:24576
    ds_read_b64_tr_b16 v[230:231], v14 offset:24832
    v_mfma_f32_16x16x32_bf16 v[180:183], v[232:235], v[32:35], v[180:183]
    v_mfma_f32_16x16x32_bf16 v[184:187], v[232:235], v[96:99], v[184:187]
    ds_read_b64_tr_b16 v[232:233], v13 offset:24576
    ds_read_b64_tr_b16 v[234:235], v13 offset:24832
    s_waitcnt lgkmcnt(15)
    v_mfma_f32_16x16x32_bf16 v[156:159], v[236:239], v[36:39], v[156:159]
    v_mfma_f32_16x16x32_bf16 v[160:163], v[236:239], v[100:103], v[160:163]
    s_add_u32 s38, s45, 0x2000
    buffer_load_dwordx4 v[60:63], v5, s[8:11], s38 offen offset:0 sc1
    s_add_u32 s39, s45, 0x6000
    buffer_load_dwordx4 v[124:127], v5, s[8:11], s39 offen offset:0 sc1
    ds_read_b64_tr_b16 v[236:237], v14 offset:10240
    ds_read_b64_tr_b16 v[238:239], v14 offset:10496
    v_mfma_f32_16x16x32_bf16 v[164:167], v[240:243], v[36:39], v[164:167]
    v_mfma_f32_16x16x32_bf16 v[168:171], v[240:243], v[100:103], v[168:171]
    s_waitcnt vmcnt(8)
    v_max3_u32 v7, v43, v107, v47
    v_max_u32 v7, v7, v111
    v_cmp_eq_u32 vcc, -1, v7
    ds_read_b64_tr_b16 v[240:241], v13 offset:10240
    ds_read_b64_tr_b16 v[242:243], v13 offset:10496
    v_mfma_f32_16x16x32_bf16 v[172:175], v[244:247], v[36:39], v[172:175]
    v_mfma_f32_16x16x32_bf16 v[176:179], v[244:247], v[100:103], v[176:179]
    s_cbranch_vccnz L_rt34_main_kernel
L_ok34_main_kernel:
    ds_read_b64_tr_b16 v[244:245], v14 offset:26624
    ds_read_b64_tr_b16 v[246:247], v14 offset:26880
    v_mfma_f32_16x16x32_bf16 v[180:183], v[248:251], v[36:39], v[180:183]
    v_mfma_f32_16x16x32_bf16 v[184:187], v[248:251], v[100:103], v[184:187]
    ds_read_b64_tr_b16 v[248:249], v13 offset:26624
    ds_read_b64_tr_b16 v[250:251], v13 offset:26880
    s_waitcnt lgkmcnt(15)
    v_mfma_f32_16x16x32_bf16 v[156:159], v[204:207], v[40:43], v[156:159]
    v_add_f32 v16, v16, v18
    v_mfma_f32_16x16x32_bf16 v[160:163], v[204:207], v[104:107], v[160:163]
    v_add_f32 v20, v20, v22
    buffer_load_dwordx4 v[64:67], v5, s[8:11], s38 offen offset:1024 sc1
    buffer_load_dwordx4 v[128:131], v5, s[8:11], s39 offen offset:1024 sc1
    ds_read_b64_tr_b16 v[204:205], v14 offset:12288
    ds_read_b64_tr_b16 v[206:207], v14 offset:12544
    v_mfma_f32_16x16x32_bf16 v[164:167], v[208:211], v[40:43], v[164:167]
    v_add_f32 v17, v17, v19
    v_mfma_f32_16x16x32_bf16 v[168:171], v[208:211], v[104:107], v[168:171]
    v_add_f32 v21, v21, v23
    ds_read_b64_tr_b16 v[208:209], v13 offset:12288
    ds_read_b64_tr_b16 v[210:211], v13 offset:12544
    v_mfma_f32_16x16x32_bf16 v[172:175], v[212:215], v[40:43], v[172:175]
    v_mov_b32 v18, v16
    v_mfma_f32_16x16x32_bf16 v[176:179], v[212:215], v[104:107], v[176:179]
    v_mov_b32 v22, v20
    ds_read_b64_tr_b16 v[212:213], v14 offset:28672
    ds_read_b64_tr_b16 v[214:215], v14 offset:28928
    v_mfma_f32_16x16x32_bf16 v[180:183], v[216:219], v[40:43], v[180:183]
    v_mov_b32 v19, v17
    v_mfma_f32_16x16x32_bf16 v[184:187], v[216:219], v[104:107], v[184:187]
    v_mov_b32 v23, v21
    ds_read_b64_tr_b16 v[216:217], v13 offset:28672
    ds_read_b64_tr_b16 v[218:219], v13 offset:28928
    s_waitcnt lgkmcnt(15)
    v_mfma_f32_16x16x32_bf16 v[156:159], v[220:223], v[44:47], v[156:159]
    v_permlane32_swap_b32 v16, v18
    v_mfma_f32_16x16x32_bf16 v[160:163], v[220:223], v[108:111], v[160:163]
    v_permlane32_swap_b32 v20, v22
    buffer_load_dwordx4 v[68:71], v5, s[8:11], s38 offen offset:2048 sc1
    buffer_load_dwordx4 v[132:135], v5, s[8:11], s39 offen offset:2048 sc1
    ds_read_b64_tr_b16 v[220:221], v14 offset:14336
    ds_read_b64_tr_b16 v[222:223], v14 offset:14592
    v_mfma_f32_16x16x32_bf16 v[164:167], v[224:227], v[44:47], v[164:167]
    v_permlane32_swap_b32 v17, v19
    v_mfma_f32_16x16x32_bf16 v[168:171], v[224:227], v[108:111], v[168:171]
    v_permlane32_swap_b32 v21, v23
    s_waitcnt vmcnt(8)
    v_max3_u32 v7, v51, v115, v55
    v_max_u32 v7, v7, v119
    v_cmp_eq_u32 vcc, -1, v7
    ds_read_b64_tr_b16 v[224:225], v13 offset:14336
    ds_read_b64_tr_b16 v[226:227], v13 offset:14592
    v_mfma_f32_16x16x32_bf16 v[172:175], v[228:231], v[44:47], v[172:175]
    v_add_f32 v16, v16, v18
    v_mfma_f32_16x16x32_bf16 v[176:179], v[228:231], v[108:111], v[176:179]
    v_add_f32 v20, v20, v22
    s_cbranch_vccnz L_rt35_main_kernel
L_ok35_main_kernel:
    ds_read_b64_tr_b16 v[228:229], v14 offset:30720
    ds_read_b64_tr_b16 v[230:231], v14 offset:30976
    v_mfma_f32_16x16x32_bf16 v[180:183], v[232:235], v[44:47], v[180:183]
    v_add_f32 v17, v17, v19
    v_mfma_f32_16x16x32_bf16 v[184:187], v[232:235], v[108:111], v[184:187]
    v_add_f32 v21, v21, v23
    ds_read_b64_tr_b16 v[232:233], v13 offset:30720
    ds_read_b64_tr_b16 v[234:235], v13 offset:30976
    s_waitcnt lgkmcnt(15)
    v_mfma_f32_16x16x32_bf16 v[156:159], v[236:239], v[48:51], v[156:159]
    v_mov_b32 v18, v16
    v_mov_b32 v22, v20
    v_mfma_f32_16x16x32_bf16 v[160:163], v[236:239], v[112:115], v[160:163]
    v_mov_b32 v19, v17
    buffer_load_dwordx4 v[72:75], v5, s[8:11], s38 offen offset:3072 sc1
    buffer_load_dwordx4 v[136:139], v5, s[8:11], s39 offen offset:3072 sc1
    ds_read_b64_tr_b16 v[236:237], v11 offset:0
    ds_read_b64_tr_b16 v[238:239], v11 offset:256
    v_mfma_f32_16x16x32_bf16 v[164:167], v[240:243], v[48:51], v[164:167]
    v_mov_b32 v23, v21
    v_mfma_f32_16x16x32_bf16 v[168:171], v[240:243], v[112:115], v[168:171]
    v_permlane16_swap_b32 v16, v18
    ds_read_b64_tr_b16 v[240:241], v12 offset:0
    ds_read_b64_tr_b16 v[242:243], v12 offset:256
    v_mfma_f32_16x16x32_bf16 v[172:175], v[244:247], v[48:51], v[172:175]
    v_permlane16_swap_b32 v20, v22
    v_mfma_f32_16x16x32_bf16 v[176:179], v[244:247], v[112:115], v[176:179]
    v_permlane16_swap_b32 v17, v19
    ds_read_b64_tr_b16 v[244:245], v11 offset:16384
    ds_read_b64_tr_b16 v[246:247], v11 offset:16640
    v_mfma_f32_16x16x32_bf16 v[180:183], v[248:251], v[48:51], v[180:183]
    v_permlane16_swap_b32 v21, v23
    v_mfma_f32_16x16x32_bf16 v[184:187], v[248:251], v[112:115], v[184:187]
    v_add_f32 v16, v16, v18
    ds_read_b64_tr_b16 v[248:249], v12 offset:16384
    ds_read_b64_tr_b16 v[250:251], v12 offset:16640
    s_waitcnt lgkmcnt(15)
    v_mfma_f32_16x16x32_bf16 v[156:159], v[204:207], v[52:55], v[156:159]
    v_add_f32 v20, v20, v22
    v_mfma_f32_16x16x32_bf16 v[160:163], v[204:207], v[116:119], v[160:163]
    v_add_f32 v17, v17, v19
    s_add_u32 s38, s45, 0x3000
    buffer_load_dwordx4 v[76:79], v5, s[8:11], s38 offen offset:0 sc1
    s_add_u32 s39, s45, 0x7000
    buffer_load_dwordx4 v[140:143], v5, s[8:11], s39 offen offset:0 sc1
    ds_read_b64_tr_b16 v[204:205], v11 offset:2048
    ds_read_b64_tr_b16 v[206:207], v11 offset:2304
    v_mfma_f32_16x16x32_bf16 v[164:167], v[208:211], v[52:55], v[164:167]
    v_add_f32 v21, v21, v23
    v_mfma_f32_16x16x32_bf16 v[168:171], v[208:211], v[116:119], v[168:171]
    v_mul_f32 v19, 0xbb000000, v16
    s_waitcnt vmcnt(8)
    v_max3_u32 v7, v59, v123, v63
    v_max_u32 v7, v7, v127
    v_cmp_eq_u32 vcc, -1, v7
    ds_read_b64_tr_b16 v[208:209], v12 offset:2048
    ds_read_b64_tr_b16 v[210:211], v12 offset:2304
    v_mfma_f32_16x16x32_bf16 v[172:175], v[212:215], v[52:55], v[172:175]
    v_mul_f32 v23, 0xbb000000, v20
    v_mfma_f32_16x16x32_bf16 v[176:179], v[212:215], v[116:119], v[176:179]
    v_mul_f32 v17, 0x3b000000, v17
    s_cbranch_vccnz L_rt36_main_kernel
L_ok36_main_kernel:
    ds_read_b64_tr_b16 v[212:213], v11 offset:18432
    ds_read_b64_tr_b16 v[214:215], v11 offset:18688
    v_mfma_f32_16x16x32_bf16 v[180:183], v[216:219], v[52:55], v[180:183]
    v_mul_f32 v21, 0x3b000000, v21
    v_mfma_f32_16x16x32_bf16 v[184:187], v[216:219], v[116:119], v[184:187]
    v_fma_f32 v17, -v19, v19, v17
    ds_read_b64_tr_b16 v[216:217], v12 offset:18432
    ds_read_b64_tr_b16 v[218:219], v12 offset:18688
    s_waitcnt lgkmcnt(15)
    v_mfma_f32_16x16x32_bf16 v[156:159], v[220:223], v[56:59], v[156:159]
    v_fma_f32 v21, -v23, v23, v21
    v_mfma_f32_16x16x32_bf16 v[160:163], v[220:223], v[120:123], v[160:163]
    v_max_f32 v17, 0, v17
    buffer_load_dwordx4 v[80:83], v5, s[8:11], s38 offen offset:1024 sc1
    buffer_load_dwordx4 v[144:147], v5, s[8:11], s39 offen offset:1024 sc1
    ds_read_b64_tr_b16 v[220:221], v11 offset:4096
    ds_read_b64_tr_b16 v[222:223], v11 offset:4352
    v_mfma_f32_16x16x32_bf16 v[164:167], v[224:227], v[56:59], v[164:167]
    v_max_f32 v21, 0, v21
    v_mfma_f32_16x16x32_bf16 v[168:171], v[224:227], v[120:123], v[168:171]
    v_add_f32 v18, 0x3727c5ac, v17
    ds_read_b64_tr_b16 v[224:225], v12 offset:4096
    ds_read_b64_tr_b16 v[226:227], v12 offset:4352
    v_mfma_f32_16x16x32_bf16 v[172:175], v[228:231], v[56:59], v[172:175]
    v_add_f32 v22, 0x3727c5ac, v21
    v_mfma_f32_16x16x32_bf16 v[176:179], v[228:231], v[120:123], v[176:179]
    v_rsq_f32 v16, v18
    ds_read_b64_tr_b16 v[228:229], v11 offset:20480
    ds_read_b64_tr_b16 v[230:231], v11 offset:20736
    v_mfma_f32_16x16x32_bf16 v[180:183], v[232:235], v[56:59], v[180:183]
    v_rsq_f32 v20, v22
    v_mfma_f32_16x16x32_bf16 v[184:187], v[232:235], v[120:123], v[184:187]
    v_mul_f32 v18, v18, v16
    ds_read_b64_tr_b16 v[232:233], v12 offset:20480
    ds_read_b64_tr_b16 v[234:235], v12 offset:20736
    s_waitcnt lgkmcnt(15)
    v_mfma_f32_16x16x32_bf16 v[156:159], v[236:239], v[60:63], v[156:159]
    v_mul_f32 v22, v22, v20
    v_mul_f32 v17, s99, v16
    v_mfma_f32_16x16x32_bf16 v[160:163], v[236:239], v[124:127], v[160:163]
    v_mul_f32 v21, s99, v20
    buffer_load_dwordx4 v[84:87], v5, s[8:11], s38 offen offset:2048 sc1
    buffer_load_dwordx4 v[148:151], v5, s[8:11], s39 offen offset:2048 sc1
    ds_read_b64_tr_b16 v[236:237], v11 offset:6144
    ds_read_b64_tr_b16 v[238:239], v11 offset:6400
    v_mfma_f32_16x16x32_bf16 v[164:167], v[240:243], v[60:63], v[164:167]
    v_mul_f32 v16, v16, v16
    v_mfma_f32_16x16x32_bf16 v[168:171], v[240:243], v[124:127], v[168:171]
    v_mul_f32 v20, v20, v20
    s_waitcnt vmcnt(8)
    v_max3_u32 v7, v67, v131, v71
    v_max_u32 v7, v7, v135
    v_cmp_eq_u32 vcc, -1, v7
    ds_read_b64_tr_b16 v[240:241], v12 offset:6144
    ds_read_b64_tr_b16 v[242:243], v12 offset:6400
    v_mfma_f32_16x16x32_bf16 v[172:175], v[244:247], v[60:63], v[172:175]
    v_mul_f32 v16, v16, v17
    v_mfma_f32_16x16x32_bf16 v[176:179], v[244:247], v[124:127], v[176:179]
    v_mul_f32 v20, v20, v21
    s_cbranch_vccnz L_rt37_main_kernel
L_ok37_main_kernel:
    ds_read_b64_tr_b16 v[244:245], v11 offset:22528
    ds_read_b64_tr_b16 v[246:247], v11 offset:22784
    v_mfma_f32_16x16x32_bf16 v[180:183], v[248:251], v[60:63], v[180:183]
    v_mul_f32 v16, 0x3d372713, v16
    v_mfma_f32_16x16x32_bf16 v[184:187], v[248:251], v[124:127], v[184:187]
    v_mul_f32 v20, 0x3d372713, v20
    ds_read_b64_tr_b16 v[248:249], v12 offset:22528
    ds_read_b64_tr_b16 v[250:251], v12 offset:22784
    s_waitcnt lgkmcnt(15)
    v_mfma_f32_16x16x32_bf16 v[156:159], v[204:207], v[64:67], v[156:159]
    v_mfma_f32_16x16x32_bf16 v[160:163], v[204:207], v[128:131], v[160:163]
    buffer_load_dwordx4 v[88:91], v5, s[8:11], s38 offen offset:3072 sc1
    buffer_load_dwordx4 v[152:155], v5, s[8:11], s39 offen offset:3072 sc1
    ds_read_b64_tr_b16 v[204:205], v11 offset:8192
    ds_read_b64_tr_b16 v[206:207], v11 offset:8448
    v_mfma_f32_16x16x32_bf16 v[164:167], v[208:211], v[64:67], v[164:167]
    v_mfma_f32_16x16x32_bf16 v[168:171], v[208:211], v[128:131], v[168:171]
    ds_read_b64_tr_b16 v[208:209], v12 offset:8192
    ds_read_b64_tr_b16 v[210:211], v12 offset:8448
    v_mfma_f32_16x16x32_bf16 v[172:175], v[212:215], v[64:67], v[172:175]
    v_mfma_f32_16x16x32_bf16 v[176:179], v[212:215], v[128:131], v[176:179]
    ds_read_b64_tr_b16 v[212:213], v11 offset:24576
    ds_read_b64_tr_b16 v[214:215], v11 offset:24832
    v_mfma_f32_16x16x32_bf16 v[180:183], v[216:219], v[64:67], v[180:183]
    v_mfma_f32_16x16x32_bf16 v[184:187], v[216:219], v[128:131], v[184:187]
    ds_read_b64_tr_b16 v[216:217], v12 offset:24576
    ds_read_b64_tr_b16 v[218:219], v12 offset:24832
    s_waitcnt lgkmcnt(15)
    v_mfma_f32_16x16x32_bf16 v[156:159], v[220:223], v[68:71], v[156:159]
    v_mfma_f32_16x16x32_bf16 v[160:163], v[220:223], v[132:135], v[160:163]
    ds_read_b64_tr_b16 v[220:221], v11 offset:10240
    ds_read_b64_tr_b16 v[222:223], v11 offset:10496
    v_mfma_f32_16x16x32_bf16 v[164:167], v[224:227], v[68:71], v[164:167]
    v_mfma_f32_16x16x32_bf16 v[168:171], v[224:227], v[132:135], v[168:171]
    s_waitcnt vmcnt(6)
    v_max3_u32 v7, v75, v139, v79
    v_max_u32 v7, v7, v143
    v_cmp_eq_u32 vcc, -1, v7
    ds_read_b64_tr_b16 v[224:225], v12 offset:10240
    ds_read_b64_tr_b16 v[226:227], v12 offset:10496
    v_mfma_f32_16x16x32_bf16 v[172:175], v[228:231], v[68:71], v[172:175]
    v_mfma_f32_16x16x32_bf16 v[176:179], v[228:231], v[132:135], v[176:179]
    s_cbranch_vccnz L_rt38_main_kernel
L_ok38_main_kernel:
    ds_read_b64_tr_b16 v[228:229], v11 offset:26624
    ds_read_b64_tr_b16 v[230:231], v11 offset:26880
    v_mfma_f32_16x16x32_bf16 v[180:183], v[232:235], v[68:71], v[180:183]
    v_mfma_f32_16x16x32_bf16 v[184:187], v[232:235], v[132:135], v[184:187]
    ds_read_b64_tr_b16 v[232:233], v12 offset:26624
    ds_read_b64_tr_b16 v[234:235], v12 offset:26880
    s_barrier
    ds_read_b128 v[188:191], v24 offset:0
    ds_read_b128 v[192:195], v24 offset:64
    ds_read_b128 v[196:199], v24 offset:128
    ds_read_b128 v[200:203], v24 offset:192
    s_waitcnt lgkmcnt(15)
    v_mfma_f32_16x16x32_bf16 v[156:159], v[236:239], v[72:75], v[156:159]
    v_mfma_f32_16x16x32_bf16 v[160:163], v[236:239], v[136:139], v[160:163]
    ds_read_b64_tr_b16 v[236:237], v11 offset:12288
    ds_read_b64_tr_b16 v[238:239], v11 offset:12544
    v_mfma_f32_16x16x32_bf16 v[164:167], v[240:243], v[72:75], v[164:167]
    v_mfma_f32_16x16x32_bf16 v[168:171], v[240:243], v[136:139], v[168:171]
    ds_read_b64_tr_b16 v[240:241], v12 offset:12288
    ds_read_b64_tr_b16 v[242:243], v12 offset:12544
    v_mfma_f32_16x16x32_bf16 v[172:175], v[244:247], v[72:75], v[172:175]
    v_mfma_f32_16x16x32_bf16 v[176:179], v[244:247], v[136:139], v[176:179]
    ds_read_b64_tr_b16 v[244:245], v11 offset:28672
    ds_read_b64_tr_b16 v[246:247], v11 offset:28928
    v_mfma_f32_16x16x32_bf16 v[180:183], v[248:251], v[72:75], v[180:183]
    v_mfma_f32_16x16x32_bf16 v[184:187], v[248:251], v[136:139], v[184:187]
    ds_read_b64_tr_b16 v[248:249], v12 offset:28672
    ds_read_b64_tr_b16 v[250:251], v12 offset:28928
    s_waitcnt lgkmcnt(8)
    v_mfma_f32_16x16x32_bf16 v[156:159], v[204:207], v[76:79], v[156:159]
    v_mfma_f32_16x16x32_bf16 v[160:163], v[204:207], v[140:143], v[160:163]
    ds_read_b64_tr_b16 v[204:205], v11 offset:14336
    ds_read_b64_tr_b16 v[206:207], v11 offset:14592
    v_mfma_f32_16x16x32_bf16 v[164:167], v[208:211], v[76:79], v[164:167]
    v_mfma_f32_16x16x32_bf16 v[168:171], v[208:211], v[140:143], v[168:171]
    s_waitcnt vmcnt(2)
    v_max3_u32 v7, v83, v147, v87
    v_max_u32 v7, v7, v151
    v_cmp_eq_u32 vcc, -1, v7
    ds_read_b64_tr_b16 v[208:209], v12 offset:14336
    ds_read_b64_tr_b16 v[210:211], v12 offset:14592
    v_mfma_f32_16x16x32_bf16 v[172:175], v[212:215], v[76:79], v[172:175]
    v_mfma_f32_16x16x32_bf16 v[176:179], v[212:215], v[140:143], v[176:179]
    v_pk_fma_f32 v[156:157], v[188:189], v[18:19], v[156:157] op_sel:[0,1,0] op_sel_hi:[1,1,1]
    v_pk_fma_f32 v[158:159], v[190:191], v[18:19], v[158:159] op_sel:[0,1,0] op_sel_hi:[1,1,1]
    v_pk_fma_f32 v[160:161], v[188:189], v[22:23], v[160:161] op_sel:[0,1,0] op_sel_hi:[1,1,1]
    v_pk_fma_f32 v[162:163], v[190:191], v[22:23], v[162:163] op_sel:[0,1,0] op_sel_hi:[1,1,1]
    s_cbranch_vccnz L_rt39_main_kernel
L_ok39_main_kernel:
    ds_read_b64_tr_b16 v[212:213], v11 offset:30720
    ds_read_b64_tr_b16 v[214:215], v11 offset:30976
    v_mfma_f32_16x16x32_bf16 v[180:183], v[216:219], v[76:79], v[180:183]
    v_mfma_f32_16x16x32_bf16 v[184:187], v[216:219], v[140:143], v[184:187]
    v_pk_fma_f32 v[164:165], v[192:193], v[18:19], v[164:165] op_sel:[0,1,0] op_sel_hi:[1,1,1]
    v_pk_fma_f32 v[166:167], v[194:195], v[18:19], v[166:167] op_sel:[0,1,0] op_sel_hi:[1,1,1]
    v_pk_fma_f32 v[168:169], v[192:193], v[22:23], v[168:169] op_sel:[0,1,0] op_sel_hi:[1,1,1]
    v_pk_fma_f32 v[170:171], v[194:195], v[22:23], v[170:171] op_sel:[0,1,0] op_sel_hi:[1,1,1]
    ds_read_b64_tr_b16 v[216:217], v12 offset:30720
    ds_read_b64_tr_b16 v[218:219], v12 offset:30976
    s_waitcnt lgkmcnt(15)
    v_mfma_f32_16x16x32_bf16 v[156:159], v[220:223], v[80:83], v[156:159]
    v_mfma_f32_16x16x32_bf16 v[160:163], v[220:223], v[144:147], v[160:163]
    v_pk_fma_f32 v[172:173], v[196:197], v[18:19], v[172:173] op_sel:[0,1,0] op_sel_hi:[1,1,1]
    v_pk_fma_f32 v[174:175], v[198:199], v[18:19], v[174:175] op_sel:[0,1,0] op_sel_hi:[1,1,1]
    v_pk_fma_f32 v[176:177], v[196:197], v[22:23], v[176:177] op_sel:[0,1,0] op_sel_hi:[1,1,1]
    v_pk_fma_f32 v[178:179], v[198:199], v[22:23], v[178:179] op_sel:[0,1,0] op_sel_hi:[1,1,1]
    ds_read_b64_tr_b16 v[220:221], v11 offset:32768
    ds_read_b64_tr_b16 v[222:223], v11 offset:33024
    v_mfma_f32_16x16x32_bf16 v[164:167], v[224:227], v[80:83], v[164:167]
    v_mfma_f32_16x16x32_bf16 v[168:171], v[224:227], v[144:147], v[168:171]
    v_pk_fma_f32 v[180:181], v[200:201], v[18:19], v[180:181] op_sel:[0,1,0] op_sel_hi:[1,1,1]
    v_pk_fma_f32 v[182:183], v[202:203], v[18:19], v[182:183] op_sel:[0,1,0] op_sel_hi:[1,1,1]
    v_pk_fma_f32 v[184:185], v[200:201], v[22:23], v[184:185] op_sel:[0,1,0] op_sel_hi:[1,1,1]
    v_pk_fma_f32 v[186:187], v[202:203], v[22:23], v[186:187] op_sel:[0,1,0] op_sel_hi:[1,1,1]
    ds_read_b64_tr_b16 v[224:225], v12 offset:32768
    ds_read_b64_tr_b16 v[226:227], v12 offset:33024
    v_mfma_f32_16x16x32_bf16 v[172:175], v[228:231], v[80:83], v[172:175]
    v_mfma_f32_16x16x32_bf16 v[176:179], v[228:231], v[144:147], v[176:179]
    ds_read_b64_tr_b16 v[228:229], v11 offset:34816
    ds_read_b64_tr_b16 v[230:231], v11 offset:35072
    v_mfma_f32_16x16x32_bf16 v[180:183], v[232:235], v[80:83], v[180:183]
    v_mfma_f32_16x16x32_bf16 v[184:187], v[232:235], v[144:147], v[184:187]
    ds_read_b64_tr_b16 v[232:233], v12 offset:34816
    ds_read_b64_tr_b16 v[234:235], v12 offset:35072
    ds_read_b128 v[188:191], v24 offset:256
    ds_read_b128 v[196:199], v24 offset:320
    s_waitcnt lgkmcnt(15)
    v_mfma_f32_16x16x32_bf16 v[156:159], v[236:239], v[84:87], v[156:159]
    v_mfma_f32_16x16x32_bf16 v[160:163], v[236:239], v[148:151], v[160:163]
    ds_read_b64_tr_b16 v[236:237], v11 offset:36864
    ds_read_b64_tr_b16 v[238:239], v11 offset:37120
    v_mfma_f32_16x16x32_bf16 v[164:167], v[240:243], v[84:87], v[164:167]
    v_mfma_f32_16x16x32_bf16 v[168:171], v[240:243], v[148:151], v[168:171]
    s_waitcnt vmcnt(0)
    v_max_u32 v7, v91, v155
    v_cmp_eq_u32 vcc, -1, v7
    ds_read_b64_tr_b16 v[240:241], v12 offset:36864
    ds_read_b64_tr_b16 v[242:243], v12 offset:37120
    v_mfma_f32_16x16x32_bf16 v[172:175], v[244:247], v[84:87], v[172:175]
    v_mfma_f32_16x16x32_bf16 v[176:179], v[244:247], v[148:151], v[176:179]
    s_cbranch_vccnz L_rt40_main_kernel
L_ok40_main_kernel:
    ds_read_b64_tr_b16 v[244:245], v11 offset:38912
    ds_read_b64_tr_b16 v[246:247], v11 offset:39168
    v_mfma_f32_16x16x32_bf16 v[180:183], v[248:251], v[84:87], v[180:183]
    v_mfma_f32_16x16x32_bf16 v[184:187], v[248:251], v[148:151], v[184:187]
    ds_read_b64_tr_b16 v[248:249], v12 offset:38912
    ds_read_b64_tr_b16 v[250:251], v12 offset:39168
    s_waitcnt lgkmcnt(15)
    v_mfma_f32_16x16x32_bf16 v[156:159], v[204:207], v[88:91], v[156:159]
    s_waitcnt lgkmcnt(8)
    v_pk_mul_f32 v[192:193], v[188:189], v[22:23] op_sel:[0,1] op_sel_hi:[1,1]
    s_nop 1
    v_mfma_f32_16x16x32_bf16 v[160:163], v[204:207], v[152:155], v[160:163]
    v_pk_mul_f32 v[194:195], v[190:191], v[22:23] op_sel:[0,1] op_sel_hi:[1,1]
    s_nop 1
    v_mfma_f32_16x16x32_bf16 v[164:167], v[208:211], v[88:91], v[164:167]
    v_pk_mul_f32 v[188:189], v[188:189], v[18:19] op_sel:[0,1] op_sel_hi:[1,1]
    s_nop 1
    v_mfma_f32_16x16x32_bf16 v[168:171], v[208:211], v[152:155], v[168:171]
    v_pk_mul_f32 v[190:191], v[190:191], v[18:19] op_sel:[0,1] op_sel_hi:[1,1]
    s_nop 1
    v_mfma_f32_16x16x32_bf16 v[172:175], v[212:215], v[88:91], v[172:175]
    v_pk_mul_f32 v[200:201], v[196:197], v[22:23] op_sel:[0,1] op_sel_hi:[1,1]
    s_nop 1
    v_mfma_f32_16x16x32_bf16 v[176:179], v[212:215], v[152:155], v[176:179]
    v_pk_mul_f32 v[202:203], v[198:199], v[22:23] op_sel:[0,1] op_sel_hi:[1,1]
    s_nop 1
    v_mfma_f32_16x16x32_bf16 v[180:183], v[216:219], v[88:91], v[180:183]
    v_pk_mul_f32 v[196:197], v[196:197], v[18:19] op_sel:[0,1] op_sel_hi:[1,1]
    s_nop 1
    v_mfma_f32_16x16x32_bf16 v[184:187], v[216:219], v[152:155], v[184:187]
    v_pk_mul_f32 v[198:199], v[198:199], v[18:19] op_sel:[0,1] op_sel_hi:[1,1]
    s_barrier
    s_add_u32 s39, s47, 44032
    v_pk_mul_f32 v[204:205], v[156:157], v[156:157]
    v_pk_mul_f32 v[208:209], v[164:165], v[164:165]
    v_pk_mul_f32 v[212:213], v[160:161], v[160:161]
    v_pk_mul_f32 v[216:217], v[168:169], v[168:169]
    v_pk_mul_f32 v[206:207], v[158:159], v[158:159]
    v_pk_mul_f32 v[210:211], v[166:167], v[166:167]
    v_pk_mul_f32 v[214:215], v[162:163], v[162:163]
    v_pk_mul_f32 v[218:219], v[170:171], v[170:171]
    v_pk_fma_f32 v[204:205], v[204:205], v[16:17], v[16:17] op_sel:[0,0,1] op_sel_hi:[1,0,1]
    v_pk_fma_f32 v[208:209], v[208:209], v[16:17], v[16:17] op_sel:[0,0,1] op_sel_hi:[1,0,1]
    v_pk_fma_f32 v[212:213], v[212:213], v[20:21], v[20:21] op_sel:[0,0,1] op_sel_hi:[1,0,1]
    v_pk_fma_f32 v[216:217], v[216:217], v[20:21], v[20:21] op_sel:[0,0,1] op_sel_hi:[1,0,1]
    v_pk_fma_f32 v[206:207], v[206:207], v[16:17], v[16:17] op_sel:[0,0,1] op_sel_hi:[1,0,1]
    v_pk_fma_f32 v[210:211], v[210:211], v[16:17], v[16:17] op_sel:[0,0,1] op_sel_hi:[1,0,1]
    v_pk_fma_f32 v[214:215], v[214:215], v[20:21], v[20:21] op_sel:[0,0,1] op_sel_hi:[1,0,1]
    v_pk_fma_f32 v[218:219], v[218:219], v[20:21], v[20:21] op_sel:[0,0,1] op_sel_hi:[1,0,1]
    v_pk_mul_f32 v[204:205], v[204:205], v[156:157]
    v_pk_mul_f32 v[208:209], v[208:209], v[164:165]
    v_pk_mul_f32 v[212:213], v[212:213], v[160:161]
    v_pk_mul_f32 v[216:217], v[216:217], v[168:169]
    v_pk_mul_f32 v[206:207], v[206:207], v[158:159]
    v_pk_mul_f32 v[210:211], v[210:211], v[166:167]
    v_pk_mul_f32 v[214:215], v[214:215], v[162:163]
    v_pk_mul_f32 v[218:219], v[218:219], v[170:171]
    v_exp_f32 v204, v204
    s_waitcnt lgkmcnt(14)
    v_mfma_f32_16x16x32_bf16 v[188:191], v[220:223], v[28:31], v[188:191]
    v_exp_f32 v208, v208
    v_mfma_f32_16x16x32_bf16 v[192:195], v[220:223], v[92:95], v[192:195]
    ds_read_b64_tr_b16 v[220:221], v11 offset:40960
    ds_read_b64_tr_b16 v[222:223], v11 offset:41216
    v_exp_f32 v212, v212
    v_mfma_f32_16x16x32_bf16 v[196:199], v[224:227], v[28:31], v[196:199]
    v_exp_f32 v216, v216
    v_mfma_f32_16x16x32_bf16 v[200:203], v[224:227], v[92:95], v[200:203]
    ds_read_b64_tr_b16 v[224:225], v12 offset:40960
    ds_read_b64_tr_b16 v[226:227], v12 offset:41216
    v_exp_f32 v205, v205
    s_waitcnt lgkmcnt(14)
    v_mfma_f32_16x16x32_bf16 v[188:191], v[228:231], v[32:35], v[188:191]
    v_exp_f32 v209, v209
    v_mfma_f32_16x16x32_bf16 v[192:195], v[228:231], v[96:99], v[192:195]
    ds_read_b64_tr_b16 v[228:229], v11 offset:43008
    ds_read_b64_tr_b16 v[230:231], v11 offset:43264
    v_exp_f32 v213, v213
    v_mfma_f32_16x16x32_bf16 v[196:199], v[232:235], v[32:35], v[196:199]
    v_exp_f32 v217, v217
    v_mfma_f32_16x16x32_bf16 v[200:203], v[232:235], v[96:99], v[200:203]
    ds_read_b64_tr_b16 v[232:233], v12 offset:43008
    ds_read_b64_tr_b16 v[234:235], v12 offset:43264
    v_exp_f32 v206, v206
    s_waitcnt lgkmcnt(12)
    v_mfma_f32_16x16x32_bf16 v[188:191], v[236:239], v[36:39], v[188:191]
    v_exp_f32 v210, v210
    v_mfma_f32_16x16x32_bf16 v[192:195], v[236:239], v[100:103], v[192:195]
    ds_read_b64_tr_b16 v[236:237], v11 offset:45056
    ds_read_b64_tr_b16 v[238:239], v11 offset:45312
    v_exp_f32 v214, v214
    v_mfma_f32_16x16x32_bf16 v[196:199], v[240:243], v[36:39], v[196:199]
    v_exp_f32 v218, v218
    v_mfma_f32_16x16x32_bf16 v[200:203], v[240:243], v[100:103], v[200:203]
    ds_read_b64_tr_b16 v[240:241], v12 offset:45056
    ds_read_b64_tr_b16 v[242:243], v12 offset:45312
    v_exp_f32 v207, v207
    s_waitcnt lgkmcnt(12)
    v_mfma_f32_16x16x32_bf16 v[188:191], v[244:247], v[40:43], v[188:191]
    v_exp_f32 v211, v211
    v_mfma_f32_16x16x32_bf16 v[192:195], v[244:247], v[104:107], v[192:195]
    ds_read_b64_tr_b16 v[244:245], v11 offset:47104
    ds_read_b64_tr_b16 v[246:247], v11 offset:47360
    v_exp_f32 v215, v215
    v_mfma_f32_16x16x32_bf16 v[196:199], v[248:251], v[40:43], v[196:199]
    v_exp_f32 v219, v219
    v_mfma_f32_16x16x32_bf16 v[200:203], v[248:251], v[104:107], v[200:203]
    ds_read_b64_tr_b16 v[248:249], v12 offset:47104
    ds_read_b64_tr_b16 v[250:251], v12 offset:47360
    v_pk_fma_f32 v[204:205], v[204:205], v[18:19], v[18:19] op_sel_hi:[1,0,0]
    v_pk_fma_f32 v[208:209], v[208:209], v[18:19], v[18:19] op_sel_hi:[1,0,0]
    v_pk_fma_f32 v[212:213], v[212:213], v[22:23], v[22:23] op_sel_hi:[1,0,0]
    v_pk_fma_f32 v[216:217], v[216:217], v[22:23], v[22:23] op_sel_hi:[1,0,0]
    v_pk_fma_f32 v[206:207], v[206:207], v[18:19], v[18:19] op_sel_hi:[1,0,0]
    v_pk_fma_f32 v[210:211], v[210:211], v[18:19], v[18:19] op_sel_hi:[1,0,0]
    v_pk_fma_f32 v[214:215], v[214:215], v[22:23], v[22:23] op_sel_hi:[1,0,0]
    v_pk_fma_f32 v[218:219], v[218:219], v[22:23], v[22:23] op_sel_hi:[1,0,0]
    v_rcp_f32 v204, v204
    s_waitcnt lgkmcnt(12)
    v_mfma_f32_16x16x32_bf16 v[188:191], v[220:223], v[44:47], v[188:191]
    v_rcp_f32 v208, v208
    v_mfma_f32_16x16x32_bf16 v[192:195], v[220:223], v[108:111], v[192:195]
    ds_read_b64_tr_b16 v[220:221], v11 offset:49152
    ds_read_b64_tr_b16 v[222:223], v11 offset:49408
    v_rcp_f32 v212, v212
    v_mfma_f32_16x16x32_bf16 v[196:199], v[224:227], v[44:47], v[196:199]
    v_rcp_f32 v216, v216
    v_mfma_f32_16x16x32_bf16 v[200:203], v[224:227], v[108:111], v[200:203]
    ds_read_b64_tr_b16 v[224:225], v12 offset:49152
    ds_read_b64_tr_b16 v[226:227], v12 offset:49408
    v_rcp_f32 v205, v205
    s_waitcnt lgkmcnt(12)
    v_mfma_f32_16x16x32_bf16 v[188:191], v[228:231], v[48:51], v[188:191]
    v_rcp_f32 v209, v209
    v_mfma_f32_16x16x32_bf16 v[192:195], v[228:231], v[112:115], v[192:195]
    ds_read_b64_tr_b16 v[228:229], v11 offset:51200
    ds_read_b64_tr_b16 v[230:231], v11 offset:51456
    v_rcp_f32 v213, v213
    v_mfma_f32_16x16x32_bf16 v[196:199], v[232:235], v[48:51], v[196:199]
    v_rcp_f32 v217, v217
    v_mfma_f32_16x16x32_bf16 v[200:203], v[232:235], v[112:115], v[200:203]
    ds_read_b64_tr_b16 v[232:233], v12 offset:51200
    ds_read_b64_tr_b16 v[234:235], v12 offset:51456
    v_rcp_f32 v206, v206
    s_waitcnt lgkmcnt(12)
    v_mfma_f32_16x16x32_bf16 v[188:191], v[236:239], v[52:55], v[188:191]
    v_rcp_f32 v210, v210
    v_mfma_f32_16x16x32_bf16 v[192:195], v[236:239], v[116:119], v[192:195]
    ds_read_b64_tr_b16 v[236:237], v11 offset:53248
    ds_read_b64_tr_b16 v[238:239], v11 offset:53504
    v_rcp_f32 v214, v214
    v_mfma_f32_16x16x32_bf16 v[196:199], v[240:243], v[52:55], v[196:199]
    v_rcp_f32 v218, v218
    v_mfma_f32_16x16x32_bf16 v[200:203], v[240:243], v[116:119], v[200:203]
    ds_read_b64_tr_b16 v[240:241], v12 offset:53248
    ds_read_b64_tr_b16 v[242:243], v12 offset:53504
    v_rcp_f32 v207, v207
    s_waitcnt lgkmcnt(12)
    v_mfma_f32_16x16x32_bf16 v[188:191], v[244:247], v[56:59], v[188:191]
    v_rcp_f32 v211, v211
    v_mfma_f32_16x16x32_bf16 v[192:195], v[244:247], v[120:123], v[192:195]
    ds_read_b64_tr_b16 v[244:245], v11 offset:55296
    ds_read_b64_tr_b16 v[246:247], v11 offset:55552
    v_rcp_f32 v215, v215
    v_mfma_f32_16x16x32_bf16 v[196:199], v[248:251], v[56:59], v[196:199]
    v_rcp_f32 v219, v219
    v_mfma_f32_16x16x32_bf16 v[200:203], v[248:251], v[120:123], v[200:203]
    ds_read_b64_tr_b16 v[248:249], v12 offset:55296
    ds_read_b64_tr_b16 v[250:251], v12 offset:55552
    v_pk_mul_f32 v[204:205], v[204:205], v[156:157]
    v_pk_mul_f32 v[208:209], v[208:209], v[164:165]
    v_pk_mul_f32 v[212:213], v[212:213], v[160:161]
    v_pk_mul_f32 v[216:217], v[216:217], v[168:169]
    v_pk_mul_f32 v[206:207], v[206:207], v[158:159]
    v_pk_mul_f32 v[210:211], v[210:211], v[166:167]
    v_pk_mul_f32 v[214:215], v[214:215], v[162:163]
    v_pk_mul_f32 v[218:219], v[218:219], v[170:171]
    v_cvt_pk_bf16_f32 v156, v204, v205
    v_cvt_pk_bf16_f32 v158, v208, v209
    v_cvt_pk_bf16_f32 v160, v212, v213
    v_cvt_pk_bf16_f32 v162, v216, v217
    v_cvt_pk_bf16_f32 v157, v206, v207
    v_cvt_pk_bf16_f32 v159, v210, v211
    v_cvt_pk_bf16_f32 v161, v214, v215
    v_cvt_pk_bf16_f32 v163, v218, v219
    v_permlane16_swap_b32 v156, v158
    v_permlane16_swap_b32 v157, v159
    v_permlane16_swap_b32 v160, v162
    v_permlane16_swap_b32 v161, v163
    buffer_store_dwordx4 v[156:159], v8, s[16:19], s47 offen offset:0
    buffer_store_dwordx4 v[160:163], v8, s[16:19], s39 offen offset:0
    v_pk_mul_f32 v[204:205], v[172:173], v[172:173]
    v_pk_mul_f32 v[208:209], v[180:181], v[180:181]
    v_pk_mul_f32 v[212:213], v[176:177], v[176:177]
    v_pk_mul_f32 v[216:217], v[184:185], v[184:185]
    v_pk_mul_f32 v[206:207], v[174:175], v[174:175]
    v_pk_mul_f32 v[210:211], v[182:183], v[182:183]
    v_pk_mul_f32 v[214:215], v[178:179], v[178:179]
    v_pk_mul_f32 v[218:219], v[186:187], v[186:187]
    v_pk_fma_f32 v[204:205], v[204:205], v[16:17], v[16:17] op_sel:[0,0,1] op_sel_hi:[1,0,1]
    v_pk_fma_f32 v[208:209], v[208:209], v[16:17], v[16:17] op_sel:[0,0,1] op_sel_hi:[1,0,1]
    v_pk_fma_f32 v[212:213], v[212:213], v[20:21], v[20:21] op_sel:[0,0,1] op_sel_hi:[1,0,1]
    v_pk_fma_f32 v[216:217], v[216:217], v[20:21], v[20:21] op_sel:[0,0,1] op_sel_hi:[1,0,1]
    v_pk_fma_f32 v[206:207], v[206:207], v[16:17], v[16:17] op_sel:[0,0,1] op_sel_hi:[1,0,1]
    v_pk_fma_f32 v[210:211], v[210:211], v[16:17], v[16:17] op_sel:[0,0,1] op_sel_hi:[1,0,1]
    v_pk_fma_f32 v[214:215], v[214:215], v[20:21], v[20:21] op_sel:[0,0,1] op_sel_hi:[1,0,1]
    v_pk_fma_f32 v[218:219], v[218:219], v[20:21], v[20:21] op_sel:[0,0,1] op_sel_hi:[1,0,1]
    v_pk_mul_f32 v[204:205], v[204:205], v[172:173]
    v_pk_mul_f32 v[208:209], v[208:209], v[180:181]
    v_pk_mul_f32 v[212:213], v[212:213], v[176:177]
    v_pk_mul_f32 v[216:217], v[216:217], v[184:185]
    v_pk_mul_f32 v[206:207], v[206:207], v[174:175]
    v_pk_mul_f32 v[210:211], v[210:211], v[182:183]
    v_pk_mul_f32 v[214:215], v[214:215], v[178:179]
    v_pk_mul_f32 v[218:219], v[218:219], v[186:187]
    v_exp_f32 v204, v204
    s_waitcnt lgkmcnt(12)
    v_mfma_f32_16x16x32_bf16 v[188:191], v[220:223], v[60:63], v[188:191]
    v_exp_f32 v208, v208
    v_mfma_f32_16x16x32_bf16 v[192:195], v[220:223], v[124:127], v[192:195]
    ds_read_b64_tr_b16 v[220:221], v11 offset:57344
    ds_read_b64_tr_b16 v[222:223], v11 offset:57600
    v_exp_f32 v212, v212
    v_mfma_f32_16x16x32_bf16 v[196:199], v[224:227], v[60:63], v[196:199]
    v_exp_f32 v216, v216
    v_mfma_f32_16x16x32_bf16 v[200:203], v[224:227], v[124:127], v[200:203]
    ds_read_b64_tr_b16 v[224:225], v12 offset:57344
    ds_read_b64_tr_b16 v[226:227], v12 offset:57600
    v_exp_f32 v205, v205
    s_waitcnt lgkmcnt(12)
    v_mfma_f32_16x16x32_bf16 v[188:191], v[228:231], v[64:67], v[188:191]
    v_exp_f32 v209, v209
    v_mfma_f32_16x16x32_bf16 v[192:195], v[228:231], v[128:131], v[192:195]
    ds_read_b64_tr_b16 v[228:229], v11 offset:59392
    ds_read_b64_tr_b16 v[230:231], v11 offset:59648
    v_exp_f32 v213, v213
    v_mfma_f32_16x16x32_bf16 v[196:199], v[232:235], v[64:67], v[196:199]
    v_exp_f32 v217, v217
    v_mfma_f32_16x16x32_bf16 v[200:203], v[232:235], v[128:131], v[200:203]
    ds_read_b64_tr_b16 v[232:233], v12 offset:59392
    ds_read_b64_tr_b16 v[234:235], v12 offset:59648
    v_exp_f32 v206, v206
    s_waitcnt lgkmcnt(12)
    v_mfma_f32_16x16x32_bf16 v[188:191], v[236:239], v[68:71], v[188:191]
    v_exp_f32 v210, v210
    v_mfma_f32_16x16x32_bf16 v[192:195], v[236:239], v[132:135], v[192:195]
    ds_read_b64_tr_b16 v[236:237], v11 offset:61440
    ds_read_b64_tr_b16 v[238:239], v11 offset:61696
    v_exp_f32 v214, v214
    v_mfma_f32_16x16x32_bf16 v[196:199], v[240:243], v[68:71], v[196:199]
    v_exp_f32 v218, v218
    v_mfma_f32_16x16x32_bf16 v[200:203], v[240:243], v[132:135], v[200:203]
    ds_read_b64_tr_b16 v[240:241], v12 offset:61440
    ds_read_b64_tr_b16 v[242:243], v12 offset:61696
    v_exp_f32 v207, v207
    s_waitcnt lgkmcnt(12)
    v_mfma_f32_16x16x32_bf16 v[188:191], v[244:247], v[72:75], v[188:191]
    v_exp_f32 v211, v211
    v_mfma_f32_16x16x32_bf16 v[192:195], v[244:247], v[136:139], v[192:195]
    ds_read_b64_tr_b16 v[244:245], v11 offset:63488
    ds_read_b64_tr_b16 v[246:247], v11 offset:63744
    v_exp_f32 v215, v215
    v_mfma_f32_16x16x32_bf16 v[196:199], v[248:251], v[72:75], v[196:199]
    v_exp_f32 v219, v219
    v_mfma_f32_16x16x32_bf16 v[200:203], v[248:251], v[136:139], v[200:203]
    ds_read_b64_tr_b16 v[248:249], v12 offset:63488
    ds_read_b64_tr_b16 v[250:251], v12 offset:63744
    v_pk_fma_f32 v[204:205], v[204:205], v[18:19], v[18:19] op_sel_hi:[1,0,0]
    v_pk_fma_f32 v[208:209], v[208:209], v[18:19], v[18:19] op_sel_hi:[1,0,0]
    v_pk_fma_f32 v[212:213], v[212:213], v[22:23], v[22:23] op_sel_hi:[1,0,0]
    v_pk_fma_f32 v[216:217], v[216:217], v[22:23], v[22:23] op_sel_hi:[1,0,0]
    v_pk_fma_f32 v[206:207], v[206:207], v[18:19], v[18:19] op_sel_hi:[1,0,0]
    v_pk_fma_f32 v[210:211], v[210:211], v[18:19], v[18:19] op_sel_hi:[1,0,0]
    v_pk_fma_f32 v[214:215], v[214:215], v[22:23], v[22:23] op_sel_hi:[1,0,0]
    v_pk_fma_f32 v[218:219], v[218:219], v[22:23], v[22:23] op_sel_hi:[1,0,0]
    v_rcp_f32 v204, v204
    s_waitcnt lgkmcnt(12)
    v_mfma_f32_16x16x32_bf16 v[188:191], v[220:223], v[76:79], v[188:191]
    v_rcp_f32 v208, v208
    v_mfma_f32_16x16x32_bf16 v[192:195], v[220:223], v[140:143], v[192:195]
    v_rcp_f32 v212, v212
    v_mfma_f32_16x16x32_bf16 v[196:199], v[224:227], v[76:79], v[196:199]
    v_rcp_f32 v216, v216
    v_mfma_f32_16x16x32_bf16 v[200:203], v[224:227], v[140:143], v[200:203]
    v_rcp_f32 v205, v205
    s_waitcnt lgkmcnt(8)
    v_mfma_f32_16x16x32_bf16 v[188:191], v[228:231], v[80:83], v[188:191]
    v_rcp_f32 v209, v209
    v_mfma_f32_16x16x32_bf16 v[192:195], v[228:231], v[144:147], v[192:195]
    v_rcp_f32 v213, v213
    v_mfma_f32_16x16x32_bf16 v[196:199], v[232:235], v[80:83], v[196:199]
    v_rcp_f32 v217, v217
    v_mfma_f32_16x16x32_bf16 v[200:203], v[232:235], v[144:147], v[200:203]
    v_rcp_f32 v206, v206
    s_waitcnt lgkmcnt(4)
    v_mfma_f32_16x16x32_bf16 v[188:191], v[236:239], v[84:87], v[188:191]
    v_rcp_f32 v210, v210
    v_mfma_f32_16x16x32_bf16 v[192:195], v[236:239], v[148:151], v[192:195]
    v_rcp_f32 v214, v214
    v_mfma_f32_16x16x32_bf16 v[196:199], v[240:243], v[84:87], v[196:199]
    v_rcp_f32 v218, v218
    v_mfma_f32_16x16x32_bf16 v[200:203], v[240:243], v[148:151], v[200:203]
    v_rcp_f32 v207, v207
    s_waitcnt lgkmcnt(0)
    v_mfma_f32_16x16x32_bf16 v[188:191], v[244:247], v[88:91], v[188:191]
    v_rcp_f32 v211, v211
    v_mfma_f32_16x16x32_bf16 v[192:195], v[244:247], v[152:155], v[192:195]
    v_rcp_f32 v215, v215
    v_mfma_f32_16x16x32_bf16 v[196:199], v[248:251], v[88:91], v[196:199]
    v_rcp_f32 v219, v219
    v_mfma_f32_16x16x32_bf16 v[200:203], v[248:251], v[152:155], v[200:203]
    v_pk_mul_f32 v[204:205], v[204:205], v[172:173]
    v_pk_mul_f32 v[208:209], v[208:209], v[180:181]
    v_pk_mul_f32 v[212:213], v[212:213], v[176:177]
    v_pk_mul_f32 v[216:217], v[216:217], v[184:185]
    v_pk_mul_f32 v[206:207], v[206:207], v[174:175]
    v_pk_mul_f32 v[210:211], v[210:211], v[182:183]
    v_pk_mul_f32 v[214:215], v[214:215], v[178:179]
    v_pk_mul_f32 v[218:219], v[218:219], v[186:187]
    v_cvt_pk_bf16_f32 v172, v204, v205
    v_cvt_pk_bf16_f32 v174, v208, v209
    v_cvt_pk_bf16_f32 v176, v212, v213
    v_cvt_pk_bf16_f32 v178, v216, v217
    v_cvt_pk_bf16_f32 v173, v206, v207
    v_cvt_pk_bf16_f32 v175, v210, v211
    v_cvt_pk_bf16_f32 v177, v214, v215
    v_cvt_pk_bf16_f32 v179, v218, v219
    v_permlane16_swap_b32 v172, v174
    v_permlane16_swap_b32 v173, v175
    v_permlane16_swap_b32 v176, v178
    v_permlane16_swap_b32 v177, v179
    buffer_store_dwordx4 v[172:175], v8, s[16:19], s47 offen offset:1024
    buffer_store_dwordx4 v[176:179], v8, s[16:19], s39 offen offset:1024
    v_pk_mul_f32 v[204:205], v[188:189], v[188:189]
    v_pk_mul_f32 v[208:209], v[196:197], v[196:197]
    v_pk_mul_f32 v[212:213], v[192:193], v[192:193]
    v_pk_mul_f32 v[216:217], v[200:201], v[200:201]
    v_pk_mul_f32 v[206:207], v[190:191], v[190:191]
    v_pk_mul_f32 v[210:211], v[198:199], v[198:199]
    v_pk_mul_f32 v[214:215], v[194:195], v[194:195]
    v_pk_mul_f32 v[218:219], v[202:203], v[202:203]
    v_pk_fma_f32 v[204:205], v[204:205], v[16:17], v[16:17] op_sel:[0,0,1] op_sel_hi:[1,0,1]
    v_pk_fma_f32 v[208:209], v[208:209], v[16:17], v[16:17] op_sel:[0,0,1] op_sel_hi:[1,0,1]
    v_pk_fma_f32 v[212:213], v[212:213], v[20:21], v[20:21] op_sel:[0,0,1] op_sel_hi:[1,0,1]
    v_pk_fma_f32 v[216:217], v[216:217], v[20:21], v[20:21] op_sel:[0,0,1] op_sel_hi:[1,0,1]
    v_pk_fma_f32 v[206:207], v[206:207], v[16:17], v[16:17] op_sel:[0,0,1] op_sel_hi:[1,0,1]
    v_pk_fma_f32 v[210:211], v[210:211], v[16:17], v[16:17] op_sel:[0,0,1] op_sel_hi:[1,0,1]
    v_pk_fma_f32 v[214:215], v[214:215], v[20:21], v[20:21] op_sel:[0,0,1] op_sel_hi:[1,0,1]
    v_pk_fma_f32 v[218:219], v[218:219], v[20:21], v[20:21] op_sel:[0,0,1] op_sel_hi:[1,0,1]
    v_pk_mul_f32 v[204:205], v[204:205], v[188:189]
    v_pk_mul_f32 v[208:209], v[208:209], v[196:197]
    v_pk_mul_f32 v[212:213], v[212:213], v[192:193]
    v_pk_mul_f32 v[216:217], v[216:217], v[200:201]
    v_pk_mul_f32 v[206:207], v[206:207], v[190:191]
    v_pk_mul_f32 v[210:211], v[210:211], v[198:199]
    v_pk_mul_f32 v[214:215], v[214:215], v[194:195]
    v_pk_mul_f32 v[218:219], v[218:219], v[202:203]
    v_exp_f32 v204, v204
    v_exp_f32 v208, v208
    v_exp_f32 v212, v212
    v_exp_f32 v216, v216
    v_exp_f32 v205, v205
    v_exp_f32 v209, v209
    v_exp_f32 v213, v213
    v_exp_f32 v217, v217
    v_exp_f32 v206, v206
    v_exp_f32 v210, v210
    v_exp_f32 v214, v214
    v_exp_f32 v218, v218
    v_exp_f32 v207, v207
    v_exp_f32 v211, v211
    v_exp_f32 v215, v215
    v_exp_f32 v219, v219
    v_pk_fma_f32 v[204:205], v[204:205], v[18:19], v[18:19] op_sel_hi:[1,0,0]
    v_pk_fma_f32 v[208:209], v[208:209], v[18:19], v[18:19] op_sel_hi:[1,0,0]
    v_pk_fma_f32 v[212:213], v[212:213], v[22:23], v[22:23] op_sel_hi:[1,0,0]
    v_pk_fma_f32 v[216:217], v[216:217], v[22:23], v[22:23] op_sel_hi:[1,0,0]
    v_pk_fma_f32 v[206:207], v[206:207], v[18:19], v[18:19] op_sel_hi:[1,0,0]
    v_pk_fma_f32 v[210:211], v[210:211], v[18:19], v[18:19] op_sel_hi:[1,0,0]
    v_pk_fma_f32 v[214:215], v[214:215], v[22:23], v[22:23] op_sel_hi:[1,0,0]
    v_pk_fma_f32 v[218:219], v[218:219], v[22:23], v[22:23] op_sel_hi:[1,0,0]
    v_rcp_f32 v204, v204
    v_rcp_f32 v208, v208
    v_rcp_f32 v212, v212
    v_rcp_f32 v216, v216
    v_rcp_f32 v205, v205
    v_rcp_f32 v209, v209
    v_rcp_f32 v213, v213
    v_rcp_f32 v217, v217
    v_rcp_f32 v206, v206
    v_rcp_f32 v210, v210
    v_rcp_f32 v214, v214
    v_rcp_f32 v218, v218
    v_rcp_f32 v207, v207
    v_rcp_f32 v211, v211
    v_rcp_f32 v215, v215
    v_rcp_f32 v219, v219
    v_pk_mul_f32 v[204:205], v[204:205], v[188:189]
    v_pk_mul_f32 v[208:209], v[208:209], v[196:197]
    v_pk_mul_f32 v[212:213], v[212:213], v[192:193]
    v_pk_mul_f32 v[216:217], v[216:217], v[200:201]
    v_pk_mul_f32 v[206:207], v[206:207], v[190:191]
    v_pk_mul_f32 v[210:211], v[210:211], v[198:199]
    v_pk_mul_f32 v[214:215], v[214:215], v[194:195]
    v_pk_mul_f32 v[218:219], v[218:219], v[202:203]
    v_cvt_pk_bf16_f32 v188, v204, v205
    v_cvt_pk_bf16_f32 v190, v208, v209
    v_cvt_pk_bf16_f32 v192, v212, v213
    v_cvt_pk_bf16_f32 v194, v216, v217
    v_cvt_pk_bf16_f32 v189, v206, v207
    v_cvt_pk_bf16_f32 v191, v210, v211
    v_cvt_pk_bf16_f32 v193, v214, v215
    v_cvt_pk_bf16_f32 v195, v218, v219
    v_permlane16_swap_b32 v188, v190
    v_permlane16_swap_b32 v189, v191
    v_permlane16_swap_b32 v192, v194
    v_permlane16_swap_b32 v193, v195
    buffer_store_dwordx4 v[188:191], v8, s[16:19], s47 offen offset:2048
    buffer_store_dwordx4 v[192:195], v8, s[16:19], s39 offen offset:2048
    s_mov_b32 s46, s92
    s_mul_i32 s45, s46, 2752
    s_lshl_b32 s47, s46, 10
    s_lshl_b32 s37, s34, 11
    s_add_u32 s47, s47, s37
    v_and_b32 v14, 3, v2
    v_lshrrev_b32 v13, 2, v2
    v_and_b32 v13, 3, v13
    v_lshlrev_b32 v13, 6, v13
    v_lshl_add_u32 v13, v14, 3, v13
    v_lshl_add_u32 v13, v3, 9, v13
    v_and_b32 v14, 1, v3
    v_lshl_add_u32 v11, v14, 5, v13
    v_xor_b32 v14, 1, v14
    v_lshl_add_u32 v12, v14, 5, v13
    v_add_u32 v14, 0x10000, v11
    v_add_u32 v13, 0x10000, v12
    v_add_u32 v15, 0x20000, v11
    v_add_u32 v16, 0x20000, v12
    v_add_u32 v208, s46, v4
    v_lshlrev_b32 v208, 10, v208
    v_and_b32 v209, 1, v3
    v_lshl_add_u32 v208, v209, 5, v208
    v_lshrrev_b32 v209, 1, v3
    v_lshl_add_u32 v208, v209, 4, v208
    s_lshl_b32 s37, s34, 7
    v_add_u32 v208, s37, v208
    v_mul_u32_u24 v209, 43, v2
    v_lshrrev_b32 v209, 4, v209
    v_min_u32 v209, 40, v209
    v_add_u32 v209, 2, v209
    v_lshlrev_b32 v209, 10, v209
    s_add_u32 s8, s60, 0xc00000
    s_addc_u32 s9, s61, 0
    s_mov_b32 s10, 0x560000
    s_mov_b32 s11, 0x00020000
    s_add_u32 s16, s60, 0x2000000
    s_addc_u32 s17, s61, 0
    s_mov_b32 s18, 0x200000
    s_mov_b32 s19, 0x00020000
    s_add_u32 s20, s60, 0x200000
    s_addc_u32 s21, s61, 0
    s_mov_b32 s22, 0x200000
    s_mov_b32 s23, 0x00020000
    s_add_u32 s24, s60, 0xa00000
    s_addc_u32 s25, s61, 0
    s_mov_b32 s26, 0x200000
    s_mov_b32 s27, 0x00020000
    s_add_u32 s52, s60, 0x3200000
    s_addc_u32 s53, s61, 0
    s_mov_b32 s54, 0x20000
    s_mov_b32 s55, 0x00020000
    s_mov_b32 s48, s82
    s_mov_b32 s49, s83
    s_mov_b32 s50, 0x200000
    s_mov_b32 s51, 0x00020000
    buffer_load_dwordx4 v[176:179], v8, s[20:23], s47 offen offset:0
    buffer_load_dwordx4 v[180:183], v8, s[20:23], s47 offen offset:1024
    buffer_load_dwordx4 v[184:187], v8, s[24:27], s47 offen offset:0
    buffer_load_dwordx4 v[188:191], v8, s[24:27], s47 offen offset:1024
    s_barrier
    ds_read_b64_tr_b16 v[212:213], v14 offset:0
    ds_read_b64_tr_b16 v[214:215], v14 offset:256
    ds_read_b64_tr_b16 v[216:217], v13 offset:0
    ds_read_b64_tr_b16 v[218:219], v13 offset:256
    ds_read_b64_tr_b16 v[220:221], v14 offset:16384
    ds_read_b64_tr_b16 v[222:223], v14 offset:16640
    ds_read_b64_tr_b16 v[224:225], v13 offset:16384
    ds_read_b64_tr_b16 v[226:227], v13 offset:16640
    ds_read_b64_tr_b16 v[228:229], v14 offset:2048
    ds_read_b64_tr_b16 v[230:231], v14 offset:2304
    ds_read_b64_tr_b16 v[232:233], v13 offset:2048
    ds_read_b64_tr_b16 v[234:235], v13 offset:2304
    ds_read_b64_tr_b16 v[236:237], v14 offset:18432
    ds_read_b64_tr_b16 v[238:239], v14 offset:18688
    ds_read_b64_tr_b16 v[240:241], v13 offset:18432
    ds_read_b64_tr_b16 v[242:243], v13 offset:18688
    s_waitcnt vmcnt(0)
    v_permlane16_swap_b32 v176, v178
    v_permlane16_swap_b32 v177, v179
    v_permlane16_swap_b32 v184, v186
    v_permlane16_swap_b32 v185, v187
    v_permlane16_swap_b32 v180, v182
    v_permlane16_swap_b32 v181, v183
    v_permlane16_swap_b32 v188, v190
    v_permlane16_swap_b32 v189, v191
    v_lshlrev_b32 v192, 16, v184
    v_lshlrev_b32 v196, 16, v186
    v_lshlrev_b32 v200, 16, v188
    v_lshlrev_b32 v204, 16, v190
    v_and_b32 v193, 0xffff0000, v184
    v_and_b32 v197, 0xffff0000, v186
    v_and_b32 v201, 0xffff0000, v188
    v_and_b32 v205, 0xffff0000, v190
    v_lshlrev_b32 v194, 16, v185
    v_lshlrev_b32 v198, 16, v187
    v_lshlrev_b32 v202, 16, v189
    v_lshlrev_b32 v206, 16, v191
    v_and_b32 v195, 0xffff0000, v185
    v_and_b32 v199, 0xffff0000, v187
    v_and_b32 v203, 0xffff0000, v189
    v_and_b32 v207, 0xffff0000, v191
    v_lshlrev_b32 v140, 16, v176
    v_lshlrev_b32 v144, 16, v178
    v_lshlrev_b32 v148, 16, v180
    v_lshlrev_b32 v152, 16, v182
    v_and_b32 v141, 0xffff0000, v176
    v_and_b32 v145, 0xffff0000, v178
    v_and_b32 v149, 0xffff0000, v180
    v_and_b32 v153, 0xffff0000, v182
    v_lshlrev_b32 v142, 16, v177
    v_lshlrev_b32 v146, 16, v179
    v_lshlrev_b32 v150, 16, v181
    v_lshlrev_b32 v154, 16, v183
    v_and_b32 v143, 0xffff0000, v177
    v_and_b32 v147, 0xffff0000, v179
    v_and_b32 v151, 0xffff0000, v181
    v_and_b32 v155, 0xffff0000, v183
    v_pk_add_f32 v[192:193], v[192:193], v[140:141]
    v_pk_add_f32 v[196:197], v[196:197], v[144:145]
    v_pk_add_f32 v[200:201], v[200:201], v[148:149]
    v_pk_add_f32 v[204:205], v[204:205], v[152:153]
    v_pk_add_f32 v[194:195], v[194:195], v[142:143]
    v_pk_add_f32 v[198:199], v[198:199], v[146:147]
    v_pk_add_f32 v[202:203], v[202:203], v[150:151]
    v_pk_add_f32 v[206:207], v[206:207], v[154:155]
    s_add_u32 s38, s45, 0x0
    buffer_load_dwordx4 v[20:23], v5, s[8:11], s38 offen offset:0 sc1
    buffer_load_dwordx4 v[24:27], v5, s[8:11], s38 offen offset:1024 sc1
    buffer_load_dwordx4 v[28:31], v5, s[8:11], s38 offen offset:2048 sc1
    buffer_load_dwordx4 v[32:35], v5, s[8:11], s38 offen offset:3072 sc1
    s_add_u32 s38, s45, 0x1000
    buffer_load_dwordx4 v[36:39], v5, s[8:11], s38 offen offset:0 sc1
    buffer_load_dwordx4 v[40:43], v5, s[8:11], s38 offen offset:1024 sc1
    buffer_load_dwordx4 v[44:47], v5, s[8:11], s38 offen offset:2048 sc1
    buffer_load_dwordx4 v[48:51], v5, s[8:11], s38 offen offset:3072 sc1
    s_add_u32 s38, s45, 0x2000
    buffer_load_dwordx4 v[52:55], v5, s[8:11], s38 offen offset:0 sc1
    buffer_load_dwordx4 v[56:59], v5, s[8:11], s38 offen offset:1024 sc1
    buffer_load_dwordx4 v[60:63], v5, s[8:11], s38 offen offset:2048 sc1
    buffer_load_dwordx4 v[64:67], v5, s[8:11], s38 offen offset:3072 sc1
    s_waitcnt vmcnt(11)
    v_cmp_eq_u32 vcc, -1, v23
    s_cbranch_vccnz L_rt42_main_kernel
L_ok42_main_kernel:
    s_waitcnt lgkmcnt(8)
    v_mfma_f32_16x16x32_bf16 v[192:195], v[212:215], v[20:23], v[192:195]
    s_add_u32 s38, s45, 0x3000
    buffer_load_dwordx4 v[68:71], v5, s[8:11], s38 offen offset:0 sc1
    ds_read_b64_tr_b16 v[212:213], v14 offset:4096
    ds_read_b64_tr_b16 v[214:215], v14 offset:4352
    v_mfma_f32_16x16x32_bf16 v[196:199], v[216:219], v[20:23], v[196:199]
    s_waitcnt vmcnt(9)
    v_max3_u32 v7, v27, v31, v35
    v_cmp_eq_u32 vcc, -1, v7
    ds_read_b64_tr_b16 v[216:217], v13 offset:4096
    ds_read_b64_tr_b16 v[218:219], v13 offset:4352
    v_mfma_f32_16x16x32_bf16 v[200:203], v[220:223], v[20:23], v[200:203]
    s_cbranch_vccnz L_rt43_main_kernel
L_ok43_main_kernel:
    ds_read_b64_tr_b16 v[220:221], v14 offset:20480
    ds_read_b64_tr_b16 v[222:223], v14 offset:20736
    v_mfma_f32_16x16x32_bf16 v[204:207], v[224:227], v[20:23], v[204:207]
    ds_read_b64_tr_b16 v[224:225], v13 offset:20480
    ds_read_b64_tr_b16 v[226:227], v13 offset:20736
    s_waitcnt lgkmcnt(8)
    v_mfma_f32_16x16x32_bf16 v[192:195], v[228:231], v[24:27], v[192:195]
    buffer_load_dwordx4 v[72:75], v5, s[8:11], s38 offen offset:1024 sc1
    ds_read_b64_tr_b16 v[228:229], v14 offset:6144
    ds_read_b64_tr_b16 v[230:231], v14 offset:6400
    v_mfma_f32_16x16x32_bf16 v[196:199], v[232:235], v[24:27], v[196:199]
    ds_read_b64_tr_b16 v[232:233], v13 offset:6144
    ds_read_b64_tr_b16 v[234:235], v13 offset:6400
    v_mfma_f32_16x16x32_bf16 v[200:203], v[236:239], v[24:27], v[200:203]
    ds_read_b64_tr_b16 v[236:237], v14 offset:22528
    ds_read_b64_tr_b16 v[238:239], v14 offset:22784
    v_mfma_f32_16x16x32_bf16 v[204:207], v[240:243], v[24:27], v[204:207]
    ds_read_b64_tr_b16 v[240:241], v13 offset:22528
    ds_read_b64_tr_b16 v[242:243], v13 offset:22784
    s_waitcnt lgkmcnt(8)
    v_mfma_f32_16x16x32_bf16 v[192:195], v[212:215], v[28:31], v[192:195]
    buffer_load_dwordx4 v[76:79], v5, s[8:11], s38 offen offset:2048 sc1
    ds_read_b64_tr_b16 v[212:213], v14 offset:8192
    ds_read_b64_tr_b16 v[214:215], v14 offset:8448
    v_mfma_f32_16x16x32_bf16 v[196:199], v[216:219], v[28:31], v[196:199]
    ds_read_b64_tr_b16 v[216:217], v13 offset:8192
    ds_read_b64_tr_b16 v[218:219], v13 offset:8448
    v_mfma_f32_16x16x32_bf16 v[200:203], v[220:223], v[28:31], v[200:203]
    ds_read_b64_tr_b16 v[220:221], v14 offset:24576
    ds_read_b64_tr_b16 v[222:223], v14 offset:24832
    v_mfma_f32_16x16x32_bf16 v[204:207], v[224:227], v[28:31], v[204:207]
    ds_read_b64_tr_b16 v[224:225], v13 offset:24576
    ds_read_b64_tr_b16 v[226:227], v13 offset:24832
    s_waitcnt lgkmcnt(8)
    v_mfma_f32_16x16x32_bf16 v[192:195], v[228:231], v[32:35], v[192:195]
    buffer_load_dwordx4 v[80:83], v5, s[8:11], s38 offen offset:3072 sc1
    ds_read_b64_tr_b16 v[228:229], v14 offset:10240
    ds_read_b64_tr_b16 v[230:231], v14 offset:10496
    v_mfma_f32_16x16x32_bf16 v[196:199], v[232:235], v[32:35], v[196:199]
    s_waitcnt vmcnt(9)
    v_max3_u32 v7, v39, v43, v47
    v_cmp_eq_u32 vcc, -1, v7
    ds_read_b64_tr_b16 v[232:233], v13 offset:10240
    ds_read_b64_tr_b16 v[234:235], v13 offset:10496
    v_mfma_f32_16x16x32_bf16 v[200:203], v[236:239], v[32:35], v[200:203]
    s_cbranch_vccnz L_rt44_main_kernel
L_ok44_main_kernel:
    ds_read_b64_tr_b16 v[236:237], v14 offset:26624
    ds_read_b64_tr_b16 v[238:239], v14 offset:26880
    v_mfma_f32_16x16x32_bf16 v[204:207], v[240:243], v[32:35], v[204:207]
    ds_read_b64_tr_b16 v[240:241], v13 offset:26624
    ds_read_b64_tr_b16 v[242:243], v13 offset:26880
    s_waitcnt lgkmcnt(8)
    v_mfma_f32_16x16x32_bf16 v[192:195], v[212:215], v[36:39], v[192:195]
    s_add_u32 s38, s45, 0x4000
    buffer_load_dwordx4 v[84:87], v5, s[8:11], s38 offen offset:0 sc1
    ds_read_b64_tr_b16 v[212:213], v14 offset:12288
    ds_read_b64_tr_b16 v[214:215], v14 offset:12544
    v_mfma_f32_16x16x32_bf16 v[196:199], v[216:219], v[36:39], v[196:199]
    ds_read_b64_tr_b16 v[216:217], v13 offset:12288
    ds_read_b64_tr_b16 v[218:219], v13 offset:12544
    v_mfma_f32_16x16x32_bf16 v[200:203], v[220:223], v[36:39], v[200:203]
    ds_read_b64_tr_b16 v[220:221], v14 offset:28672
    ds_read_b64_tr_b16 v[222:223], v14 offset:28928
    v_mfma_f32_16x16x32_bf16 v[204:207], v[224:227], v[36:39], v[204:207]
    ds_read_b64_tr_b16 v[224:225], v13 offset:28672
    ds_read_b64_tr_b16 v[226:227], v13 offset:28928
    s_waitcnt lgkmcnt(8)
    v_mfma_f32_16x16x32_bf16 v[192:195], v[228:231], v[40:43], v[192:195]
    buffer_load_dwordx4 v[88:91], v5, s[8:11], s38 offen offset:1024 sc1
    ds_read_b64_tr_b16 v[228:229], v14 offset:14336
    ds_read_b64_tr_b16 v[230:231], v14 offset:14592
    v_mfma_f32_16x16x32_bf16 v[196:199], v[232:235], v[40:43], v[196:199]
    ds_read_b64_tr_b16 v[232:233], v13 offset:14336
    ds_read_b64_tr_b16 v[234:235], v13 offset:14592
    v_mfma_f32_16x16x32_bf16 v[200:203], v[236:239], v[40:43], v[200:203]
    ds_read_b64_tr_b16 v[236:237], v14 offset:30720
    ds_read_b64_tr_b16 v[238:239], v14 offset:30976
    v_mfma_f32_16x16x32_bf16 v[204:207], v[240:243], v[40:43], v[204:207]
    ds_read_b64_tr_b16 v[240:241], v13 offset:30720
    ds_read_b64_tr_b16 v[242:243], v13 offset:30976
    s_waitcnt lgkmcnt(8)
    v_mfma_f32_16x16x32_bf16 v[192:195], v[212:215], v[44:47], v[192:195]
    buffer_load_dwordx4 v[92:95], v5, s[8:11], s38 offen offset:2048 sc1
    ds_read_b64_tr_b16 v[212:213], v14 offset:32768
    ds_read_b64_tr_b16 v[214:215], v14 offset:33024
    v_mfma_f32_16x16x32_bf16 v[196:199], v[216:219], v[44:47], v[196:199]
    s_waitcnt vmcnt(9)
    v_max3_u32 v7, v51, v55, v59
    v_cmp_eq_u32 vcc, -1, v7
    ds_read_b64_tr_b16 v[216:217], v13 offset:32768
    ds_read_b64_tr_b16 v[218:219], v13 offset:33024
    v_mfma_f32_16x16x32_bf16 v[200:203], v[220:223], v[44:47], v[200:203]
    s_cbranch_vccnz L_rt45_main_kernel
L_ok45_main_kernel:
    ds_read_b64_tr_b16 v[220:221], v14 offset:49152
    ds_read_b64_tr_b16 v[222:223], v14 offset:49408
    v_mfma_f32_16x16x32_bf16 v[204:207], v[224:227], v[44:47], v[204:207]
    ds_read_b64_tr_b16 v[224:225], v13 offset:49152
    ds_read_b64_tr_b16 v[226:227], v13 offset:49408
    s_waitcnt lgkmcnt(8)
    v_mfma_f32_16x16x32_bf16 v[192:195], v[228:231], v[48:51], v[192:195]
    buffer_load_dwordx4 v[96:99], v5, s[8:11], s38 offen offset:3072 sc1
    ds_read_b64_tr_b16 v[228:229], v14 offset:34816
    ds_read_b64_tr_b16 v[230:231], v14 offset:35072
    v_mfma_f32_16x16x32_bf16 v[196:199], v[232:235], v[48:51], v[196:199]
    ds_read_b64_tr_b16 v[232:233], v13 offset:34816
    ds_read_b64_tr_b16 v[234:235], v13 offset:35072
    v_mfma_f32_16x16x32_bf16 v[200:203], v[236:239], v[48:51], v[200:203]
    ds_read_b64_tr_b16 v[236:237], v14 offset:51200
    ds_read_b64_tr_b16 v[238:239], v14 offset:51456
    v_mfma_f32_16x16x32_bf16 v[204:207], v[240:243], v[48:51], v[204:207]
    ds_read_b64_tr_b16 v[240:241], v13 offset:51200
    ds_read_b64_tr_b16 v[242:243], v13 offset:51456
    s_barrier
    s_waitcnt lgkmcnt(8)
    v_mfma_f32_16x16x32_bf16 v[192:195], v[212:215], v[52:55], v[192:195]
    s_add_u32 s38, s45, 0x5000
    buffer_load_dwordx4 v[100:103], v5, s[8:11], s38 offen offset:0 sc1
    ds_read_b64_tr_b16 v[212:213], v14 offset:36864
    ds_read_b64_tr_b16 v[214:215], v14 offset:37120
    v_mfma_f32_16x16x32_bf16 v[196:199], v[216:219], v[52:55], v[196:199]
    ds_read_b64_tr_b16 v[216:217], v13 offset:36864
    ds_read_b64_tr_b16 v[218:219], v13 offset:37120
    v_mfma_f32_16x16x32_bf16 v[200:203], v[220:223], v[52:55], v[200:203]
    ds_read_b64_tr_b16 v[220:221], v14 offset:53248
    ds_read_b64_tr_b16 v[222:223], v14 offset:53504
    v_mfma_f32_16x16x32_bf16 v[204:207], v[224:227], v[52:55], v[204:207]
    ds_read_b64_tr_b16 v[224:225], v13 offset:53248
    ds_read_b64_tr_b16 v[226:227], v13 offset:53504
    s_waitcnt lgkmcnt(8)
    v_mfma_f32_16x16x32_bf16 v[192:195], v[228:231], v[56:59], v[192:195]
    buffer_load_dwordx4 v[104:107], v5, s[8:11], s38 offen offset:1024 sc1
    ds_read_b64_tr_b16 v[228:229], v14 offset:38912
    ds_read_b64_tr_b16 v[230:231], v14 offset:39168
    v_mfma_f32_16x16x32_bf16 v[196:199], v[232:235], v[56:59], v[196:199]
    s_waitcnt vmcnt(9)
    v_max3_u32 v7, v63, v67, v71
    v_cmp_eq_u32 vcc, -1, v7
    ds_read_b64_tr_b16 v[232:233], v13 offset:38912
    ds_read_b64_tr_b16 v[234:235], v13 offset:39168
    v_mfma_f32_16x16x32_bf16 v[200:203], v[236:239], v[56:59], v[200:203]
    s_cbranch_vccnz L_rt46_main_kernel
L_ok46_main_kernel:
    ds_read_b64_tr_b16 v[236:237], v14 offset:55296
    ds_read_b64_tr_b16 v[238:239], v14 offset:55552
    v_mfma_f32_16x16x32_bf16 v[204:207], v[240:243], v[56:59], v[204:207]
    ds_read_b64_tr_b16 v[240:241], v13 offset:55296
    ds_read_b64_tr_b16 v[242:243], v13 offset:55552
    s_waitcnt lgkmcnt(8)
    v_mfma_f32_16x16x32_bf16 v[192:195], v[212:215], v[60:63], v[192:195]
    buffer_load_dwordx4 v[108:111], v5, s[8:11], s38 offen offset:2048 sc1
    ds_read_b64_tr_b16 v[212:213], v14 offset:40960
    ds_read_b64_tr_b16 v[214:215], v14 offset:41216
    v_mfma_f32_16x16x32_bf16 v[196:199], v[216:219], v[60:63], v[196:199]
    ds_read_b64_tr_b16 v[216:217], v13 offset:40960
    ds_read_b64_tr_b16 v[218:219], v13 offset:41216
    v_mfma_f32_16x16x32_bf16 v[200:203], v[220:223], v[60:63], v[200:203]
    ds_read_b64_tr_b16 v[220:221], v14 offset:57344
    ds_read_b64_tr_b16 v[222:223], v14 offset:57600
    v_mfma_f32_16x16x32_bf16 v[204:207], v[224:227], v[60:63], v[204:207]
    ds_read_b64_tr_b16 v[224:225], v13 offset:57344
    ds_read_b64_tr_b16 v[226:227], v13 offset:57600
    s_waitcnt lgkmcnt(8)
    v_mfma_f32_16x16x32_bf16 v[192:195], v[228:231], v[64:67], v[192:195]
    buffer_load_dwordx4 v[112:115], v5, s[8:11], s38 offen offset:3072 sc1
    ds_read_b64_tr_b16 v[228:229], v14 offset:43008
    ds_read_b64_tr_b16 v[230:231], v14 offset:43264
    v_mfma_f32_16x16x32_bf16 v[196:199], v[232:235], v[64:67], v[196:199]
    ds_read_b64_tr_b16 v[232:233], v13 offset:43008
    ds_read_b64_tr_b16 v[234:235], v13 offset:43264
    v_mfma_f32_16x16x32_bf16 v[200:203], v[236:239], v[64:67], v[200:203]
    ds_read_b64_tr_b16 v[236:237], v14 offset:59392
    ds_read_b64_tr_b16 v[238:239], v14 offset:59648
    v_mfma_f32_16x16x32_bf16 v[204:207], v[240:243], v[64:67], v[204:207]
    ds_read_b64_tr_b16 v[240:241], v13 offset:59392
    ds_read_b64_tr_b16 v[242:243], v13 offset:59648
    s_waitcnt lgkmcnt(8)
    v_mfma_f32_16x16x32_bf16 v[192:195], v[212:215], v[68:71], v[192:195]
    s_add_u32 s38, s45, 0x6000
    buffer_load_dwordx4 v[116:119], v5, s[8:11], s38 offen offset:0 sc1
    ds_read_b64_tr_b16 v[212:213], v14 offset:45056
    ds_read_b64_tr_b16 v[214:215], v14 offset:45312
    v_mfma_f32_16x16x32_bf16 v[196:199], v[216:219], v[68:71], v[196:199]
    s_waitcnt vmcnt(9)
    v_max3_u32 v7, v75, v79, v83
    v_cmp_eq_u32 vcc, -1, v7
    ds_read_b64_tr_b16 v[216:217], v13 offset:45056
    ds_read_b64_tr_b16 v[218:219], v13 offset:45312
    v_mfma_f32_16x16x32_bf16 v[200:203], v[220:223], v[68:71], v[200:203]
    s_cbranch_vccnz L_rt47_main_kernel
L_ok47_main_kernel:
    ds_read_b64_tr_b16 v[220:221], v14 offset:61440
    ds_read_b64_tr_b16 v[222:223], v14 offset:61696
    v_mfma_f32_16x16x32_bf16 v[204:207], v[224:227], v[68:71], v[204:207]
    ds_read_b64_tr_b16 v[224:225], v13 offset:61440
    ds_read_b64_tr_b16 v[226:227], v13 offset:61696
    s_waitcnt lgkmcnt(8)
    v_mfma_f32_16x16x32_bf16 v[192:195], v[228:231], v[72:75], v[192:195]
    buffer_load_dwordx4 v[120:123], v5, s[8:11], s38 offen offset:1024 sc1
    ds_read_b64_tr_b16 v[228:229], v14 offset:47104
    ds_read_b64_tr_b16 v[230:231], v14 offset:47360
    v_mfma_f32_16x16x32_bf16 v[196:199], v[232:235], v[72:75], v[196:199]
    ds_read_b64_tr_b16 v[232:233], v13 offset:47104
    ds_read_b64_tr_b16 v[234:235], v13 offset:47360
    v_mfma_f32_16x16x32_bf16 v[200:203], v[236:239], v[72:75], v[200:203]
    ds_read_b64_tr_b16 v[236:237], v14 offset:63488
    ds_read_b64_tr_b16 v[238:239], v14 offset:63744
    v_mfma_f32_16x16x32_bf16 v[204:207], v[240:243], v[72:75], v[204:207]
    ds_read_b64_tr_b16 v[240:241], v13 offset:63488
    ds_read_b64_tr_b16 v[242:243], v13 offset:63744
    s_waitcnt lgkmcnt(8)
    v_mfma_f32_16x16x32_bf16 v[192:195], v[212:215], v[76:79], v[192:195]
    buffer_load_dwordx4 v[124:127], v5, s[8:11], s38 offen offset:2048 sc1
    ds_read_b64_tr_b16 v[212:213], v11 offset:0
    ds_read_b64_tr_b16 v[214:215], v11 offset:256
    v_mfma_f32_16x16x32_bf16 v[196:199], v[216:219], v[76:79], v[196:199]
    ds_read_b64_tr_b16 v[216:217], v12 offset:0
    ds_read_b64_tr_b16 v[218:219], v12 offset:256
    v_mfma_f32_16x16x32_bf16 v[200:203], v[220:223], v[76:79], v[200:203]
    ds_read_b64_tr_b16 v[220:221], v11 offset:16384
    ds_read_b64_tr_b16 v[222:223], v11 offset:16640
    v_mfma_f32_16x16x32_bf16 v[204:207], v[224:227], v[76:79], v[204:207]
    ds_read_b64_tr_b16 v[224:225], v12 offset:16384
    ds_read_b64_tr_b16 v[226:227], v12 offset:16640
    s_waitcnt lgkmcnt(8)
    v_mfma_f32_16x16x32_bf16 v[192:195], v[228:231], v[80:83], v[192:195]
    buffer_load_dwordx4 v[128:131], v5, s[8:11], s38 offen offset:3072 sc1
    ds_read_b64_tr_b16 v[228:229], v11 offset:2048
    ds_read_b64_tr_b16 v[230:231], v11 offset:2304
    v_mfma_f32_16x16x32_bf16 v[196:199], v[232:235], v[80:83], v[196:199]
    s_waitcnt vmcnt(9)
    v_max3_u32 v7, v87, v91, v95
    v_cmp_eq_u32 vcc, -1, v7
    ds_read_b64_tr_b16 v[232:233], v12 offset:2048
    ds_read_b64_tr_b16 v[234:235], v12 offset:2304
    v_mfma_f32_16x16x32_bf16 v[200:203], v[236:239], v[80:83], v[200:203]
    s_cbranch_vccnz L_rt48_main_kernel
L_ok48_main_kernel:
    ds_read_b64_tr_b16 v[236:237], v11 offset:18432
    ds_read_b64_tr_b16 v[238:239], v11 offset:18688
    v_mfma_f32_16x16x32_bf16 v[204:207], v[240:243], v[80:83], v[204:207]
    ds_read_b64_tr_b16 v[240:241], v12 offset:18432
    ds_read_b64_tr_b16 v[242:243], v12 offset:18688
    s_barrier
    s_waitcnt lgkmcnt(8)
    v_mfma_f32_16x16x32_bf16 v[192:195], v[212:215], v[84:87], v[192:195]
    s_add_u32 s38, s45, 0x7000
    buffer_load_dwordx4 v[132:135], v5, s[8:11], s38 offen offset:0 sc1
    ds_read_b64_tr_b16 v[212:213], v11 offset:4096
    ds_read_b64_tr_b16 v[214:215], v11 offset:4352
    v_mfma_f32_16x16x32_bf16 v[196:199], v[216:219], v[84:87], v[196:199]
    ds_read_b64_tr_b16 v[216:217], v12 offset:4096
    ds_read_b64_tr_b16 v[218:219], v12 offset:4352
    v_mfma_f32_16x16x32_bf16 v[200:203], v[220:223], v[84:87], v[200:203]
    ds_read_b64_tr_b16 v[220:221], v11 offset:20480
    ds_read_b64_tr_b16 v[222:223], v11 offset:20736
    v_mfma_f32_16x16x32_bf16 v[204:207], v[224:227], v[84:87], v[204:207]
    ds_read_b64_tr_b16 v[224:225], v12 offset:20480
    ds_read_b64_tr_b16 v[226:227], v12 offset:20736
    s_waitcnt lgkmcnt(8)
    v_mfma_f32_16x16x32_bf16 v[192:195], v[228:231], v[88:91], v[192:195]
    buffer_load_dwordx4 v[136:139], v5, s[8:11], s38 offen offset:1024 sc1
    ds_read_b64_tr_b16 v[228:229], v11 offset:6144
    ds_read_b64_tr_b16 v[230:231], v11 offset:6400
    v_mfma_f32_16x16x32_bf16 v[196:199], v[232:235], v[88:91], v[196:199]
    ds_read_b64_tr_b16 v[232:233], v12 offset:6144
    ds_read_b64_tr_b16 v[234:235], v12 offset:6400
    v_mfma_f32_16x16x32_bf16 v[200:203], v[236:239], v[88:91], v[200:203]
    ds_read_b64_tr_b16 v[236:237], v11 offset:22528
    ds_read_b64_tr_b16 v[238:239], v11 offset:22784
    v_mfma_f32_16x16x32_bf16 v[204:207], v[240:243], v[88:91], v[204:207]
    ds_read_b64_tr_b16 v[240:241], v12 offset:22528
    ds_read_b64_tr_b16 v[242:243], v12 offset:22784
    s_waitcnt lgkmcnt(8)
    v_mfma_f32_16x16x32_bf16 v[192:195], v[212:215], v[92:95], v[192:195]
    buffer_load_dwordx4 v[140:143], v5, s[8:11], s38 offen offset:2048 sc1
    ds_read_b64_tr_b16 v[212:213], v11 offset:8192
    ds_read_b64_tr_b16 v[214:215], v11 offset:8448
    v_mfma_f32_16x16x32_bf16 v[196:199], v[216:219], v[92:95], v[196:199]
    s_waitcnt vmcnt(9)
    v_max3_u32 v7, v99, v103, v107
    v_cmp_eq_u32 vcc, -1, v7
    ds_read_b64_tr_b16 v[216:217], v12 offset:8192
    ds_read_b64_tr_b16 v[218:219], v12 offset:8448
    v_mfma_f32_16x16x32_bf16 v[200:203], v[220:223], v[92:95], v[200:203]
    s_cbranch_vccnz L_rt49_main_kernel
L_ok49_main_kernel:
    ds_read_b64_tr_b16 v[220:221], v11 offset:24576
    ds_read_b64_tr_b16 v[222:223], v11 offset:24832
    v_mfma_f32_16x16x32_bf16 v[204:207], v[224:227], v[92:95], v[204:207]
    ds_read_b64_tr_b16 v[224:225], v12 offset:24576
    ds_read_b64_tr_b16 v[226:227], v12 offset:24832
    s_waitcnt lgkmcnt(8)
    v_mfma_f32_16x16x32_bf16 v[192:195], v[228:231], v[96:99], v[192:195]
    buffer_load_dwordx4 v[144:147], v5, s[8:11], s38 offen offset:3072 sc1
    ds_read_b64_tr_b16 v[228:229], v11 offset:10240
    ds_read_b64_tr_b16 v[230:231], v11 offset:10496
    v_mfma_f32_16x16x32_bf16 v[196:199], v[232:235], v[96:99], v[196:199]
    ds_read_b64_tr_b16 v[232:233], v12 offset:10240
    ds_read_b64_tr_b16 v[234:235], v12 offset:10496
    v_mfma_f32_16x16x32_bf16 v[200:203], v[236:239], v[96:99], v[200:203]
    ds_read_b64_tr_b16 v[236:237], v11 offset:26624
    ds_read_b64_tr_b16 v[238:239], v11 offset:26880
    v_mfma_f32_16x16x32_bf16 v[204:207], v[240:243], v[96:99], v[204:207]
    ds_read_b64_tr_b16 v[240:241], v12 offset:26624
    ds_read_b64_tr_b16 v[242:243], v12 offset:26880
    s_waitcnt lgkmcnt(8)
    v_mfma_f32_16x16x32_bf16 v[192:195], v[212:215], v[100:103], v[192:195]
    s_add_u32 s38, s45, 0x8000
    buffer_load_dwordx4 v[148:151], v5, s[8:11], s38 offen offset:0 sc1
    ds_read_b64_tr_b16 v[212:213], v11 offset:12288
    ds_read_b64_tr_b16 v[214:215], v11 offset:12544
    v_mfma_f32_16x16x32_bf16 v[196:199], v[216:219], v[100:103], v[196:199]
    ds_read_b64_tr_b16 v[216:217], v12 offset:12288
    ds_read_b64_tr_b16 v[218:219], v12 offset:12544
    v_mfma_f32_16x16x32_bf16 v[200:203], v[220:223], v[100:103], v[200:203]
    ds_read_b64_tr_b16 v[220:221], v11 offset:28672
    ds_read_b64_tr_b16 v[222:223], v11 offset:28928
    v_mfma_f32_16x16x32_bf16 v[204:207], v[224:227], v[100:103], v[204:207]
    ds_read_b64_tr_b16 v[224:225], v12 offset:28672
    ds_read_b64_tr_b16 v[226:227], v12 offset:28928
    s_waitcnt lgkmcnt(8)
    v_mfma_f32_16x16x32_bf16 v[192:195], v[228:231], v[104:107], v[192:195]
    buffer_load_dwordx4 v[152:155], v5, s[8:11], s38 offen offset:1024 sc1
    ds_read_b64_tr_b16 v[228:229], v11 offset:14336
    ds_read_b64_tr_b16 v[230:231], v11 offset:14592
    v_mfma_f32_16x16x32_bf16 v[196:199], v[232:235], v[104:107], v[196:199]
    s_waitcnt vmcnt(9)
    v_max3_u32 v7, v111, v115, v119
    v_cmp_eq_u32 vcc, -1, v7
    ds_read_b64_tr_b16 v[232:233], v12 offset:14336
    ds_read_b64_tr_b16 v[234:235], v12 offset:14592
    v_mfma_f32_16x16x32_bf16 v[200:203], v[236:239], v[104:107], v[200:203]
    s_cbranch_vccnz L_rt50_main_kernel
L_ok50_main_kernel:
    ds_read_b64_tr_b16 v[236:237], v11 offset:30720
    ds_read_b64_tr_b16 v[238:239], v11 offset:30976
    v_mfma_f32_16x16x32_bf16 v[204:207], v[240:243], v[104:107], v[204:207]
    ds_read_b64_tr_b16 v[240:241], v12 offset:30720
    ds_read_b64_tr_b16 v[242:243], v12 offset:30976
    s_waitcnt lgkmcnt(8)
    v_mfma_f32_16x16x32_bf16 v[192:195], v[212:215], v[108:111], v[192:195]
    buffer_load_dwordx4 v[156:159], v5, s[8:11], s38 offen offset:2048 sc1
    ds_read_b64_tr_b16 v[212:213], v15 offset:0
    ds_read_b64_tr_b16 v[214:215], v15 offset:256
    v_mfma_f32_16x16x32_bf16 v[196:199], v[216:219], v[108:111], v[196:199]
    ds_read_b64_tr_b16 v[216:217], v16 offset:0
    ds_read_b64_tr_b16 v[218:219], v16 offset:256
    v_mfma_f32_16x16x32_bf16 v[200:203], v[220:223], v[108:111], v[200:203]
    ds_read_b64_tr_b16 v[220:221], v15 offset:16384
    ds_read_b64_tr_b16 v[222:223], v15 offset:16640
    v_mfma_f32_16x16x32_bf16 v[204:207], v[224:227], v[108:111], v[204:207]
    ds_read_b64_tr_b16 v[224:225], v16 offset:16384
    ds_read_b64_tr_b16 v[226:227], v16 offset:16640
    s_waitcnt lgkmcnt(8)
    v_mfma_f32_16x16x32_bf16 v[192:195], v[228:231], v[112:115], v[192:195]
    buffer_load_dwordx4 v[160:163], v5, s[8:11], s38 offen offset:3072 sc1
    ds_read_b64_tr_b16 v[228:229], v15 offset:2048
    ds_read_b64_tr_b16 v[230:231], v15 offset:2304
    v_mfma_f32_16x16x32_bf16 v[196:199], v[232:235], v[112:115], v[196:199]
    ds_read_b64_tr_b16 v[232:233], v16 offset:2048
    ds_read_b64_tr_b16 v[234:235], v16 offset:2304
    v_mfma_f32_16x16x32_bf16 v[200:203], v[236:239], v[112:115], v[200:203]
    ds_read_b64_tr_b16 v[236:237], v15 offset:18432
    ds_read_b64_tr_b16 v[238:239], v15 offset:18688
    v_mfma_f32_16x16x32_bf16 v[204:207], v[240:243], v[112:115], v[204:207]
    ds_read_b64_tr_b16 v[240:241], v16 offset:18432
    ds_read_b64_tr_b16 v[242:243], v16 offset:18688
    s_barrier
    s_waitcnt lgkmcnt(8)
    v_mfma_f32_16x16x32_bf16 v[192:195], v[212:215], v[116:119], v[192:195]
    s_add_u32 s38, s45, 0x9000
    buffer_load_dwordx4 v[164:167], v5, s[8:11], s38 offen offset:0 sc1
    ds_read_b64_tr_b16 v[212:213], v15 offset:4096
    ds_read_b64_tr_b16 v[214:215], v15 offset:4352
    v_mfma_f32_16x16x32_bf16 v[196:199], v[216:219], v[116:119], v[196:199]
    s_waitcnt vmcnt(9)
    v_max3_u32 v7, v123, v127, v131
    v_cmp_eq_u32 vcc, -1, v7
    ds_read_b64_tr_b16 v[216:217], v16 offset:4096
    ds_read_b64_tr_b16 v[218:219], v16 offset:4352
    v_mfma_f32_16x16x32_bf16 v[200:203], v[220:223], v[116:119], v[200:203]
    s_cbranch_vccnz L_rt51_main_kernel
L_ok51_main_kernel:
    ds_read_b64_tr_b16 v[220:221], v15 offset:20480
    ds_read_b64_tr_b16 v[222:223], v15 offset:20736
    v_mfma_f32_16x16x32_bf16 v[204:207], v[224:227], v[116:119], v[204:207]
    ds_read_b64_tr_b16 v[224:225], v16 offset:20480
    ds_read_b64_tr_b16 v[226:227], v16 offset:20736
    s_waitcnt lgkmcnt(8)
    v_mfma_f32_16x16x32_bf16 v[192:195], v[228:231], v[120:123], v[192:195]
    buffer_load_dwordx4 v[168:171], v5, s[8:11], s38 offen offset:1024 sc1
    ds_read_b64_tr_b16 v[228:229], v15 offset:6144
    ds_read_b64_tr_b16 v[230:231], v15 offset:6400
    v_mfma_f32_16x16x32_bf16 v[196:199], v[232:235], v[120:123], v[196:199]
    ds_read_b64_tr_b16 v[232:233], v16 offset:6144
    ds_read_b64_tr_b16 v[234:235], v16 offset:6400
    v_mfma_f32_16x16x32_bf16 v[200:203], v[236:239], v[120:123], v[200:203]
    ds_read_b64_tr_b16 v[236:237], v15 offset:22528
    ds_read_b64_tr_b16 v[238:239], v15 offset:22784
    v_mfma_f32_16x16x32_bf16 v[204:207], v[240:243], v[120:123], v[204:207]
    ds_read_b64_tr_b16 v[240:241], v16 offset:22528
    ds_read_b64_tr_b16 v[242:243], v16 offset:22784
    s_waitcnt lgkmcnt(8)
    v_mfma_f32_16x16x32_bf16 v[192:195], v[212:215], v[124:127], v[192:195]
    buffer_load_dwordx4 v[172:175], v5, s[8:11], s38 offen offset:2048 sc1
    ds_read_b64_tr_b16 v[212:213], v15 offset:8192
    ds_read_b64_tr_b16 v[214:215], v15 offset:8448
    v_mfma_f32_16x16x32_bf16 v[196:199], v[216:219], v[124:127], v[196:199]
    ds_read_b64_tr_b16 v[216:217], v16 offset:8192
    ds_read_b64_tr_b16 v[218:219], v16 offset:8448
    v_mfma_f32_16x16x32_bf16 v[200:203], v[220:223], v[124:127], v[200:203]
    ds_read_b64_tr_b16 v[220:221], v15 offset:24576
    ds_read_b64_tr_b16 v[222:223], v15 offset:24832
    v_mfma_f32_16x16x32_bf16 v[204:207], v[224:227], v[124:127], v[204:207]
    ds_read_b64_tr_b16 v[224:225], v16 offset:24576
    ds_read_b64_tr_b16 v[226:227], v16 offset:24832
    s_waitcnt lgkmcnt(8)
    v_mfma_f32_16x16x32_bf16 v[192:195], v[228:231], v[128:131], v[192:195]
    buffer_load_dwordx4 v[176:179], v5, s[8:11], s38 offen offset:3072 sc1
    ds_read_b64_tr_b16 v[228:229], v15 offset:10240
    ds_read_b64_tr_b16 v[230:231], v15 offset:10496
    v_mfma_f32_16x16x32_bf16 v[196:199], v[232:235], v[128:131], v[196:199]
    s_waitcnt vmcnt(9)
    v_max3_u32 v7, v135, v139, v143
    v_cmp_eq_u32 vcc, -1, v7
    ds_read_b64_tr_b16 v[232:233], v16 offset:10240
    ds_read_b64_tr_b16 v[234:235], v16 offset:10496
    v_mfma_f32_16x16x32_bf16 v[200:203], v[236:239], v[128:131], v[200:203]
    s_cbranch_vccnz L_rt52_main_kernel
L_ok52_main_kernel:
    ds_read_b64_tr_b16 v[236:237], v15 offset:26624
    ds_read_b64_tr_b16 v[238:239], v15 offset:26880
    v_mfma_f32_16x16x32_bf16 v[204:207], v[240:243], v[128:131], v[204:207]
    ds_read_b64_tr_b16 v[240:241], v16 offset:26624
    ds_read_b64_tr_b16 v[242:243], v16 offset:26880
    s_waitcnt lgkmcnt(8)
    v_mfma_f32_16x16x32_bf16 v[192:195], v[212:215], v[132:135], v[192:195]
    s_add_u32 s38, s45, 0xa000
    buffer_load_dwordx4 v[180:183], v5, s[8:11], s38 offen offset:0 sc1
    ds_read_b64_tr_b16 v[212:213], v15 offset:12288
    ds_read_b64_tr_b16 v[214:215], v15 offset:12544
    v_mfma_f32_16x16x32_bf16 v[196:199], v[216:219], v[132:135], v[196:199]
    ds_read_b64_tr_b16 v[216:217], v16 offset:12288
    ds_read_b64_tr_b16 v[218:219], v16 offset:12544
    v_mfma_f32_16x16x32_bf16 v[200:203], v[220:223], v[132:135], v[200:203]
    ds_read_b64_tr_b16 v[220:221], v15 offset:28672
    ds_read_b64_tr_b16 v[222:223], v15 offset:28928
    v_mfma_f32_16x16x32_bf16 v[204:207], v[224:227], v[132:135], v[204:207]
    ds_read_b64_tr_b16 v[224:225], v16 offset:28672
    ds_read_b64_tr_b16 v[226:227], v16 offset:28928
    s_waitcnt lgkmcnt(8)
    v_mfma_f32_16x16x32_bf16 v[192:195], v[228:231], v[136:139], v[192:195]
    buffer_load_dwordx4 v[184:187], v5, s[8:11], s38 offen offset:1024 sc1
    ds_read_b64_tr_b16 v[228:229], v15 offset:14336
    ds_read_b64_tr_b16 v[230:231], v15 offset:14592
    v_mfma_f32_16x16x32_bf16 v[196:199], v[232:235], v[136:139], v[196:199]
    ds_read_b64_tr_b16 v[232:233], v16 offset:14336
    ds_read_b64_tr_b16 v[234:235], v16 offset:14592
    v_mfma_f32_16x16x32_bf16 v[200:203], v[236:239], v[136:139], v[200:203]
    ds_read_b64_tr_b16 v[236:237], v15 offset:30720
    ds_read_b64_tr_b16 v[238:239], v15 offset:30976
    v_mfma_f32_16x16x32_bf16 v[204:207], v[240:243], v[136:139], v[204:207]
    ds_read_b64_tr_b16 v[240:241], v16 offset:30720
    ds_read_b64_tr_b16 v[242:243], v16 offset:30976
    s_waitcnt lgkmcnt(8)
    v_mfma_f32_16x16x32_bf16 v[192:195], v[212:215], v[140:143], v[192:195]
    buffer_load_dwordx4 v[188:191], v5, s[8:11], s38 offen offset:2048 sc1
    ds_read_b64_tr_b16 v[212:213], v11 offset:32768
    ds_read_b64_tr_b16 v[214:215], v11 offset:33024
    v_mfma_f32_16x16x32_bf16 v[196:199], v[216:219], v[140:143], v[196:199]
    s_waitcnt vmcnt(9)
    v_max3_u32 v7, v147, v151, v155
    v_cmp_eq_u32 vcc, -1, v7
    ds_read_b64_tr_b16 v[216:217], v12 offset:32768
    ds_read_b64_tr_b16 v[218:219], v12 offset:33024
    v_mfma_f32_16x16x32_bf16 v[200:203], v[220:223], v[140:143], v[200:203]
    s_cbranch_vccnz L_rt53_main_kernel
L_ok53_main_kernel:
    ds_read_b64_tr_b16 v[220:221], v11 offset:49152
    ds_read_b64_tr_b16 v[222:223], v11 offset:49408
    v_mfma_f32_16x16x32_bf16 v[204:207], v[224:227], v[140:143], v[204:207]
    ds_read_b64_tr_b16 v[224:225], v12 offset:49152
    ds_read_b64_tr_b16 v[226:227], v12 offset:49408
    s_waitcnt lgkmcnt(8)
    v_mfma_f32_16x16x32_bf16 v[192:195], v[228:231], v[144:147], v[192:195]
    ds_read_b64_tr_b16 v[228:229], v11 offset:34816
    ds_read_b64_tr_b16 v[230:231], v11 offset:35072
    v_mfma_f32_16x16x32_bf16 v[196:199], v[232:235], v[144:147], v[196:199]
    ds_read_b64_tr_b16 v[232:233], v12 offset:34816
    ds_read_b64_tr_b16 v[234:235], v12 offset:35072
    v_mfma_f32_16x16x32_bf16 v[200:203], v[236:239], v[144:147], v[200:203]
    ds_read_b64_tr_b16 v[236:237], v11 offset:51200
    ds_read_b64_tr_b16 v[238:239], v11 offset:51456
    v_mfma_f32_16x16x32_bf16 v[204:207], v[240:243], v[144:147], v[204:207]
    ds_read_b64_tr_b16 v[240:241], v12 offset:51200
    ds_read_b64_tr_b16 v[242:243], v12 offset:51456
    s_barrier
    s_waitcnt lgkmcnt(8)
    v_mfma_f32_16x16x32_bf16 v[192:195], v[212:215], v[148:151], v[192:195]
    ds_read_b64_tr_b16 v[212:213], v11 offset:36864
    ds_read_b64_tr_b16 v[214:215], v11 offset:37120
    v_mfma_f32_16x16x32_bf16 v[196:199], v[216:219], v[148:151], v[196:199]
    ds_read_b64_tr_b16 v[216:217], v12 offset:36864
    ds_read_b64_tr_b16 v[218:219], v12 offset:37120
    v_mfma_f32_16x16x32_bf16 v[200:203], v[220:223], v[148:151], v[200:203]
    ds_read_b64_tr_b16 v[220:221], v11 offset:53248
    ds_read_b64_tr_b16 v[222:223], v11 offset:53504
    v_mfma_f32_16x16x32_bf16 v[204:207], v[224:227], v[148:151], v[204:207]
    ds_read_b64_tr_b16 v[224:225], v12 offset:53248
    ds_read_b64_tr_b16 v[226:227], v12 offset:53504
    s_waitcnt lgkmcnt(8)
    v_mfma_f32_16x16x32_bf16 v[192:195], v[228:231], v[152:155], v[192:195]
    ds_read_b64_tr_b16 v[228:229], v11 offset:38912
    ds_read_b64_tr_b16 v[230:231], v11 offset:39168
    v_mfma_f32_16x16x32_bf16 v[196:199], v[232:235], v[152:155], v[196:199]
    s_waitcnt vmcnt(6)
    v_max3_u32 v7, v159, v163, v167
    v_cmp_eq_u32 vcc, -1, v7
    ds_read_b64_tr_b16 v[232:233], v12 offset:38912
    ds_read_b64_tr_b16 v[234:235], v12 offset:39168
    v_mfma_f32_16x16x32_bf16 v[200:203], v[236:239], v[152:155], v[200:203]
    s_cbranch_vccnz L_rt54_main_kernel
L_ok54_main_kernel:
    ds_read_b64_tr_b16 v[236:237], v11 offset:55296
    ds_read_b64_tr_b16 v[238:239], v11 offset:55552
    v_mfma_f32_16x16x32_bf16 v[204:207], v[240:243], v[152:155], v[204:207]
    ds_read_b64_tr_b16 v[240:241], v12 offset:55296
    ds_read_b64_tr_b16 v[242:243], v12 offset:55552
    s_waitcnt lgkmcnt(8)
    v_mfma_f32_16x16x32_bf16 v[192:195], v[212:215], v[156:159], v[192:195]
    ds_read_b64_tr_b16 v[212:213], v11 offset:40960
    ds_read_b64_tr_b16 v[214:215], v11 offset:41216
    v_mfma_f32_16x16x32_bf16 v[196:199], v[216:219], v[156:159], v[196:199]
    ds_read_b64_tr_b16 v[216:217], v12 offset:40960
    ds_read_b64_tr_b16 v[218:219], v12 offset:41216
    v_mfma_f32_16x16x32_bf16 v[200:203], v[220:223], v[156:159], v[200:203]
    ds_read_b64_tr_b16 v[220:221], v11 offset:57344
    ds_read_b64_tr_b16 v[222:223], v11 offset:57600
    v_mfma_f32_16x16x32_bf16 v[204:207], v[224:227], v[156:159], v[204:207]
    ds_read_b64_tr_b16 v[224:225], v12 offset:57344
    ds_read_b64_tr_b16 v[226:227], v12 offset:57600
    s_waitcnt lgkmcnt(8)
    v_mfma_f32_16x16x32_bf16 v[192:195], v[228:231], v[160:163], v[192:195]
    ds_read_b64_tr_b16 v[228:229], v11 offset:43008
    ds_read_b64_tr_b16 v[230:231], v11 offset:43264
    v_mfma_f32_16x16x32_bf16 v[196:199], v[232:235], v[160:163], v[196:199]
    ds_read_b64_tr_b16 v[232:233], v12 offset:43008
    ds_read_b64_tr_b16 v[234:235], v12 offset:43264
    v_mfma_f32_16x16x32_bf16 v[200:203], v[236:239], v[160:163], v[200:203]
    ds_read_b64_tr_b16 v[236:237], v11 offset:59392
    ds_read_b64_tr_b16 v[238:239], v11 offset:59648
    v_mfma_f32_16x16x32_bf16 v[204:207], v[240:243], v[160:163], v[204:207]
    ds_read_b64_tr_b16 v[240:241], v12 offset:59392
    ds_read_b64_tr_b16 v[242:243], v12 offset:59648
    s_waitcnt lgkmcnt(8)
    v_mfma_f32_16x16x32_bf16 v[192:195], v[212:215], v[164:167], v[192:195]
    ds_read_b64_tr_b16 v[212:213], v11 offset:45056
    ds_read_b64_tr_b16 v[214:215], v11 offset:45312
    v_mfma_f32_16x16x32_bf16 v[196:199], v[216:219], v[164:167], v[196:199]
    s_waitcnt vmcnt(3)
    v_max3_u32 v7, v171, v175, v179
    v_cmp_eq_u32 vcc, -1, v7
    ds_read_b64_tr_b16 v[216:217], v12 offset:45056
    ds_read_b64_tr_b16 v[218:219], v12 offset:45312
    v_mfma_f32_16x16x32_bf16 v[200:203], v[220:223], v[164:167], v[200:203]
    s_cbranch_vccnz L_rt55_main_kernel
L_ok55_main_kernel:
    ds_read_b64_tr_b16 v[220:221], v11 offset:61440
    ds_read_b64_tr_b16 v[222:223], v11 offset:61696
    v_mfma_f32_16x16x32_bf16 v[204:207], v[224:227], v[164:167], v[204:207]
    ds_read_b64_tr_b16 v[224:225], v12 offset:61440
    ds_read_b64_tr_b16 v[226:227], v12 offset:61696
    s_waitcnt lgkmcnt(8)
    v_mfma_f32_16x16x32_bf16 v[192:195], v[228:231], v[168:171], v[192:195]
    ds_read_b64_tr_b16 v[228:229], v11 offset:47104
    ds_read_b64_tr_b16 v[230:231], v11 offset:47360
    v_mfma_f32_16x16x32_bf16 v[196:199], v[232:235], v[168:171], v[196:199]
    ds_read_b64_tr_b16 v[232:233], v12 offset:47104
    ds_read_b64_tr_b16 v[234:235], v12 offset:47360
    v_mfma_f32_16x16x32_bf16 v[200:203], v[236:239], v[168:171], v[200:203]
    ds_read_b64_tr_b16 v[236:237], v11 offset:63488
    ds_read_b64_tr_b16 v[238:239], v11 offset:63744
    v_mfma_f32_16x16x32_bf16 v[204:207], v[240:243], v[168:171], v[204:207]
    ds_read_b64_tr_b16 v[240:241], v12 offset:63488
    ds_read_b64_tr_b16 v[242:243], v12 offset:63744
    s_waitcnt lgkmcnt(8)
    s_barrier
    v_mfma_f32_16x16x32_bf16 v[192:195], v[212:215], v[172:175], v[192:195]
    ds_read_b64_tr_b16 v[212:213], v14 offset:32768
    ds_read_b64_tr_b16 v[214:215], v14 offset:33024
    v_mfma_f32_16x16x32_bf16 v[196:199], v[216:219], v[172:175], v[196:199]
    ds_read_b64_tr_b16 v[216:217], v13 offset:32768
    ds_read_b64_tr_b16 v[218:219], v13 offset:33024
    v_mfma_f32_16x16x32_bf16 v[200:203], v[220:223], v[172:175], v[200:203]
    ds_read_b64_tr_b16 v[220:221], v14 offset:49152
    ds_read_b64_tr_b16 v[222:223], v14 offset:49408
    v_mfma_f32_16x16x32_bf16 v[204:207], v[224:227], v[172:175], v[204:207]
    ds_read_b64_tr_b16 v[224:225], v13 offset:49152
    ds_read_b64_tr_b16 v[226:227], v13 offset:49408
    s_waitcnt lgkmcnt(8)
    v_mfma_f32_16x16x32_bf16 v[192:195], v[228:231], v[176:179], v[192:195]
    ds_read_b64_tr_b16 v[228:229], v14 offset:34816
    ds_read_b64_tr_b16 v[230:231], v14 offset:35072
    v_mfma_f32_16x16x32_bf16 v[196:199], v[232:235], v[176:179], v[196:199]
    s_waitcnt vmcnt(0)
    v_max3_u32 v7, v183, v187, v191
    v_cmp_eq_u32 vcc, -1, v7
    ds_read_b64_tr_b16 v[232:233], v13 offset:34816
    ds_read_b64_tr_b16 v[234:235], v13 offset:35072
    v_mfma_f32_16x16x32_bf16 v[200:203], v[236:239], v[176:179], v[200:203]
    s_cbranch_vccnz L_rt56_main_kernel
L_ok56_main_kernel:
    ds_read_b64_tr_b16 v[236:237], v14 offset:51200
    ds_read_b64_tr_b16 v[238:239], v14 offset:51456
    v_mfma_f32_16x16x32_bf16 v[204:207], v[240:243], v[176:179], v[204:207]
    ds_read_b64_tr_b16 v[240:241], v13 offset:51200
    ds_read_b64_tr_b16 v[242:243], v13 offset:51456
    s_waitcnt lgkmcnt(8)
    v_mfma_f32_16x16x32_bf16 v[192:195], v[212:215], v[180:183], v[192:195]
    ds_read_b64_tr_b16 v[212:213], v14 offset:36864
    ds_read_b64_tr_b16 v[214:215], v14 offset:37120
    v_mfma_f32_16x16x32_bf16 v[196:199], v[216:219], v[180:183], v[196:199]
    ds_read_b64_tr_b16 v[216:217], v13 offset:36864
    ds_read_b64_tr_b16 v[218:219], v13 offset:37120
    v_mfma_f32_16x16x32_bf16 v[200:203], v[220:223], v[180:183], v[200:203]
    ds_read_b64_tr_b16 v[220:221], v14 offset:53248
    ds_read_b64_tr_b16 v[222:223], v14 offset:53504
    v_mfma_f32_16x16x32_bf16 v[204:207], v[224:227], v[180:183], v[204:207]
    ds_read_b64_tr_b16 v[224:225], v13 offset:53248
    ds_read_b64_tr_b16 v[226:227], v13 offset:53504
    s_waitcnt lgkmcnt(8)
    v_mfma_f32_16x16x32_bf16 v[192:195], v[228:231], v[184:187], v[192:195]
    v_mfma_f32_16x16x32_bf16 v[196:199], v[232:235], v[184:187], v[196:199]
    v_mfma_f32_16x16x32_bf16 v[200:203], v[236:239], v[184:187], v[200:203]
    v_mfma_f32_16x16x32_bf16 v[204:207], v[240:243], v[184:187], v[204:207]
    s_waitcnt lgkmcnt(0)
    v_mfma_f32_16x16x32_bf16 v[192:195], v[212:215], v[188:191], v[192:195]
    v_mfma_f32_16x16x32_bf16 v[196:199], v[216:219], v[188:191], v[196:199]
    v_mfma_f32_16x16x32_bf16 v[200:203], v[220:223], v[188:191], v[200:203]
    v_mfma_f32_16x16x32_bf16 v[204:207], v[224:227], v[188:191], v[204:207]
    s_nop 4
    v_cvt_pk_bf16_f32 v52, v192, v193
    v_cvt_pk_bf16_f32 v53, v194, v195
    v_cvt_pk_bf16_f32 v54, v196, v197
    v_cvt_pk_bf16_f32 v55, v198, v199
    v_cvt_pk_bf16_f32 v56, v200, v201
    v_cvt_pk_bf16_f32 v57, v202, v203
    v_cvt_pk_bf16_f32 v58, v204, v205
    v_cvt_pk_bf16_f32 v59, v206, v207
    s_barrier
    s_cmp_lg_u32 s62, 0
    s_cbranch_scc1 L_last_main_kernel
    v_permlane16_swap_b32 v52, v54
    v_permlane16_swap_b32 v53, v55
    v_permlane16_swap_b32 v56, v58
    v_permlane16_swap_b32 v57, v59
    buffer_store_dwordx4 v[52:55], v8, s[16:19], s47 offen offset:0
    buffer_store_dwordx4 v[56:59], v8, s[16:19], s47 offen offset:1024
    v_dot2_f32_bf16 v60, v52, s40, 0
    v_dot2_f32_bf16 v61, v52, v52, 0
    v_dot2_f32_bf16 v60, v53, s40, v60
    v_dot2_f32_bf16 v61, v53, v53, v61
    v_dot2_f32_bf16 v60, v54, s40, v60
    v_dot2_f32_bf16 v61, v54, v54, v61
    v_dot2_f32_bf16 v60, v55, s40, v60
    v_dot2_f32_bf16 v61, v55, v55, v61
    v_dot2_f32_bf16 v60, v56, s40, v60
    v_dot2_f32_bf16 v61, v56, v56, v61
    v_dot2_f32_bf16 v60, v57, s40, v60
    v_dot2_f32_bf16 v61, v57, v57, v61
    v_dot2_f32_bf16 v60, v58, s40, v60
    v_dot2_f32_bf16 v61, v58, v58, v61
    v_dot2_f32_bf16 v60, v59, s40, v60
    v_dot2_f32_bf16 v61, v59, v59, v61
    s_nop 1
    v_mov_b32 v62, v60
    v_mov_b32 v63, v61
    s_nop 0
    v_permlane32_swap_b32 v60, v62
    v_permlane32_swap_b32 v61, v63
    v_add_f32 v60, v60, v62
    v_add_f32 v61, v61, v63
    v_mov_b32 v62, v60
    v_mov_b32 v63, v61
    s_nop 0
    v_permlane16_swap_b32 v60, v62
    v_permlane16_swap_b32 v61, v63
    v_add_f32 v60, v60, v62
    v_add_f32 v61, v61, v63
    v_add_u32 v62, s46, v4
    v_lshlrev_b32 v62, 3, v62
    s_lshl_b32 s37, s34, 14
    s_mov_b64 exec, 0xffff
    buffer_store_dwordx2 v[60:61], v62, s[52:55], s37 offen
    s_mov_b64 exec, -1
    s_add_u32 s60, s60, 0x2000000
    s_addc_u32 s61, s61, 0
    s_mov_b32 s62, 1
    s_branch L_layer_main_kernel
L_last_main_kernel:
    s_nop 4
    v_permlane16_swap_b32 v52, v54
    v_permlane16_swap_b32 v53, v55
    v_permlane16_swap_b32 v56, v58
    v_permlane16_swap_b32 v57, v59
    buffer_store_dwordx4 v[52:55], v208, s[48:51], 0 offen offset:0
    buffer_store_dwordx4 v[56:59], v208, s[48:51], 0 offen offset:64
    s_branch L_end_main_kernel
L_loader_main_kernel:
    s_waitcnt vmcnt(0)
    v_lshrrev_b32 v15, 2, v2
    s_mov_b32 s37, 3072
    v_mul_lo_u32 v11, s37, v15
    v_lshrrev_b32 v15, 4, v2
    v_and_b32 v15, 2, v15
    v_and_b32 v16, 3, v2
    v_xor_b32 v15, v15, v16
    v_lshl_add_u32 v11, v15, 4, v11
    v_lshrrev_b32 v15, 2, v2
    s_mov_b32 s37, 1024
    v_mul_lo_u32 v12, s37, v15
    v_lshrrev_b32 v15, 4, v2
    v_and_b32 v15, 2, v15
    v_and_b32 v16, 3, v2
    v_xor_b32 v15, v15, v16
    v_lshl_add_u32 v12, v15, 4, v12
    v_lshrrev_b32 v15, 2, v2
    s_mov_b32 s37, 1024
    v_mul_lo_u32 v13, s37, v15
    v_lshrrev_b32 v15, 3, v2
    v_and_b32 v15, 2, v15
    v_and_b32 v16, 3, v2
    v_xor_b32 v15, v15, v16
    v_lshl_add_u32 v13, v15, 4, v13
    v_lshrrev_b32 v15, 2, v2
    s_mov_b32 s37, 2752
    v_mul_lo_u32 v14, s37, v15
    v_lshrrev_b32 v15, 4, v2
    v_and_b32 v15, 2, v15
    v_and_b32 v16, 3, v2
    v_xor_b32 v15, v15, v16
    v_lshl_add_u32 v14, v15, 4, v14
    v_lshlrev_b32 v24, 2, v2
    v_and_b32 v25, 0xffffffe0, v40
    v_add_u32 v25, 0x5bd1e8e0, v25
    v_mov_b32 v28, -1
    v_mov_b32 v29, -1
    v_mov_b32 v30, -1
    v_mov_b32 v31, -1
    v_and_b32 v35, 3, v2
    v_lshrrev_b32 v34, 2, v2
    v_and_b32 v34, 3, v34
    v_lshlrev_b32 v34, 6, v34
    v_lshl_add_u32 v34, v35, 3, v34
    v_lshl_add_u32 v34, v3, 9, v34
    v_and_b32 v35, 1, v3
    v_lshl_add_u32 v32, v35, 5, v34
    v_xor_b32 v35, 1, v35
    v_lshl_add_u32 v33, v35, 5, v34
    v_add_u32 v35, 0x10000, v32
    v_add_u32 v34, 0x10000, v33
    v_add_u32 v36, 0x20000, v32
    v_add_u32 v37, 0x20000, v33
    v_lshlrev_b32 v160, 7, v2
    s_mov_b32 s12, s66
    s_mov_b32 s13, s67
    s_mov_b32 s14, 0x180000
    s_mov_b32 s15, 0x00020000
    s_lshl_b32 s95, s36, 6
    s_add_u32 s37, s95, 0x400
    s_mov_b32 m0, 0x0
    s_nop 0
    buffer_load_dwordx4 v11, s[12:15], s37 offen lds
    s_add_u32 s37, s95, 0x800
    s_mov_b32 m0, 0x10000
    s_nop 0
    buffer_load_dwordx4 v11, s[12:15], s37 offen lds
    s_add_u32 s37, s95, 0xc400
    s_mov_b32 m0, 0x400
    s_nop 0
    buffer_load_dwordx4 v11, s[12:15], s37 offen lds
    s_add_u32 s37, s95, 0xc800
    s_mov_b32 m0, 0x10400
    s_nop 0
    buffer_load_dwordx4 v11, s[12:15], s37 offen lds
    s_add_u32 s37, s95, 0x18400
    s_mov_b32 m0, 0x800
    s_nop 0
    buffer_load_dwordx4 v11, s[12:15], s37 offen lds
    s_add_u32 s37, s95, 0x18800
    s_mov_b32 m0, 0x10800
    s_nop 0
    buffer_load_dwordx4 v11, s[12:15], s37 offen lds
    s_add_u32 s37, s95, 0x24400
    s_mov_b32 m0, 0xc00
    s_nop 0
    buffer_load_dwordx4 v11, s[12:15], s37 offen lds
    s_add_u32 s37, s95, 0x24800
    s_mov_b32 m0, 0x10c00
    s_nop 0
    buffer_load_dwordx4 v11, s[12:15], s37 offen lds
    s_add_u32 s37, s95, 0x30400
    s_mov_b32 m0, 0x1000
    s_nop 0
    buffer_load_dwordx4 v11, s[12:15], s37 offen lds
    s_add_u32 s37, s95, 0x30800
    s_mov_b32 m0, 0x11000
    s_nop 0
    buffer_load_dwordx4 v11, s[12:15], s37 offen lds
    s_add_u32 s37, s95, 0x3c400
    s_mov_b32 m0, 0x1400
    s_nop 0
    buffer_load_dwordx4 v11, s[12:15], s37 offen lds
    s_add_u32 s37, s95, 0x3c800
    s_mov_b32 m0, 0x11400
    s_nop 0
    buffer_load_dwordx4 v11, s[12:15], s37 offen lds
    s_add_u32 s37, s95, 0x48400
    s_mov_b32 m0, 0x1800
    s_nop 0
    buffer_load_dwordx4 v11, s[12:15], s37 offen lds
    s_add_u32 s37, s95, 0x48800
    s_mov_b32 m0, 0x11800
    s_nop 0
    buffer_load_dwordx4 v11, s[12:15], s37 offen lds
    s_add_u32 s37, s95, 0x54400
    s_mov_b32 m0, 0x1c00
    s_nop 0
    buffer_load_dwordx4 v11, s[12:15], s37 offen lds
    s_add_u32 s37, s95, 0x54800
    s_mov_b32 m0, 0x11c00
    s_nop 0
    buffer_load_dwordx4 v11, s[12:15], s37 offen lds
    s_add_u32 s37, s95, 0x60400
    s_mov_b32 m0, 0x2000
    s_nop 0
    buffer_load_dwordx4 v11, s[12:15], s37 offen lds
    s_add_u32 s37, s95, 0x60800
    s_mov_b32 m0, 0x12000
    s_nop 0
    buffer_load_dwordx4 v11, s[12:15], s37 offen lds
    s_add_u32 s37, s95, 0x6c400
    s_mov_b32 m0, 0x2400
    s_nop 0
    buffer_load_dwordx4 v11, s[12:15], s37 offen lds
    s_add_u32 s37, s95, 0x6c800
    s_mov_b32 m0, 0x12400
    s_nop 0
    buffer_load_dwordx4 v11, s[12:15], s37 offen lds
    s_add_u32 s37, s95, 0x78400
    s_mov_b32 m0, 0x2800
    s_nop 0
    buffer_load_dwordx4 v11, s[12:15], s37 offen lds
    s_add_u32 s37, s95, 0x78800
    s_mov_b32 m0, 0x12800
    s_nop 0
    buffer_load_dwordx4 v11, s[12:15], s37 offen lds
    s_add_u32 s37, s95, 0x84400
    s_mov_b32 m0, 0x2c00
    s_nop 0
    buffer_load_dwordx4 v11, s[12:15], s37 offen lds
    s_add_u32 s37, s95, 0x84800
    s_mov_b32 m0, 0x12c00
    s_nop 0
    buffer_load_dwordx4 v11, s[12:15], s37 offen lds
    s_add_u32 s37, s95, 0x90400
    s_mov_b32 m0, 0x3000
    s_nop 0
    buffer_load_dwordx4 v11, s[12:15], s37 offen lds
    s_add_u32 s37, s95, 0x90800
    s_mov_b32 m0, 0x13000
    s_nop 0
    buffer_load_dwordx4 v11, s[12:15], s37 offen lds
    s_add_u32 s37, s95, 0x9c400
    s_mov_b32 m0, 0x3400
    s_nop 0
    buffer_load_dwordx4 v11, s[12:15], s37 offen lds
    s_add_u32 s37, s95, 0x9c800
    s_mov_b32 m0, 0x13400
    s_nop 0
    buffer_load_dwordx4 v11, s[12:15], s37 offen lds
    s_add_u32 s37, s95, 0xa8400
    s_mov_b32 m0, 0x3800
    s_nop 0
    buffer_load_dwordx4 v11, s[12:15], s37 offen lds
    s_add_u32 s37, s95, 0xa8800
    s_mov_b32 m0, 0x13800
    s_nop 0
    buffer_load_dwordx4 v11, s[12:15], s37 offen lds
    s_add_u32 s37, s95, 0xb4400
    s_mov_b32 m0, 0x3c00
    s_nop 0
    buffer_load_dwordx4 v11, s[12:15], s37 offen lds
    s_add_u32 s37, s95, 0xb4800
    s_mov_b32 m0, 0x13c00
    s_nop 0
    buffer_load_dwordx4 v11, s[12:15], s37 offen lds
    s_add_u32 s37, s95, 0xc0400
    s_mov_b32 m0, 0x4000
    s_nop 0
    buffer_load_dwordx4 v11, s[12:15], s37 offen lds
    s_add_u32 s37, s95, 0xc0800
    s_mov_b32 m0, 0x14000
    s_nop 0
    buffer_load_dwordx4 v11, s[12:15], s37 offen lds
    s_add_u32 s37, s95, 0xcc400
    s_mov_b32 m0, 0x4400
    s_nop 0
    buffer_load_dwordx4 v11, s[12:15], s37 offen lds
    s_add_u32 s37, s95, 0xcc800
    s_mov_b32 m0, 0x14400
    s_nop 0
    buffer_load_dwordx4 v11, s[12:15], s37 offen lds
    s_add_u32 s37, s95, 0xd8400
    s_mov_b32 m0, 0x4800
    s_nop 0
    buffer_load_dwordx4 v11, s[12:15], s37 offen lds
    s_add_u32 s37, s95, 0xd8800
    s_mov_b32 m0, 0x14800
    s_nop 0
    buffer_load_dwordx4 v11, s[12:15], s37 offen lds
    s_add_u32 s37, s95, 0xe4400
    s_mov_b32 m0, 0x4c00
    s_nop 0
    buffer_load_dwordx4 v11, s[12:15], s37 offen lds
    s_add_u32 s37, s95, 0xe4800
    s_mov_b32 m0, 0x14c00
    s_nop 0
    buffer_load_dwordx4 v11, s[12:15], s37 offen lds
    s_add_u32 s37, s95, 0xf0400
    s_mov_b32 m0, 0x5000
    s_nop 0
    buffer_load_dwordx4 v11, s[12:15], s37 offen lds
    s_add_u32 s37, s95, 0xf0800
    s_mov_b32 m0, 0x15000
    s_nop 0
    buffer_load_dwordx4 v11, s[12:15], s37 offen lds
    s_add_u32 s37, s95, 0xfc400
    s_mov_b32 m0, 0x5400
    s_nop 0
    buffer_load_dwordx4 v11, s[12:15], s37 offen lds
    s_add_u32 s37, s95, 0xfc800
    s_mov_b32 m0, 0x15400
    s_nop 0
    buffer_load_dwordx4 v11, s[12:15], s37 offen lds
    s_add_u32 s37, s95, 0x108400
    s_mov_b32 m0, 0x5800
    s_nop 0
    buffer_load_dwordx4 v11, s[12:15], s37 offen lds
    s_add_u32 s37, s95, 0x108800
    s_mov_b32 m0, 0x15800
    s_nop 0
    buffer_load_dwordx4 v11, s[12:15], s37 offen lds
    s_add_u32 s37, s95, 0x114400
    s_mov_b32 m0, 0x5c00
    s_nop 0
    buffer_load_dwordx4 v11, s[12:15], s37 offen lds
    s_add_u32 s37, s95, 0x114800
    s_mov_b32 m0, 0x15c00
    s_nop 0
    buffer_load_dwordx4 v11, s[12:15], s37 offen lds
    v_mov_b32 v40, 0x3f803f80
    v_mov_b32 v41, 0x3f803f80
    v_mov_b32 v42, 0x3f803f80
    v_mov_b32 v43, 0x3f803f80
    v_lshlrev_b32 v132, 4, v3
    v_add_u32 v132, 0x1f800, v132
    s_waitcnt vmcnt(32)
    ds_read_b64_tr_b16 v[44:45], v32 offset:0
    ds_read_b64_tr_b16 v[46:47], v32 offset:256
    ds_read_b64_tr_b16 v[48:49], v33 offset:0
    ds_read_b64_tr_b16 v[50:51], v33 offset:256
    ds_read_b64_tr_b16 v[52:53], v35 offset:0
    ds_read_b64_tr_b16 v[54:55], v35 offset:256
    ds_read_b64_tr_b16 v[56:57], v34 offset:0
    ds_read_b64_tr_b16 v[58:59], v34 offset:256
    s_waitcnt lgkmcnt(6)
    v_mfma_f32_16x16x32_bf16 v[68:71], v[44:47], v[40:43], 0
    ds_read_b64_tr_b16 v[44:45], v32 offset:2048
    ds_read_b64_tr_b16 v[46:47], v32 offset:2304
    s_waitcnt lgkmcnt(6)
    v_mfma_f32_16x16x32_bf16 v[72:75], v[48:51], v[40:43], 0
    ds_read_b64_tr_b16 v[48:49], v33 offset:2048
    ds_read_b64_tr_b16 v[50:51], v33 offset:2304
    s_waitcnt lgkmcnt(6)
    v_mfma_f32_16x16x32_bf16 v[76:79], v[52:55], v[40:43], 0
    ds_read_b64_tr_b16 v[52:53], v35 offset:2048
    ds_read_b64_tr_b16 v[54:55], v35 offset:2304
    s_waitcnt lgkmcnt(6)
    v_mfma_f32_16x16x32_bf16 v[80:83], v[56:59], v[40:43], 0
    ds_read_b64_tr_b16 v[56:57], v34 offset:2048
    ds_read_b64_tr_b16 v[58:59], v34 offset:2304
    s_waitcnt lgkmcnt(6)
    v_mfma_f32_16x16x32_bf16 v[68:71], v[44:47], v[40:43], v[68:71]
    ds_read_b64_tr_b16 v[44:45], v32 offset:4096
    ds_read_b64_tr_b16 v[46:47], v32 offset:4352
    s_waitcnt lgkmcnt(6)
    v_mfma_f32_16x16x32_bf16 v[72:75], v[48:51], v[40:43], v[72:75]
    ds_read_b64_tr_b16 v[48:49], v33 offset:4096
    ds_read_b64_tr_b16 v[50:51], v33 offset:4352
    s_waitcnt lgkmcnt(6)
    v_mfma_f32_16x16x32_bf16 v[76:79], v[52:55], v[40:43], v[76:79]
    ds_read_b64_tr_b16 v[52:53], v35 offset:4096
    ds_read_b64_tr_b16 v[54:55], v35 offset:4352
    s_waitcnt lgkmcnt(6)
    v_mfma_f32_16x16x32_bf16 v[80:83], v[56:59], v[40:43], v[80:83]
    ds_read_b64_tr_b16 v[56:57], v34 offset:4096
    ds_read_b64_tr_b16 v[58:59], v34 offset:4352
    s_waitcnt lgkmcnt(6)
    v_mfma_f32_16x16x32_bf16 v[68:71], v[44:47], v[40:43], v[68:71]
    ds_read_b64_tr_b16 v[44:45], v32 offset:6144
    ds_read_b64_tr_b16 v[46:47], v32 offset:6400
    s_waitcnt lgkmcnt(6)
    v_mfma_f32_16x16x32_bf16 v[72:75], v[48:51], v[40:43], v[72:75]
    ds_read_b64_tr_b16 v[48:49], v33 offset:6144
    ds_read_b64_tr_b16 v[50:51], v33 offset:6400
    s_waitcnt lgkmcnt(6)
    v_mfma_f32_16x16x32_bf16 v[76:79], v[52:55], v[40:43], v[76:79]
    ds_read_b64_tr_b16 v[52:53], v35 offset:6144
    ds_read_b64_tr_b16 v[54:55], v35 offset:6400
    s_waitcnt lgkmcnt(6)
    v_mfma_f32_16x16x32_bf16 v[80:83], v[56:59], v[40:43], v[80:83]
    ds_read_b64_tr_b16 v[56:57], v34 offset:6144
    ds_read_b64_tr_b16 v[58:59], v34 offset:6400
    s_waitcnt lgkmcnt(6)
    v_mfma_f32_16x16x32_bf16 v[68:71], v[44:47], v[40:43], v[68:71]
    s_waitcnt lgkmcnt(4)
    v_mfma_f32_16x16x32_bf16 v[72:75], v[48:51], v[40:43], v[72:75]
    s_waitcnt lgkmcnt(2)
    v_mfma_f32_16x16x32_bf16 v[76:79], v[52:55], v[40:43], v[76:79]
    s_waitcnt lgkmcnt(0)
    v_mfma_f32_16x16x32_bf16 v[80:83], v[56:59], v[40:43], v[80:83]
    s_mov_b32 s12, s66
    s_mov_b32 s13, s67
    s_mov_b32 s14, 0x180000
    s_mov_b32 s15, 0x00020000
    s_lshl_b32 s95, s36, 6
    s_add_u32 s37, s95, 0x120400
    s_mov_b32 m0, 0x6000
    s_nop 0
    buffer_load_dwordx4 v11, s[12:15], s37 offen lds
    s_add_u32 s37, s95, 0x120800
    s_mov_b32 m0, 0x16000
    s_nop 0
    buffer_load_dwordx4 v11, s[12:15], s37 offen lds
    s_add_u32 s37, s95, 0x12c400
    s_mov_b32 m0, 0x6400
    s_nop 0
    buffer_load_dwordx4 v11, s[12:15], s37 offen lds
    s_add_u32 s37, s95, 0x12c800
    s_mov_b32 m0, 0x16400
    s_nop 0
    buffer_load_dwordx4 v11, s[12:15], s37 offen lds
    s_add_u32 s37, s95, 0x138400
    s_mov_b32 m0, 0x6800
    s_nop 0
    buffer_load_dwordx4 v11, s[12:15], s37 offen lds
    s_add_u32 s37, s95, 0x138800
    s_mov_b32 m0, 0x16800
    s_nop 0
    buffer_load_dwordx4 v11, s[12:15], s37 offen lds
    s_add_u32 s37, s95, 0x144400
    s_mov_b32 m0, 0x6c00
    s_nop 0
    buffer_load_dwordx4 v11, s[12:15], s37 offen lds
    s_add_u32 s37, s95, 0x144800
    s_mov_b32 m0, 0x16c00
    s_nop 0
    buffer_load_dwordx4 v11, s[12:15], s37 offen lds
    s_add_u32 s37, s95, 0x150400
    s_mov_b32 m0, 0x7000
    s_nop 0
    buffer_load_dwordx4 v11, s[12:15], s37 offen lds
    s_add_u32 s37, s95, 0x150800
    s_mov_b32 m0, 0x17000
    s_nop 0
    buffer_load_dwordx4 v11, s[12:15], s37 offen lds
    s_add_u32 s37, s95, 0x15c400
    s_mov_b32 m0, 0x7400
    s_nop 0
    buffer_load_dwordx4 v11, s[12:15], s37 offen lds
    s_add_u32 s37, s95, 0x15c800
    s_mov_b32 m0, 0x17400
    s_nop 0
    buffer_load_dwordx4 v11, s[12:15], s37 offen lds
    s_add_u32 s37, s95, 0x168400
    s_mov_b32 m0, 0x7800
    s_nop 0
    buffer_load_dwordx4 v11, s[12:15], s37 offen lds
    s_add_u32 s37, s95, 0x168800
    s_mov_b32 m0, 0x17800
    s_nop 0
    buffer_load_dwordx4 v11, s[12:15], s37 offen lds
    s_add_u32 s37, s95, 0x174400
    s_mov_b32 m0, 0x7c00
    s_nop 0
    buffer_load_dwordx4 v11, s[12:15], s37 offen lds
    s_add_u32 s37, s95, 0x174800
    s_mov_b32 m0, 0x17c00
    s_nop 0
    buffer_load_dwordx4 v11, s[12:15], s37 offen lds
    s_mov_b32 s20, s68
    s_mov_b32 s21, s69
    s_mov_b32 s22, 0x4000
    s_mov_b32 s23, 0x00020000
    v_lshlrev_b32 v15, 7, v3
    v_lshl_add_u32 v15, v4, 1, v15
    s_lshl_b32 s37, s36, 10
    buffer_load_ushort v124, v15, s[20:23], s37 offen offset:0
    buffer_load_ushort v128, v15, s[20:23], s37 offen offset:32
    buffer_load_ushort v125, v15, s[20:23], s37 offen offset:64
    buffer_load_ushort v129, v15, s[20:23], s37 offen offset:96
    buffer_load_ushort v126, v15, s[20:23], s37 offen offset:512
    buffer_load_ushort v130, v15, s[20:23], s37 offen offset:544
    buffer_load_ushort v127, v15, s[20:23], s37 offen offset:576
    buffer_load_ushort v131, v15, s[20:23], s37 offen offset:608
    s_mov_b32 s12, s66
    s_mov_b32 s13, s67
    s_mov_b32 s14, 0x180000
    s_mov_b32 s15, 0x00020000
    s_lshl_b32 s95, s36, 6
    s_waitcnt vmcnt(40)
    ds_read_b64_tr_b16 v[44:45], v32 offset:8192
    ds_read_b64_tr_b16 v[46:47], v32 offset:8448
    ds_read_b64_tr_b16 v[48:49], v33 offset:8192
    ds_read_b64_tr_b16 v[50:51], v33 offset:8448
    ds_read_b64_tr_b16 v[52:53], v35 offset:8192
    ds_read_b64_tr_b16 v[54:55], v35 offset:8448
    ds_read_b64_tr_b16 v[56:57], v34 offset:8192
    ds_read_b64_tr_b16 v[58:59], v34 offset:8448
    s_waitcnt lgkmcnt(6)
    v_mfma_f32_16x16x32_bf16 v[68:71], v[44:47], v[40:43], v[68:71]
    ds_read_b64_tr_b16 v[44:45], v32 offset:10240
    ds_read_b64_tr_b16 v[46:47], v32 offset:10496
    s_waitcnt lgkmcnt(6)
    v_mfma_f32_16x16x32_bf16 v[72:75], v[48:51], v[40:43], v[72:75]
    ds_read_b64_tr_b16 v[48:49], v33 offset:10240
    ds_read_b64_tr_b16 v[50:51], v33 offset:10496
    s_waitcnt lgkmcnt(6)
    v_mfma_f32_16x16x32_bf16 v[76:79], v[52:55], v[40:43], v[76:79]
    ds_read_b64_tr_b16 v[52:53], v35 offset:10240
    ds_read_b64_tr_b16 v[54:55], v35 offset:10496
    s_waitcnt lgkmcnt(6)
    v_mfma_f32_16x16x32_bf16 v[80:83], v[56:59], v[40:43], v[80:83]
    ds_read_b64_tr_b16 v[56:57], v34 offset:10240
    ds_read_b64_tr_b16 v[58:59], v34 offset:10496
    s_waitcnt lgkmcnt(6)
    v_mfma_f32_16x16x32_bf16 v[68:71], v[44:47], v[40:43], v[68:71]
    ds_read_b64_tr_b16 v[44:45], v32 offset:12288
    ds_read_b64_tr_b16 v[46:47], v32 offset:12544
    s_waitcnt lgkmcnt(6)
    v_mfma_f32_16x16x32_bf16 v[72:75], v[48:51], v[40:43], v[72:75]
    ds_read_b64_tr_b16 v[48:49], v33 offset:12288
    ds_read_b64_tr_b16 v[50:51], v33 offset:12544
    s_waitcnt lgkmcnt(6)
    v_mfma_f32_16x16x32_bf16 v[76:79], v[52:55], v[40:43], v[76:79]
    ds_read_b64_tr_b16 v[52:53], v35 offset:12288
    ds_read_b64_tr_b16 v[54:55], v35 offset:12544
    s_waitcnt lgkmcnt(6)
    v_mfma_f32_16x16x32_bf16 v[80:83], v[56:59], v[40:43], v[80:83]
    ds_read_b64_tr_b16 v[56:57], v34 offset:12288
    ds_read_b64_tr_b16 v[58:59], v34 offset:12544
    s_waitcnt lgkmcnt(6)
    v_mfma_f32_16x16x32_bf16 v[68:71], v[44:47], v[40:43], v[68:71]
    ds_read_b64_tr_b16 v[44:45], v32 offset:14336
    ds_read_b64_tr_b16 v[46:47], v32 offset:14592
    s_waitcnt lgkmcnt(6)
    v_mfma_f32_16x16x32_bf16 v[72:75], v[48:51], v[40:43], v[72:75]
    ds_read_b64_tr_b16 v[48:49], v33 offset:14336
    ds_read_b64_tr_b16 v[50:51], v33 offset:14592
    s_waitcnt lgkmcnt(6)
    v_mfma_f32_16x16x32_bf16 v[76:79], v[52:55], v[40:43], v[76:79]
    ds_read_b64_tr_b16 v[52:53], v35 offset:14336
    ds_read_b64_tr_b16 v[54:55], v35 offset:14592
    s_waitcnt lgkmcnt(6)
    v_mfma_f32_16x16x32_bf16 v[80:83], v[56:59], v[40:43], v[80:83]
    ds_read_b64_tr_b16 v[56:57], v34 offset:14336
    ds_read_b64_tr_b16 v[58:59], v34 offset:14592
    s_waitcnt lgkmcnt(6)
    v_mfma_f32_16x16x32_bf16 v[68:71], v[44:47], v[40:43], v[68:71]
    s_waitcnt lgkmcnt(4)
    v_mfma_f32_16x16x32_bf16 v[72:75], v[48:51], v[40:43], v[72:75]
    s_waitcnt lgkmcnt(2)
    v_mfma_f32_16x16x32_bf16 v[76:79], v[52:55], v[40:43], v[76:79]
    s_waitcnt lgkmcnt(0)
    v_mfma_f32_16x16x32_bf16 v[80:83], v[56:59], v[40:43], v[80:83]
    s_waitcnt vmcnt(40)
    s_barrier
L_llayer_main_kernel:
    s_add_u32 s28, s60, 0x1400000
    s_addc_u32 s29, s61, 0
    s_mov_b32 s30, 0x20000
    s_mov_b32 s31, 0x00020000
    s_add_u32 s52, s60, 0x0
    s_addc_u32 s53, s61, 0
    s_mov_b32 s54, 0x4000000
    s_mov_b32 s55, 0x00020000
    s_cmp_lg_u32 s62, 0
    s_cbranch_scc1 L_nl0_main_kernel
    s_mov_b32 s12, s66
    s_mov_b32 s13, s67
    s_mov_b32 s14, 0x180000
    s_mov_b32 s15, 0x00020000
    s_lshl_b32 s95, s36, 6
    s_add_u32 s37, s95, 0x0
    s_mov_b32 m0, 0x8000
    s_nop 0
    buffer_load_dwordx4 v11, s[12:15], s37 offen lds
    s_add_u32 s37, s95, 0xc000
    s_mov_b32 m0, 0x8400
    s_nop 0
    buffer_load_dwordx4 v11, s[12:15], s37 offen lds
    s_add_u32 s37, s95, 0x18000
    s_mov_b32 m0, 0x8800
    s_nop 0
    buffer_load_dwordx4 v11, s[12:15], s37 offen lds
    s_add_u32 s37, s95, 0x24000
    s_mov_b32 m0, 0x8c00
    s_nop 0
    buffer_load_dwordx4 v11, s[12:15], s37 offen lds
    s_add_u32 s37, s95, 0x30000
    s_mov_b32 m0, 0x9000
    s_nop 0
    buffer_load_dwordx4 v11, s[12:15], s37 offen lds
    s_add_u32 s37, s95, 0x3c000
    s_mov_b32 m0, 0x9400
    s_nop 0
    buffer_load_dwordx4 v11, s[12:15], s37 offen lds
    s_add_u32 s37, s95, 0x48000
    s_mov_b32 m0, 0x9800
    s_nop 0
    buffer_load_dwordx4 v11, s[12:15], s37 offen lds
    s_add_u32 s37, s95, 0x54000
    s_mov_b32 m0, 0x9c00
    s_nop 0
    buffer_load_dwordx4 v11, s[12:15], s37 offen lds
    s_add_u32 s37, s95, 0x60000
    s_mov_b32 m0, 0xa000
    s_nop 0
    buffer_load_dwordx4 v11, s[12:15], s37 offen lds
    s_add_u32 s37, s95, 0x6c000
    s_mov_b32 m0, 0xa400
    s_nop 0
    buffer_load_dwordx4 v11, s[12:15], s37 offen lds
    s_add_u32 s37, s95, 0x78000
    s_mov_b32 m0, 0xa800
    s_nop 0
    buffer_load_dwordx4 v11, s[12:15], s37 offen lds
    s_add_u32 s37, s95, 0x84000
    s_mov_b32 m0, 0xac00
    s_nop 0
    buffer_load_dwordx4 v11, s[12:15], s37 offen lds
    s_add_u32 s37, s95, 0x90000
    s_mov_b32 m0, 0xb000
    s_nop 0
    buffer_load_dwordx4 v11, s[12:15], s37 offen lds
    s_add_u32 s37, s95, 0x9c000
    s_mov_b32 m0, 0xb400
    s_nop 0
    buffer_load_dwordx4 v11, s[12:15], s37 offen lds
    s_add_u32 s37, s95, 0xa8000
    s_mov_b32 m0, 0xb800
    s_nop 0
    buffer_load_dwordx4 v11, s[12:15], s37 offen lds
    s_add_u32 s37, s95, 0xb4000
    s_mov_b32 m0, 0xbc00
    s_nop 0
    buffer_load_dwordx4 v11, s[12:15], s37 offen lds
    s_add_u32 s37, s95, 0xc0000
    s_mov_b32 m0, 0xc000
    s_nop 0
    buffer_load_dwordx4 v11, s[12:15], s37 offen lds
    s_add_u32 s37, s95, 0xcc000
    s_mov_b32 m0, 0xc400
    s_nop 0
    buffer_load_dwordx4 v11, s[12:15], s37 offen lds
    s_add_u32 s37, s95, 0xd8000
    s_mov_b32 m0, 0xc800
    s_nop 0
    buffer_load_dwordx4 v11, s[12:15], s37 offen lds
    s_add_u32 s37, s95, 0xe4000
    s_mov_b32 m0, 0xcc00
    s_nop 0
    buffer_load_dwordx4 v11, s[12:15], s37 offen lds
    s_add_u32 s37, s95, 0xf0000
    s_mov_b32 m0, 0xd000
    s_nop 0
    buffer_load_dwordx4 v11, s[12:15], s37 offen lds
    s_add_u32 s37, s95, 0xfc000
    s_mov_b32 m0, 0xd400
    s_nop 0
    buffer_load_dwordx4 v11, s[12:15], s37 offen lds
    s_add_u32 s37, s95, 0x108000
    s_mov_b32 m0, 0xd800
    s_nop 0
    buffer_load_dwordx4 v11, s[12:15], s37 offen lds
    s_add_u32 s37, s95, 0x114000
    s_mov_b32 m0, 0xdc00
    s_nop 0
    buffer_load_dwordx4 v11, s[12:15], s37 offen lds
    s_add_u32 s37, s95, 0x120000
    s_mov_b32 m0, 0xe000
    s_nop 0
    buffer_load_dwordx4 v11, s[12:15], s37 offen lds
    s_add_u32 s37, s95, 0x12c000
    s_mov_b32 m0, 0xe400
    s_nop 0
    buffer_load_dwordx4 v11, s[12:15], s37 offen lds
    s_add_u32 s37, s95, 0x138000
    s_mov_b32 m0, 0xe800
    s_nop 0
    buffer_load_dwordx4 v11, s[12:15], s37 offen lds
    s_add_u32 s37, s95, 0x144000
    s_mov_b32 m0, 0xec00
    s_nop 0
    buffer_load_dwordx4 v11, s[12:15], s37 offen lds
    s_add_u32 s37, s95, 0x150000
    s_mov_b32 m0, 0xf000
    s_nop 0
    buffer_load_dwordx4 v11, s[12:15], s37 offen lds
    s_add_u32 s37, s95, 0x15c000
    s_mov_b32 m0, 0xf400
    s_nop 0
    buffer_load_dwordx4 v11, s[12:15], s37 offen lds
    s_add_u32 s37, s95, 0x168000
    s_mov_b32 m0, 0xf800
    s_nop 0
    buffer_load_dwordx4 v11, s[12:15], s37 offen lds
    s_add_u32 s37, s95, 0x174000
    s_mov_b32 m0, 0xfc00
    s_nop 0
    buffer_load_dwordx4 v11, s[12:15], s37 offen lds
    s_waitcnt vmcnt(32)
    v_lshl_or_b32 v124, v128, 16, v124
    v_lshl_or_b32 v125, v129, 16, v125
    v_lshl_or_b32 v126, v130, 16, v126
    v_lshl_or_b32 v127, v131, 16, v127
    ds_read_b64_tr_b16 v[44:45], v32 offset:16384
    ds_read_b64_tr_b16 v[46:47], v32 offset:16640
    ds_read_b64_tr_b16 v[48:49], v33 offset:16384
    ds_read_b64_tr_b16 v[50:51], v33 offset:16640
    ds_read_b64_tr_b16 v[52:53], v35 offset:16384
    ds_read_b64_tr_b16 v[54:55], v35 offset:16640
    ds_read_b64_tr_b16 v[56:57], v34 offset:16384
    ds_read_b64_tr_b16 v[58:59], v34 offset:16640
    s_waitcnt lgkmcnt(6)
    v_mfma_f32_16x16x32_bf16 v[68:71], v[44:47], v[40:43], v[68:71]
    ds_read_b64_tr_b16 v[44:45], v32 offset:18432
    ds_read_b64_tr_b16 v[46:47], v32 offset:18688
    s_waitcnt lgkmcnt(6)
    v_mfma_f32_16x16x32_bf16 v[72:75], v[48:51], v[40:43], v[72:75]
    ds_read_b64_tr_b16 v[48:49], v33 offset:18432
    ds_read_b64_tr_b16 v[50:51], v33 offset:18688
    s_waitcnt lgkmcnt(6)
    v_mfma_f32_16x16x32_bf16 v[76:79], v[52:55], v[40:43], v[76:79]
    ds_read_b64_tr_b16 v[52:53], v35 offset:18432
    ds_read_b64_tr_b16 v[54:55], v35 offset:18688
    s_waitcnt lgkmcnt(6)
    v_mfma_f32_16x16x32_bf16 v[80:83], v[56:59], v[40:43], v[80:83]
    ds_read_b64_tr_b16 v[56:57], v34 offset:18432
    ds_read_b64_tr_b16 v[58:59], v34 offset:18688
    s_waitcnt lgkmcnt(6)
    v_mfma_f32_16x16x32_bf16 v[68:71], v[44:47], v[40:43], v[68:71]
    ds_read_b64_tr_b16 v[44:45], v32 offset:20480
    ds_read_b64_tr_b16 v[46:47], v32 offset:20736
    s_waitcnt lgkmcnt(6)
    v_mfma_f32_16x16x32_bf16 v[72:75], v[48:51], v[40:43], v[72:75]
    ds_read_b64_tr_b16 v[48:49], v33 offset:20480
    ds_read_b64_tr_b16 v[50:51], v33 offset:20736
    s_waitcnt lgkmcnt(6)
    v_mfma_f32_16x16x32_bf16 v[76:79], v[52:55], v[40:43], v[76:79]
    ds_read_b64_tr_b16 v[52:53], v35 offset:20480
    ds_read_b64_tr_b16 v[54:55], v35 offset:20736
    s_waitcnt lgkmcnt(6)
    v_mfma_f32_16x16x32_bf16 v[80:83], v[56:59], v[40:43], v[80:83]
    ds_read_b64_tr_b16 v[56:57], v34 offset:20480
    ds_read_b64_tr_b16 v[58:59], v34 offset:20736
    s_waitcnt lgkmcnt(6)
    v_mfma_f32_16x16x32_bf16 v[68:71], v[44:47], v[40:43], v[68:71]
    ds_read_b64_tr_b16 v[44:45], v32 offset:22528
    ds_read_b64_tr_b16 v[46:47], v32 offset:22784
    s_waitcnt lgkmcnt(6)
    v_mfma_f32_16x16x32_bf16 v[72:75], v[48:51], v[40:43], v[72:75]
    ds_read_b64_tr_b16 v[48:49], v33 offset:22528
    ds_read_b64_tr_b16 v[50:51], v33 offset:22784
    s_waitcnt lgkmcnt(6)
    v_mfma_f32_16x16x32_bf16 v[76:79], v[52:55], v[40:43], v[76:79]
    ds_read_b64_tr_b16 v[52:53], v35 offset:22528
    ds_read_b64_tr_b16 v[54:55], v35 offset:22784
    s_waitcnt lgkmcnt(6)
    v_mfma_f32_16x16x32_bf16 v[80:83], v[56:59], v[40:43], v[80:83]
    ds_read_b64_tr_b16 v[56:57], v34 offset:22528
    ds_read_b64_tr_b16 v[58:59], v34 offset:22784
    s_waitcnt lgkmcnt(6)
    v_mfma_f32_16x16x32_bf16 v[68:71], v[44:47], v[40:43], v[68:71]
    s_waitcnt lgkmcnt(4)
    v_mfma_f32_16x16x32_bf16 v[72:75], v[48:51], v[40:43], v[72:75]
    s_waitcnt lgkmcnt(2)
    v_mfma_f32_16x16x32_bf16 v[76:79], v[52:55], v[40:43], v[76:79]
    s_waitcnt lgkmcnt(0)
    v_mfma_f32_16x16x32_bf16 v[80:83], v[56:59], v[40:43], v[80:83]
    s_barrier
    ds_read_b64_tr_b16 v[44:45], v32 offset:24576
    ds_read_b64_tr_b16 v[46:47], v32 offset:24832
    ds_read_b64_tr_b16 v[48:49], v33 offset:24576
    ds_read_b64_tr_b16 v[50:51], v33 offset:24832
    ds_read_b64_tr_b16 v[52:53], v35 offset:24576
    ds_read_b64_tr_b16 v[54:55], v35 offset:24832
    ds_read_b64_tr_b16 v[56:57], v34 offset:24576
    ds_read_b64_tr_b16 v[58:59], v34 offset:24832
    s_waitcnt lgkmcnt(6)
    v_mfma_f32_16x16x32_bf16 v[68:71], v[44:47], v[40:43], v[68:71]
    ds_read_b64_tr_b16 v[44:45], v32 offset:26624
    ds_read_b64_tr_b16 v[46:47], v32 offset:26880
    s_waitcnt lgkmcnt(6)
    v_mfma_f32_16x16x32_bf16 v[72:75], v[48:51], v[40:43], v[72:75]
    ds_read_b64_tr_b16 v[48:49], v33 offset:26624
    ds_read_b64_tr_b16 v[50:51], v33 offset:26880
    s_waitcnt lgkmcnt(6)
    v_mfma_f32_16x16x32_bf16 v[76:79], v[52:55], v[40:43], v[76:79]
    ds_read_b64_tr_b16 v[52:53], v35 offset:26624
    ds_read_b64_tr_b16 v[54:55], v35 offset:26880
    s_waitcnt lgkmcnt(6)
    v_mfma_f32_16x16x32_bf16 v[80:83], v[56:59], v[40:43], v[80:83]
    ds_read_b64_tr_b16 v[56:57], v34 offset:26624
    ds_read_b64_tr_b16 v[58:59], v34 offset:26880
    s_waitcnt lgkmcnt(6)
    v_mfma_f32_16x16x32_bf16 v[68:71], v[44:47], v[40:43], v[68:71]
    ds_read_b64_tr_b16 v[44:45], v32 offset:28672
    ds_read_b64_tr_b16 v[46:47], v32 offset:28928
    s_waitcnt lgkmcnt(6)
    v_mfma_f32_16x16x32_bf16 v[72:75], v[48:51], v[40:43], v[72:75]
    ds_read_b64_tr_b16 v[48:49], v33 offset:28672
    ds_read_b64_tr_b16 v[50:51], v33 offset:28928
    s_waitcnt lgkmcnt(6)
    v_mfma_f32_16x16x32_bf16 v[76:79], v[52:55], v[40:43], v[76:79]
    ds_read_b64_tr_b16 v[52:53], v35 offset:28672
    ds_read_b64_tr_b16 v[54:55], v35 offset:28928
    s_waitcnt lgkmcnt(6)
    v_mfma_f32_16x16x32_bf16 v[80:83], v[56:59], v[40:43], v[80:83]
    ds_read_b64_tr_b16 v[56:57], v34 offset:28672
    ds_read_b64_tr_b16 v[58:59], v34 offset:28928
    s_waitcnt lgkmcnt(6)
    v_mfma_f32_16x16x32_bf16 v[68:71], v[44:47], v[40:43], v[68:71]
    ds_read_b64_tr_b16 v[44:45], v32 offset:30720
    ds_read_b64_tr_b16 v[46:47], v32 offset:30976
    s_waitcnt lgkmcnt(6)
    v_mfma_f32_16x16x32_bf16 v[72:75], v[48:51], v[40:43], v[72:75]
    ds_read_b64_tr_b16 v[48:49], v33 offset:30720
    ds_read_b64_tr_b16 v[50:51], v33 offset:30976
    s_waitcnt lgkmcnt(6)
    v_mfma_f32_16x16x32_bf16 v[76:79], v[52:55], v[40:43], v[76:79]
    ds_read_b64_tr_b16 v[52:53], v35 offset:30720
    ds_read_b64_tr_b16 v[54:55], v35 offset:30976
    s_waitcnt lgkmcnt(6)
    v_mfma_f32_16x16x32_bf16 v[80:83], v[56:59], v[40:43], v[80:83]
    ds_read_b64_tr_b16 v[56:57], v34 offset:30720
    ds_read_b64_tr_b16 v[58:59], v34 offset:30976
    s_waitcnt lgkmcnt(6)
    v_mfma_f32_16x16x32_bf16 v[68:71], v[44:47], v[40:43], v[68:71]
    s_waitcnt lgkmcnt(4)
    v_mfma_f32_16x16x32_bf16 v[72:75], v[48:51], v[40:43], v[72:75]
    s_waitcnt lgkmcnt(2)
    v_mfma_f32_16x16x32_bf16 v[76:79], v[52:55], v[40:43], v[76:79]
    s_waitcnt lgkmcnt(0)
    v_mfma_f32_16x16x32_bf16 v[80:83], v[56:59], v[40:43], v[80:83]
    s_waitcnt vmcnt(0)
    s_lshl_b32 s37, s33, 5
    s_lshl_b32 s38, s34, 2
    s_add_u32 s37, s37, s38
    s_add_u32 s37, s37, 0x10000
    s_mov_b64 exec, 1
    buffer_store_dword v6, v10, s[28:31], s37 offen sc1
    s_mov_b64 exec, -1
    ds_read_b64_tr_b16 v[44:45], v32 offset:32768
    ds_read_b64_tr_b16 v[46:47], v32 offset:33024
    ds_read_b64_tr_b16 v[48:49], v33 offset:32768
    ds_read_b64_tr_b16 v[50:51], v33 offset:33024
    ds_read_b64_tr_b16 v[52:53], v32 offset:34816
    ds_read_b64_tr_b16 v[54:55], v32 offset:35072
    ds_read_b64_tr_b16 v[56:57], v33 offset:34816
    ds_read_b64_tr_b16 v[58:59], v33 offset:35072
    s_waitcnt lgkmcnt(6)
    v_mfma_f32_16x16x32_bf16 v[60:63], v[44:47], v[40:43], 0
    ds_read_b64_tr_b16 v[44:45], v32 offset:36864
    ds_read_b64_tr_b16 v[46:47], v32 offset:37120
    s_waitcnt lgkmcnt(6)
    v_mfma_f32_16x16x32_bf16 v[64:67], v[48:51], v[40:43], 0
    ds_read_b64_tr_b16 v[48:49], v33 offset:36864
    ds_read_b64_tr_b16 v[50:51], v33 offset:37120
    s_waitcnt lgkmcnt(6)
    v_mfma_f32_16x16x32_bf16 v[60:63], v[52:55], v[40:43], v[60:63]
    ds_read_b64_tr_b16 v[52:53], v32 offset:38912
    ds_read_b64_tr_b16 v[54:55], v32 offset:39168
    s_waitcnt lgkmcnt(6)
    v_mfma_f32_16x16x32_bf16 v[64:67], v[56:59], v[40:43], v[64:67]
    ds_read_b64_tr_b16 v[56:57], v33 offset:38912
    ds_read_b64_tr_b16 v[58:59], v33 offset:39168
    s_waitcnt lgkmcnt(6)
    v_mfma_f32_16x16x32_bf16 v[60:63], v[44:47], v[40:43], v[60:63]
    ds_read_b64_tr_b16 v[44:45], v32 offset:40960
    ds_read_b64_tr_b16 v[46:47], v32 offset:41216
    s_waitcnt lgkmcnt(6)
    v_mfma_f32_16x16x32_bf16 v[64:67], v[48:51], v[40:43], v[64:67]
    ds_read_b64_tr_b16 v[48:49], v33 offset:40960
    ds_read_b64_tr_b16 v[50:51], v33 offset:41216
    s_waitcnt lgkmcnt(6)
    v_mfma_f32_16x16x32_bf16 v[60:63], v[52:55], v[40:43], v[60:63]
    ds_read_b64_tr_b16 v[52:53], v32 offset:43008
    ds_read_b64_tr_b16 v[54:55], v32 offset:43264
    s_waitcnt lgkmcnt(6)
    v_mfma_f32_16x16x32_bf16 v[64:67], v[56:59], v[40:43], v[64:67]
    ds_read_b64_tr_b16 v[56:57], v33 offset:43008
    ds_read_b64_tr_b16 v[58:59], v33 offset:43264
    s_waitcnt lgkmcnt(6)
    v_mfma_f32_16x16x32_bf16 v[60:63], v[44:47], v[40:43], v[60:63]
    ds_read_b64_tr_b16 v[44:45], v32 offset:45056
    ds_read_b64_tr_b16 v[46:47], v32 offset:45312
    s_waitcnt lgkmcnt(6)
    v_mfma_f32_16x16x32_bf16 v[64:67], v[48:51], v[40:43], v[64:67]
    ds_read_b64_tr_b16 v[48:49], v33 offset:45056
    ds_read_b64_tr_b16 v[50:51], v33 offset:45312
    s_waitcnt lgkmcnt(6)
    v_mfma_f32_16x16x32_bf16 v[60:63], v[52:55], v[40:43], v[60:63]
    ds_read_b64_tr_b16 v[52:53], v32 offset:47104
    ds_read_b64_tr_b16 v[54:55], v32 offset:47360
    s_waitcnt lgkmcnt(6)
    v_mfma_f32_16x16x32_bf16 v[64:67], v[56:59], v[40:43], v[64:67]
    ds_read_b64_tr_b16 v[56:57], v33 offset:47104
    ds_read_b64_tr_b16 v[58:59], v33 offset:47360
    s_waitcnt lgkmcnt(6)
    v_mfma_f32_16x16x32_bf16 v[60:63], v[44:47], v[40:43], v[60:63]
    ds_read_b64_tr_b16 v[44:45], v32 offset:49152
    ds_read_b64_tr_b16 v[46:47], v32 offset:49408
    s_waitcnt lgkmcnt(6)
    v_mfma_f32_16x16x32_bf16 v[64:67], v[48:51], v[40:43], v[64:67]
    ds_read_b64_tr_b16 v[48:49], v33 offset:49152
    ds_read_b64_tr_b16 v[50:51], v33 offset:49408
    s_waitcnt lgkmcnt(6)
    v_mfma_f32_16x16x32_bf16 v[60:63], v[52:55], v[40:43], v[60:63]
    ds_read_b64_tr_b16 v[52:53], v32 offset:51200
    ds_read_b64_tr_b16 v[54:55], v32 offset:51456
    s_waitcnt lgkmcnt(6)
    v_mfma_f32_16x16x32_bf16 v[64:67], v[56:59], v[40:43], v[64:67]
    ds_read_b64_tr_b16 v[56:57], v33 offset:51200
    ds_read_b64_tr_b16 v[58:59], v33 offset:51456
    s_waitcnt lgkmcnt(6)
    v_mfma_f32_16x16x32_bf16 v[60:63], v[44:47], v[40:43], v[60:63]
    ds_read_b64_tr_b16 v[44:45], v32 offset:53248
    ds_read_b64_tr_b16 v[46:47], v32 offset:53504
    s_waitcnt lgkmcnt(6)
    v_mfma_f32_16x16x32_bf16 v[64:67], v[48:51], v[40:43], v[64:67]
    ds_read_b64_tr_b16 v[48:49], v33 offset:53248
    ds_read_b64_tr_b16 v[50:51], v33 offset:53504
    s_waitcnt lgkmcnt(6)
    v_mfma_f32_16x16x32_bf16 v[60:63], v[52:55], v[40:43], v[60:63]
    ds_read_b64_tr_b16 v[52:53], v32 offset:55296
    ds_read_b64_tr_b16 v[54:55], v32 offset:55552
    s_waitcnt lgkmcnt(6)
    v_mfma_f32_16x16x32_bf16 v[64:67], v[56:59], v[40:43], v[64:67]
    ds_read_b64_tr_b16 v[56:57], v33 offset:55296
    ds_read_b64_tr_b16 v[58:59], v33 offset:55552
    s_waitcnt lgkmcnt(6)
    v_mfma_f32_16x16x32_bf16 v[60:63], v[44:47], v[40:43], v[60:63]
    ds_read_b64_tr_b16 v[44:45], v32 offset:57344
    ds_read_b64_tr_b16 v[46:47], v32 offset:57600
    s_waitcnt lgkmcnt(6)
    v_mfma_f32_16x16x32_bf16 v[64:67], v[48:51], v[40:43], v[64:67]
    ds_read_b64_tr_b16 v[48:49], v33 offset:57344
    ds_read_b64_tr_b16 v[50:51], v33 offset:57600
    s_waitcnt lgkmcnt(6)
    v_mfma_f32_16x16x32_bf16 v[60:63], v[52:55], v[40:43], v[60:63]
    ds_read_b64_tr_b16 v[52:53], v32 offset:59392
    ds_read_b64_tr_b16 v[54:55], v32 offset:59648
    s_waitcnt lgkmcnt(6)
    v_mfma_f32_16x16x32_bf16 v[64:67], v[56:59], v[40:43], v[64:67]
    ds_read_b64_tr_b16 v[56:57], v33 offset:59392
    ds_read_b64_tr_b16 v[58:59], v33 offset:59648
    s_waitcnt lgkmcnt(6)
    v_mfma_f32_16x16x32_bf16 v[60:63], v[44:47], v[40:43], v[60:63]
    ds_read_b64_tr_b16 v[44:45], v32 offset:61440
    ds_read_b64_tr_b16 v[46:47], v32 offset:61696
    s_waitcnt lgkmcnt(6)
    v_mfma_f32_16x16x32_bf16 v[64:67], v[48:51], v[40:43], v[64:67]
    ds_read_b64_tr_b16 v[48:49], v33 offset:61440
    ds_read_b64_tr_b16 v[50:51], v33 offset:61696
    s_waitcnt lgkmcnt(6)
    v_mfma_f32_16x16x32_bf16 v[60:63], v[52:55], v[40:43], v[60:63]
    ds_read_b64_tr_b16 v[52:53], v32 offset:63488
    ds_read_b64_tr_b16 v[54:55], v32 offset:63744
    s_waitcnt lgkmcnt(6)
    v_mfma_f32_16x16x32_bf16 v[64:67], v[56:59], v[40:43], v[64:67]
    ds_read_b64_tr_b16 v[56:57], v33 offset:63488
    ds_read_b64_tr_b16 v[58:59], v33 offset:63744
    s_waitcnt lgkmcnt(6)
    v_mfma_f32_16x16x32_bf16 v[60:63], v[44:47], v[40:43], v[60:63]
    s_waitcnt lgkmcnt(4)
    v_mfma_f32_16x16x32_bf16 v[64:67], v[48:51], v[40:43], v[64:67]
    s_waitcnt lgkmcnt(2)
    v_mfma_f32_16x16x32_bf16 v[60:63], v[52:55], v[40:43], v[60:63]
    s_waitcnt lgkmcnt(0)
    v_mfma_f32_16x16x32_bf16 v[64:67], v[56:59], v[40:43], v[64:67]
L_nl0_main_kernel:
    s_cmp_eq_u32 s62, 0
    s_cbranch_scc1 L_lh_main_kernel
    s_waitcnt vmcnt(32)
    s_barrier
L_lh_main_kernel:
    s_nop 7
    s_mov_b32 exec_lo, 0x00010001
    s_mov_b32 exec_hi, 0x00010001
    ds_write_b128 v132, v[60:63] offset:0
    ds_write_b128 v132, v[64:67] offset:64
    ds_write_b128 v132, v[68:71] offset:128
    ds_write_b128 v132, v[72:75] offset:192
    ds_write_b128 v132, v[76:79] offset:256
    ds_write_b128 v132, v[80:83] offset:320
    s_mov_b64 exec, -1
    v_add_u32 v15, 0x1fc00, v5
    ds_write_b128 v15, v[124:127]
    s_cmp_eq_u32 s62, 0
    s_cbranch_scc1 L_lq_main_kernel
    s_waitcnt vmcnt(0)
L_lq_main_kernel:
    s_waitcnt lgkmcnt(0)
    s_barrier
    s_cmp_lg_u32 s62, 0
    s_cbranch_scc1 L_nl1_main_kernel
    s_lshl_b32 s63, s2, 2
    s_add_u32 s63, s63, 0
    s_mov_b32 s12, s74
    s_mov_b32 s13, s75
    s_mov_b32 s39, s63
    s_sub_u32 s38, s63, 128
    s_cmp_ge_u32 s63, 128
    s_cselect_b32 s12, s76, s12
    s_cselect_b32 s13, s77, s13
    s_cselect_b32 s39, s38, s39
    s_sub_u32 s38, s63, 256
    s_cmp_ge_u32 s63, 256
    s_cselect_b32 s12, s78, s12
    s_cselect_b32 s13, s79, s13
    s_cselect_b32 s39, s38, s39
    s_sub_u32 s38, s63, 600
    s_cmp_ge_u32 s63, 600
    s_cselect_b32 s12, s80, s12
    s_cselect_b32 s13, s81, s13
    s_cselect_b32 s39, s38, s39
    s_min_u32 s39, s39, 343
    s_cmp_ge_u32 s63, 944
    s_cselect_b32 s39, 0, s39
    s_lshl_b32 s39, s39, 12
    s_mov_b32 s14, 0x200000
    s_mov_b32 s15, 0x00020000
    buffer_load_dword v16, v10, s[12:15], s39 offen
    s_lshl_b32 s63, s2, 2
    s_add_u32 s63, s63, 1
    s_mov_b32 s12, s74
    s_mov_b32 s13, s75
    s_mov_b32 s39, s63
    s_sub_u32 s38, s63, 128
    s_cmp_ge_u32 s63, 128
    s_cselect_b32 s12, s76, s12
    s_cselect_b32 s13, s77, s13
    s_cselect_b32 s39, s38, s39
    s_sub_u32 s38, s63, 256
    s_cmp_ge_u32 s63, 256
    s_cselect_b32 s12, s78, s12
    s_cselect_b32 s13, s79, s13
    s_cselect_b32 s39, s38, s39
    s_sub_u32 s38, s63, 600
    s_cmp_ge_u32 s63, 600
    s_cselect_b32 s12, s80, s12
    s_cselect_b32 s13, s81, s13
    s_cselect_b32 s39, s38, s39
    s_min_u32 s39, s39, 343
    s_cmp_ge_u32 s63, 944
    s_cselect_b32 s39, 0, s39
    s_lshl_b32 s39, s39, 12
    s_mov_b32 s14, 0x200000
    s_mov_b32 s15, 0x00020000
    buffer_load_dword v16, v10, s[12:15], s39 offen
    s_lshl_b32 s63, s2, 2
    s_add_u32 s63, s63, 2
    s_mov_b32 s12, s74
    s_mov_b32 s13, s75
    s_mov_b32 s39, s63
    s_sub_u32 s38, s63, 128
    s_cmp_ge_u32 s63, 128
    s_cselect_b32 s12, s76, s12
    s_cselect_b32 s13, s77, s13
    s_cselect_b32 s39, s38, s39
    s_sub_u32 s38, s63, 256
    s_cmp_ge_u32 s63, 256
    s_cselect_b32 s12, s78, s12
    s_cselect_b32 s13, s79, s13
    s_cselect_b32 s39, s38, s39
    s_sub_u32 s38, s63, 600
    s_cmp_ge_u32 s63, 600
    s_cselect_b32 s12, s80, s12
    s_cselect_b32 s13, s81, s13
    s_cselect_b32 s39, s38, s39
    s_min_u32 s39, s39, 343
    s_cmp_ge_u32 s63, 944
    s_cselect_b32 s39, 0, s39
    s_lshl_b32 s39, s39, 12
    s_mov_b32 s14, 0x200000
    s_mov_b32 s15, 0x00020000
    buffer_load_dword v16, v10, s[12:15], s39 offen
    s_lshl_b32 s63, s2, 2
    s_add_u32 s63, s63, 3
    s_mov_b32 s12, s74
    s_mov_b32 s13, s75
    s_mov_b32 s39, s63
    s_sub_u32 s38, s63, 128
    s_cmp_ge_u32 s63, 128
    s_cselect_b32 s12, s76, s12
    s_cselect_b32 s13, s77, s13
    s_cselect_b32 s39, s38, s39
    s_sub_u32 s38, s63, 256
    s_cmp_ge_u32 s63, 256
    s_cselect_b32 s12, s78, s12
    s_cselect_b32 s13, s79, s13
    s_cselect_b32 s39, s38, s39
    s_sub_u32 s38, s63, 600
    s_cmp_ge_u32 s63, 600
    s_cselect_b32 s12, s80, s12
    s_cselect_b32 s13, s81, s13
    s_cselect_b32 s39, s38, s39
    s_min_u32 s39, s39, 343
    s_cmp_ge_u32 s63, 944
    s_cselect_b32 s39, 0, s39
    s_lshl_b32 s39, s39, 12
    s_mov_b32 s14, 0x200000
    s_mov_b32 s15, 0x00020000
    buffer_load_dword v16, v10, s[12:15], s39 offen
L_nl1_main_kernel:
    s_barrier
    s_lshl_b32 s38, s33, 16
    s_lshl_b32 s39, s34, 11
    s_add_u32 s38, s38, s39
    s_add_u32 s4, s38, 0x200000
    buffer_store_dwordx4 v[28:31], v5, s[52:55], s4 offen offset:0
    s_add_u32 s4, s38, 0x200400
    buffer_store_dwordx4 v[28:31], v5, s[52:55], s4 offen offset:0
    s_add_u32 s4, s38, 0x204000
    buffer_store_dwordx4 v[28:31], v5, s[52:55], s4 offen offset:0
    s_add_u32 s4, s38, 0x204400
    buffer_store_dwordx4 v[28:31], v5, s[52:55], s4 offen offset:0
    s_add_u32 s4, s38, 0x208000
    buffer_store_dwordx4 v[28:31], v5, s[52:55], s4 offen offset:0
    s_add_u32 s4, s38, 0x208400
    buffer_store_dwordx4 v[28:31], v5, s[52:55], s4 offen offset:0
    s_add_u32 s4, s38, 0x20c000
    buffer_store_dwordx4 v[28:31], v5, s[52:55], s4 offen offset:0
    s_add_u32 s4, s38, 0x20c400
    buffer_store_dwordx4 v[28:31], v5, s[52:55], s4 offen offset:0
    s_add_u32 s4, s38, 0x800000
    buffer_store_dwordx4 v[28:31], v5, s[52:55], s4 offen offset:0 sc1
    s_add_u32 s4, s38, 0x800400
    buffer_store_dwordx4 v[28:31], v5, s[52:55], s4 offen offset:0 sc1
    s_add_u32 s4, s38, 0x804000
    buffer_store_dwordx4 v[28:31], v5, s[52:55], s4 offen offset:0
    s_add_u32 s4, s38, 0x804400
    buffer_store_dwordx4 v[28:31], v5, s[52:55], s4 offen offset:0
    s_add_u32 s4, s38, 0x808000
    buffer_store_dwordx4 v[28:31], v5, s[52:55], s4 offen offset:0
    s_add_u32 s4, s38, 0x808400
    buffer_store_dwordx4 v[28:31], v5, s[52:55], s4 offen offset:0
    s_add_u32 s4, s38, 0x80c000
    buffer_store_dwordx4 v[28:31], v5, s[52:55], s4 offen offset:0 sc1
    s_add_u32 s4, s38, 0x80c400
    buffer_store_dwordx4 v[28:31], v5, s[52:55], s4 offen offset:0 sc1
    s_add_u32 s4, s38, 0xa00000
    buffer_store_dwordx4 v[28:31], v5, s[52:55], s4 offen offset:0
    s_add_u32 s4, s38, 0xa00400
    buffer_store_dwordx4 v[28:31], v5, s[52:55], s4 offen offset:0
    s_add_u32 s4, s38, 0xa04000
    buffer_store_dwordx4 v[28:31], v5, s[52:55], s4 offen offset:0
    s_add_u32 s4, s38, 0xa04400
    buffer_store_dwordx4 v[28:31], v5, s[52:55], s4 offen offset:0
    s_add_u32 s4, s38, 0xa08000
    buffer_store_dwordx4 v[28:31], v5, s[52:55], s4 offen offset:0
    s_add_u32 s4, s38, 0xa08400
    buffer_store_dwordx4 v[28:31], v5, s[52:55], s4 offen offset:0
    s_add_u32 s4, s38, 0xa0c000
    buffer_store_dwordx4 v[28:31], v5, s[52:55], s4 offen offset:0
    s_add_u32 s4, s38, 0xa0c400
    buffer_store_dwordx4 v[28:31], v5, s[52:55], s4 offen offset:0
    s_lshl_b32 s38, s34, 14
    s_lshl_b32 s39, s33, 9
    s_add_u32 s38, s38, s39
    s_mov_b64 exec, 0xffffffff
    s_add_u32 s4, s38, 0x1220000
    buffer_store_dwordx4 v[28:31], v5, s[52:55], s4 offen offset:0
    s_add_u32 s4, s38, 0x1240000
    buffer_store_dwordx4 v[28:31], v5, s[52:55], s4 offen offset:0
    s_mov_b64 exec, -1
    s_mov_b32 s12, s70
    s_mov_b32 s13, s71
    s_mov_b32 s14, 0x80000
    s_mov_b32 s15, 0x00020000
    s_lshl_b32 s95, s34, 7
    s_add_u32 s37, s95, 0x0
    s_mov_b32 m0, 0x18000
    s_nop 0
    buffer_load_dwordx4 v13, s[12:15], s37 offen lds
    s_add_u32 s37, s95, 0x40
    s_mov_b32 m0, 0x20000
    s_nop 0
    buffer_load_dwordx4 v13, s[12:15], s37 offen lds
    s_add_u32 s37, s95, 0x4000
    s_mov_b32 m0, 0x18400
    s_nop 0
    buffer_load_dwordx4 v13, s[12:15], s37 offen lds
    s_add_u32 s37, s95, 0x4040
    s_mov_b32 m0, 0x20400
    s_nop 0
    buffer_load_dwordx4 v13, s[12:15], s37 offen lds
    s_add_u32 s37, s95, 0x8000
    s_mov_b32 m0, 0x18800
    s_nop 0
    buffer_load_dwordx4 v13, s[12:15], s37 offen lds
    s_add_u32 s37, s95, 0x8040
    s_mov_b32 m0, 0x20800
    s_nop 0
    buffer_load_dwordx4 v13, s[12:15], s37 offen lds
    s_add_u32 s37, s95, 0xc000
    s_mov_b32 m0, 0x18c00
    s_nop 0
    buffer_load_dwordx4 v13, s[12:15], s37 offen lds
    s_add_u32 s37, s95, 0xc040
    s_mov_b32 m0, 0x20c00
    s_nop 0
    buffer_load_dwordx4 v13, s[12:15], s37 offen lds
    s_add_u32 s37, s95, 0x10000
    s_mov_b32 m0, 0x19000
    s_nop 0
    buffer_load_dwordx4 v13, s[12:15], s37 offen lds
    s_add_u32 s37, s95, 0x10040
    s_mov_b32 m0, 0x21000
    s_nop 0
    buffer_load_dwordx4 v13, s[12:15], s37 offen lds
    s_add_u32 s37, s95, 0x14000
    s_mov_b32 m0, 0x19400
    s_nop 0
    buffer_load_dwordx4 v13, s[12:15], s37 offen lds
    s_add_u32 s37, s95, 0x14040
    s_mov_b32 m0, 0x21400
    s_nop 0
    buffer_load_dwordx4 v13, s[12:15], s37 offen lds
    s_add_u32 s37, s95, 0x18000
    s_mov_b32 m0, 0x19800
    s_nop 0
    buffer_load_dwordx4 v13, s[12:15], s37 offen lds
    s_add_u32 s37, s95, 0x18040
    s_mov_b32 m0, 0x21800
    s_nop 0
    buffer_load_dwordx4 v13, s[12:15], s37 offen lds
    s_add_u32 s37, s95, 0x1c000
    s_mov_b32 m0, 0x19c00
    s_nop 0
    buffer_load_dwordx4 v13, s[12:15], s37 offen lds
    s_add_u32 s37, s95, 0x1c040
    s_mov_b32 m0, 0x21c00
    s_nop 0
    buffer_load_dwordx4 v13, s[12:15], s37 offen lds
    s_add_u32 s37, s95, 0x20000
    s_mov_b32 m0, 0x1a000
    s_nop 0
    buffer_load_dwordx4 v13, s[12:15], s37 offen lds
    s_add_u32 s37, s95, 0x20040
    s_mov_b32 m0, 0x22000
    s_nop 0
    buffer_load_dwordx4 v13, s[12:15], s37 offen lds
    s_add_u32 s37, s95, 0x24000
    s_mov_b32 m0, 0x1a400
    s_nop 0
    buffer_load_dwordx4 v13, s[12:15], s37 offen lds
    s_add_u32 s37, s95, 0x24040
    s_mov_b32 m0, 0x22400
    s_nop 0
    buffer_load_dwordx4 v13, s[12:15], s37 offen lds
    s_add_u32 s37, s95, 0x28000
    s_mov_b32 m0, 0x1a800
    s_nop 0
    buffer_load_dwordx4 v13, s[12:15], s37 offen lds
    s_add_u32 s37, s95, 0x28040
    s_mov_b32 m0, 0x22800
    s_nop 0
    buffer_load_dwordx4 v13, s[12:15], s37 offen lds
    s_add_u32 s37, s95, 0x2c000
    s_mov_b32 m0, 0x1ac00
    s_nop 0
    buffer_load_dwordx4 v13, s[12:15], s37 offen lds
    s_add_u32 s37, s95, 0x2c040
    s_mov_b32 m0, 0x22c00
    s_nop 0
    buffer_load_dwordx4 v13, s[12:15], s37 offen lds
    s_add_u32 s37, s95, 0x30000
    s_mov_b32 m0, 0x1b000
    s_nop 0
    buffer_load_dwordx4 v13, s[12:15], s37 offen lds
    s_add_u32 s37, s95, 0x30040
    s_mov_b32 m0, 0x23000
    s_nop 0
    buffer_load_dwordx4 v13, s[12:15], s37 offen lds
    s_add_u32 s37, s95, 0x34000
    s_mov_b32 m0, 0x1b400
    s_nop 0
    buffer_load_dwordx4 v13, s[12:15], s37 offen lds
    s_add_u32 s37, s95, 0x34040
    s_mov_b32 m0, 0x23400
    s_nop 0
    buffer_load_dwordx4 v13, s[12:15], s37 offen lds
    s_add_u32 s37, s95, 0x38000
    s_mov_b32 m0, 0x1b800
    s_nop 0
    buffer_load_dwordx4 v13, s[12:15], s37 offen lds
    s_add_u32 s37, s95, 0x38040
    s_mov_b32 m0, 0x23800
    s_nop 0
    buffer_load_dwordx4 v13, s[12:15], s37 offen lds
    s_add_u32 s37, s95, 0x3c000
    s_mov_b32 m0, 0x1bc00
    s_nop 0
    buffer_load_dwordx4 v13, s[12:15], s37 offen lds
    s_add_u32 s37, s95, 0x3c040
    s_mov_b32 m0, 0x23c00
    s_nop 0
    buffer_load_dwordx4 v13, s[12:15], s37 offen lds
    s_add_u32 s37, s95, 0x40000
    s_mov_b32 m0, 0x1c000
    s_nop 0
    buffer_load_dwordx4 v13, s[12:15], s37 offen lds
    s_add_u32 s37, s95, 0x40040
    s_mov_b32 m0, 0x24000
    s_nop 0
    buffer_load_dwordx4 v13, s[12:15], s37 offen lds
    s_add_u32 s37, s95, 0x44000
    s_mov_b32 m0, 0x1c400
    s_nop 0
    buffer_load_dwordx4 v13, s[12:15], s37 offen lds
    s_add_u32 s37, s95, 0x44040
    s_mov_b32 m0, 0x24400
    s_nop 0
    buffer_load_dwordx4 v13, s[12:15], s37 offen lds
    s_add_u32 s37, s95, 0x48000
    s_mov_b32 m0, 0x1c800
    s_nop 0
    buffer_load_dwordx4 v13, s[12:15], s37 offen lds
    s_add_u32 s37, s95, 0x48040
    s_mov_b32 m0, 0x24800
    s_nop 0
    buffer_load_dwordx4 v13, s[12:15], s37 offen lds
    s_add_u32 s37, s95, 0x4c000
    s_mov_b32 m0, 0x1cc00
    s_nop 0
    buffer_load_dwordx4 v13, s[12:15], s37 offen lds
    s_add_u32 s37, s95, 0x4c040
    s_mov_b32 m0, 0x24c00
    s_nop 0
    buffer_load_dwordx4 v13, s[12:15], s37 offen lds
    s_add_u32 s37, s95, 0x50000
    s_mov_b32 m0, 0x1d000
    s_nop 0
    buffer_load_dwordx4 v13, s[12:15], s37 offen lds
    s_add_u32 s37, s95, 0x50040
    s_mov_b32 m0, 0x25000
    s_nop 0
    buffer_load_dwordx4 v13, s[12:15], s37 offen lds
    s_add_u32 s37, s95, 0x54000
    s_mov_b32 m0, 0x1d400
    s_nop 0
    buffer_load_dwordx4 v13, s[12:15], s37 offen lds
    s_add_u32 s37, s95, 0x54040
    s_mov_b32 m0, 0x25400
    s_nop 0
    buffer_load_dwordx4 v13, s[12:15], s37 offen lds
    s_add_u32 s37, s95, 0x58000
    s_mov_b32 m0, 0x1d800
    s_nop 0
    buffer_load_dwordx4 v13, s[12:15], s37 offen lds
    s_add_u32 s37, s95, 0x58040
    s_mov_b32 m0, 0x25800
    s_nop 0
    buffer_load_dwordx4 v13, s[12:15], s37 offen lds
    s_add_u32 s37, s95, 0x5c000
    s_mov_b32 m0, 0x1dc00
    s_nop 0
    buffer_load_dwordx4 v13, s[12:15], s37 offen lds
    s_add_u32 s37, s95, 0x5c040
    s_mov_b32 m0, 0x25c00
    s_nop 0
    buffer_load_dwordx4 v13, s[12:15], s37 offen lds
    s_add_u32 s37, s95, 0x60000
    s_mov_b32 m0, 0x1e000
    s_nop 0
    buffer_load_dwordx4 v13, s[12:15], s37 offen lds
    s_add_u32 s37, s95, 0x60040
    s_mov_b32 m0, 0x26000
    s_nop 0
    buffer_load_dwordx4 v13, s[12:15], s37 offen lds
    s_add_u32 s37, s95, 0x64000
    s_mov_b32 m0, 0x1e400
    s_nop 0
    buffer_load_dwordx4 v13, s[12:15], s37 offen lds
    s_add_u32 s37, s95, 0x64040
    s_mov_b32 m0, 0x26400
    s_nop 0
    buffer_load_dwordx4 v13, s[12:15], s37 offen lds
    s_add_u32 s37, s95, 0x68000
    s_mov_b32 m0, 0x1e800
    s_nop 0
    buffer_load_dwordx4 v13, s[12:15], s37 offen lds
    s_add_u32 s37, s95, 0x68040
    s_mov_b32 m0, 0x26800
    s_nop 0
    buffer_load_dwordx4 v13, s[12:15], s37 offen lds
    s_add_u32 s37, s95, 0x6c000
    s_mov_b32 m0, 0x1ec00
    s_nop 0
    buffer_load_dwordx4 v13, s[12:15], s37 offen lds
    s_add_u32 s37, s95, 0x6c040
    s_mov_b32 m0, 0x26c00
    s_nop 0
    buffer_load_dwordx4 v13, s[12:15], s37 offen lds
    s_waitcnt vmcnt(56)
    s_barrier
    s_mov_b32 s12, s70
    s_mov_b32 s13, s71
    s_mov_b32 s14, 0x80000
    s_mov_b32 s15, 0x00020000
    s_lshl_b32 s95, s34, 7
    s_add_u32 s37, s95, 0x70000
    s_mov_b32 m0, 0x1f000
    s_nop 0
    buffer_load_dwordx4 v13, s[12:15], s37 offen lds
    s_add_u32 s37, s95, 0x70040
    s_mov_b32 m0, 0x27000
    s_nop 0
    buffer_load_dwordx4 v13, s[12:15], s37 offen lds
    s_add_u32 s37, s95, 0x74000
    s_mov_b32 m0, 0x1f400
    s_nop 0
    buffer_load_dwordx4 v13, s[12:15], s37 offen lds
    s_add_u32 s37, s95, 0x74040
    s_mov_b32 m0, 0x27400
    s_nop 0
    buffer_load_dwordx4 v13, s[12:15], s37 offen lds
    s_add_u32 s37, s95, 0x78000
    s_mov_b32 m0, 0x1f800
    s_nop 0
    buffer_load_dwordx4 v13, s[12:15], s37 offen lds
    s_add_u32 s37, s95, 0x78040
    s_mov_b32 m0, 0x27800
    s_nop 0
    buffer_load_dwordx4 v13, s[12:15], s37 offen lds
    s_add_u32 s37, s95, 0x7c000
    s_mov_b32 m0, 0x1fc00
    s_nop 0
    buffer_load_dwordx4 v13, s[12:15], s37 offen lds
    s_add_u32 s37, s95, 0x7c040
    s_mov_b32 m0, 0x27c00
    s_nop 0
    buffer_load_dwordx4 v13, s[12:15], s37 offen lds
    s_mov_b32 s12, s74
    s_mov_b32 s13, s75
    s_mov_b32 s14, 0x80000
    s_mov_b32 s15, 0x00020000
    s_lshl_b32 s95, s34, 7
    s_add_u32 s37, s95, 0x0
    s_mov_b32 m0, 0x0
    s_nop 0
    buffer_load_dwordx4 v12, s[12:15], s37 offen lds
    s_add_u32 s37, s95, 0x40
    s_mov_b32 m0, 0x8000
    s_nop 0
    buffer_load_dwordx4 v12, s[12:15], s37 offen lds
    s_add_u32 s37, s95, 0x4000
    s_mov_b32 m0, 0x400
    s_nop 0
    buffer_load_dwordx4 v12, s[12:15], s37 offen lds
    s_add_u32 s37, s95, 0x4040
    s_mov_b32 m0, 0x8400
    s_nop 0
    buffer_load_dwordx4 v12, s[12:15], s37 offen lds
    s_add_u32 s37, s95, 0x8000
    s_mov_b32 m0, 0x800
    s_nop 0
    buffer_load_dwordx4 v12, s[12:15], s37 offen lds
    s_add_u32 s37, s95, 0x8040
    s_mov_b32 m0, 0x8800
    s_nop 0
    buffer_load_dwordx4 v12, s[12:15], s37 offen lds
    s_add_u32 s37, s95, 0xc000
    s_mov_b32 m0, 0xc00
    s_nop 0
    buffer_load_dwordx4 v12, s[12:15], s37 offen lds
    s_add_u32 s37, s95, 0xc040
    s_mov_b32 m0, 0x8c00
    s_nop 0
    buffer_load_dwordx4 v12, s[12:15], s37 offen lds
    s_add_u32 s37, s95, 0x10000
    s_mov_b32 m0, 0x1000
    s_nop 0
    buffer_load_dwordx4 v12, s[12:15], s37 offen lds
    s_add_u32 s37, s95, 0x10040
    s_mov_b32 m0, 0x9000
    s_nop 0
    buffer_load_dwordx4 v12, s[12:15], s37 offen lds
    s_add_u32 s37, s95, 0x14000
    s_mov_b32 m0, 0x1400
    s_nop 0
    buffer_load_dwordx4 v12, s[12:15], s37 offen lds
    s_add_u32 s37, s95, 0x14040
    s_mov_b32 m0, 0x9400
    s_nop 0
    buffer_load_dwordx4 v12, s[12:15], s37 offen lds
    s_add_u32 s37, s95, 0x18000
    s_mov_b32 m0, 0x1800
    s_nop 0
    buffer_load_dwordx4 v12, s[12:15], s37 offen lds
    s_add_u32 s37, s95, 0x18040
    s_mov_b32 m0, 0x9800
    s_nop 0
    buffer_load_dwordx4 v12, s[12:15], s37 offen lds
    s_add_u32 s37, s95, 0x1c000
    s_mov_b32 m0, 0x1c00
    s_nop 0
    buffer_load_dwordx4 v12, s[12:15], s37 offen lds
    s_add_u32 s37, s95, 0x1c040
    s_mov_b32 m0, 0x9c00
    s_nop 0
    buffer_load_dwordx4 v12, s[12:15], s37 offen lds
    s_add_u32 s37, s95, 0x20000
    s_mov_b32 m0, 0x2000
    s_nop 0
    buffer_load_dwordx4 v12, s[12:15], s37 offen lds
    s_add_u32 s37, s95, 0x20040
    s_mov_b32 m0, 0xa000
    s_nop 0
    buffer_load_dwordx4 v12, s[12:15], s37 offen lds
    s_add_u32 s37, s95, 0x24000
    s_mov_b32 m0, 0x2400
    s_nop 0
    buffer_load_dwordx4 v12, s[12:15], s37 offen lds
    s_add_u32 s37, s95, 0x24040
    s_mov_b32 m0, 0xa400
    s_nop 0
    buffer_load_dwordx4 v12, s[12:15], s37 offen lds
    s_add_u32 s37, s95, 0x28000
    s_mov_b32 m0, 0x2800
    s_nop 0
    buffer_load_dwordx4 v12, s[12:15], s37 offen lds
    s_add_u32 s37, s95, 0x28040
    s_mov_b32 m0, 0xa800
    s_nop 0
    buffer_load_dwordx4 v12, s[12:15], s37 offen lds
    s_add_u32 s37, s95, 0x2c000
    s_mov_b32 m0, 0x2c00
    s_nop 0
    buffer_load_dwordx4 v12, s[12:15], s37 offen lds
    s_add_u32 s37, s95, 0x2c040
    s_mov_b32 m0, 0xac00
    s_nop 0
    buffer_load_dwordx4 v12, s[12:15], s37 offen lds
    s_add_u32 s37, s95, 0x30000
    s_mov_b32 m0, 0x3000
    s_nop 0
    buffer_load_dwordx4 v12, s[12:15], s37 offen lds
    s_add_u32 s37, s95, 0x30040
    s_mov_b32 m0, 0xb000
    s_nop 0
    buffer_load_dwordx4 v12, s[12:15], s37 offen lds
    s_add_u32 s37, s95, 0x34000
    s_mov_b32 m0, 0x3400
    s_nop 0
    buffer_load_dwordx4 v12, s[12:15], s37 offen lds
    s_add_u32 s37, s95, 0x34040
    s_mov_b32 m0, 0xb400
    s_nop 0
    buffer_load_dwordx4 v12, s[12:15], s37 offen lds
    s_add_u32 s37, s95, 0x38000
    s_mov_b32 m0, 0x3800
    s_nop 0
    buffer_load_dwordx4 v12, s[12:15], s37 offen lds
    s_add_u32 s37, s95, 0x38040
    s_mov_b32 m0, 0xb800
    s_nop 0
    buffer_load_dwordx4 v12, s[12:15], s37 offen lds
    s_add_u32 s37, s95, 0x3c000
    s_mov_b32 m0, 0x3c00
    s_nop 0
    buffer_load_dwordx4 v12, s[12:15], s37 offen lds
    s_add_u32 s37, s95, 0x3c040
    s_mov_b32 m0, 0xbc00
    s_nop 0
    buffer_load_dwordx4 v12, s[12:15], s37 offen lds
    s_cmp_lg_u32 s62, 0
    s_cbranch_scc1 L_nl2_main_kernel
    s_mov_b32 s63, 0
    s_mov_b32 s39, 0x10000
L_pa_main_kernel:
    buffer_load_dwordx4 v[20:23], v5, s[28:31], s39 offen sc1
    s_waitcnt vmcnt(0)
    v_subrev_u32 v20, v25, v20
    v_subrev_u32 v21, v25, v21
    v_subrev_u32 v22, v25, v22
    v_subrev_u32 v23, v25, v23
    v_or3_b32 v20, v20, v21, v22
    v_or_b32 v20, v20, v23
    v_and_b32 v20, 0xffffff9f, v20
    v_cmp_ne_u32 vcc, 0, v20
    s_cbranch_vccz L_ga_main_kernel
    s_sleep 2
    s_add_u32 s63, s63, 1
    s_cmp_lt_u32 s63, 40000
    s_cbranch_scc1 L_pa_main_kernel
L_ga_main_kernel:
    s_barrier
L_nl2_main_kernel:
    s_mov_b32 s12, s74
    s_mov_b32 s13, s75
    s_mov_b32 s14, 0x80000
    s_mov_b32 s15, 0x00020000
    s_lshl_b32 s95, s34, 7
    s_add_u32 s37, s95, 0x40000
    s_mov_b32 m0, 0x4000
    s_nop 0
    buffer_load_dwordx4 v12, s[12:15], s37 offen lds
    s_add_u32 s37, s95, 0x40040
    s_mov_b32 m0, 0xc000
    s_nop 0
    buffer_load_dwordx4 v12, s[12:15], s37 offen lds
    s_add_u32 s37, s95, 0x44000
    s_mov_b32 m0, 0x4400
    s_nop 0
    buffer_load_dwordx4 v12, s[12:15], s37 offen lds
    s_add_u32 s37, s95, 0x44040
    s_mov_b32 m0, 0xc400
    s_nop 0
    buffer_load_dwordx4 v12, s[12:15], s37 offen lds
    s_add_u32 s37, s95, 0x48000
    s_mov_b32 m0, 0x4800
    s_nop 0
    buffer_load_dwordx4 v12, s[12:15], s37 offen lds
    s_add_u32 s37, s95, 0x48040
    s_mov_b32 m0, 0xc800
    s_nop 0
    buffer_load_dwordx4 v12, s[12:15], s37 offen lds
    s_add_u32 s37, s95, 0x4c000
    s_mov_b32 m0, 0x4c00
    s_nop 0
    buffer_load_dwordx4 v12, s[12:15], s37 offen lds
    s_add_u32 s37, s95, 0x4c040
    s_mov_b32 m0, 0xcc00
    s_nop 0
    buffer_load_dwordx4 v12, s[12:15], s37 offen lds
    s_add_u32 s37, s95, 0x50000
    s_mov_b32 m0, 0x5000
    s_nop 0
    buffer_load_dwordx4 v12, s[12:15], s37 offen lds
    s_add_u32 s37, s95, 0x50040
    s_mov_b32 m0, 0xd000
    s_nop 0
    buffer_load_dwordx4 v12, s[12:15], s37 offen lds
    s_add_u32 s37, s95, 0x54000
    s_mov_b32 m0, 0x5400
    s_nop 0
    buffer_load_dwordx4 v12, s[12:15], s37 offen lds
    s_add_u32 s37, s95, 0x54040
    s_mov_b32 m0, 0xd400
    s_nop 0
    buffer_load_dwordx4 v12, s[12:15], s37 offen lds
    s_add_u32 s37, s95, 0x58000
    s_mov_b32 m0, 0x5800
    s_nop 0
    buffer_load_dwordx4 v12, s[12:15], s37 offen lds
    s_add_u32 s37, s95, 0x58040
    s_mov_b32 m0, 0xd800
    s_nop 0
    buffer_load_dwordx4 v12, s[12:15], s37 offen lds
    s_add_u32 s37, s95, 0x5c000
    s_mov_b32 m0, 0x5c00
    s_nop 0
    buffer_load_dwordx4 v12, s[12:15], s37 offen lds
    s_add_u32 s37, s95, 0x5c040
    s_mov_b32 m0, 0xdc00
    s_nop 0
    buffer_load_dwordx4 v12, s[12:15], s37 offen lds
    s_add_u32 s37, s95, 0x60000
    s_mov_b32 m0, 0x6000
    s_nop 0
    buffer_load_dwordx4 v12, s[12:15], s37 offen lds
    s_add_u32 s37, s95, 0x60040
    s_mov_b32 m0, 0xe000
    s_nop 0
    buffer_load_dwordx4 v12, s[12:15], s37 offen lds
    s_add_u32 s37, s95, 0x64000
    s_mov_b32 m0, 0x6400
    s_nop 0
    buffer_load_dwordx4 v12, s[12:15], s37 offen lds
    s_add_u32 s37, s95, 0x64040
    s_mov_b32 m0, 0xe400
    s_nop 0
    buffer_load_dwordx4 v12, s[12:15], s37 offen lds
    s_add_u32 s37, s95, 0x68000
    s_mov_b32 m0, 0x6800
    s_nop 0
    buffer_load_dwordx4 v12, s[12:15], s37 offen lds
    s_add_u32 s37, s95, 0x68040
    s_mov_b32 m0, 0xe800
    s_nop 0
    buffer_load_dwordx4 v12, s[12:15], s37 offen lds
    s_add_u32 s37, s95, 0x6c000
    s_mov_b32 m0, 0x6c00
    s_nop 0
    buffer_load_dwordx4 v12, s[12:15], s37 offen lds
    s_add_u32 s37, s95, 0x6c040
    s_mov_b32 m0, 0xec00
    s_nop 0
    buffer_load_dwordx4 v12, s[12:15], s37 offen lds
    s_add_u32 s37, s95, 0x70000
    s_mov_b32 m0, 0x7000
    s_nop 0
    buffer_load_dwordx4 v12, s[12:15], s37 offen lds
    s_add_u32 s37, s95, 0x70040
    s_mov_b32 m0, 0xf000
    s_nop 0
    buffer_load_dwordx4 v12, s[12:15], s37 offen lds
    s_add_u32 s37, s95, 0x74000
    s_mov_b32 m0, 0x7400
    s_nop 0
    buffer_load_dwordx4 v12, s[12:15], s37 offen lds
    s_add_u32 s37, s95, 0x74040
    s_mov_b32 m0, 0xf400
    s_nop 0
    buffer_load_dwordx4 v12, s[12:15], s37 offen lds
    s_add_u32 s37, s95, 0x78000
    s_mov_b32 m0, 0x7800
    s_nop 0
    buffer_load_dwordx4 v12, s[12:15], s37 offen lds
    s_add_u32 s37, s95, 0x78040
    s_mov_b32 m0, 0xf800
    s_nop 0
    buffer_load_dwordx4 v12, s[12:15], s37 offen lds
    s_add_u32 s37, s95, 0x7c000
    s_mov_b32 m0, 0x7c00
    s_nop 0
    buffer_load_dwordx4 v12, s[12:15], s37 offen lds
    s_add_u32 s37, s95, 0x7c040
    s_mov_b32 m0, 0xfc00
    s_nop 0
    buffer_load_dwordx4 v12, s[12:15], s37 offen lds
    s_waitcnt vmcnt(63)
    s_barrier
    s_cmp_lg_u32 s62, 0
    s_cbranch_scc1 L_nl3_main_kernel
    s_waitcnt vmcnt(0)
    ds_read_b64_tr_b16 v[44:45], v32 offset:0
    ds_read_b64_tr_b16 v[46:47], v32 offset:256
    ds_read_b64_tr_b16 v[48:49], v33 offset:0
    ds_read_b64_tr_b16 v[50:51], v33 offset:256
    ds_read_b64_tr_b16 v[52:53], v32 offset:32768
    ds_read_b64_tr_b16 v[54:55], v32 offset:33024
    ds_read_b64_tr_b16 v[56:57], v33 offset:32768
    ds_read_b64_tr_b16 v[58:59], v33 offset:33024
    s_waitcnt lgkmcnt(6)
    v_mfma_f32_16x16x32_bf16 v[84:87], v[44:47], v[40:43], 0
    ds_read_b64_tr_b16 v[44:45], v32 offset:2048
    ds_read_b64_tr_b16 v[46:47], v32 offset:2304
    s_waitcnt lgkmcnt(6)
    v_mfma_f32_16x16x32_bf16 v[88:91], v[48:51], v[40:43], 0
    ds_read_b64_tr_b16 v[48:49], v33 offset:2048
    ds_read_b64_tr_b16 v[50:51], v33 offset:2304
    s_waitcnt lgkmcnt(6)
    v_mfma_f32_16x16x32_bf16 v[92:95], v[52:55], v[40:43], 0
    ds_read_b64_tr_b16 v[52:53], v32 offset:34816
    ds_read_b64_tr_b16 v[54:55], v32 offset:35072
    s_waitcnt lgkmcnt(6)
    v_mfma_f32_16x16x32_bf16 v[96:99], v[56:59], v[40:43], 0
    ds_read_b64_tr_b16 v[56:57], v33 offset:34816
    ds_read_b64_tr_b16 v[58:59], v33 offset:35072
    s_waitcnt lgkmcnt(6)
    v_mfma_f32_16x16x32_bf16 v[84:87], v[44:47], v[40:43], v[84:87]
    ds_read_b64_tr_b16 v[44:45], v32 offset:4096
    ds_read_b64_tr_b16 v[46:47], v32 offset:4352
    s_waitcnt lgkmcnt(6)
    v_mfma_f32_16x16x32_bf16 v[88:91], v[48:51], v[40:43], v[88:91]
    ds_read_b64_tr_b16 v[48:49], v33 offset:4096
    ds_read_b64_tr_b16 v[50:51], v33 offset:4352
    s_waitcnt lgkmcnt(6)
    v_mfma_f32_16x16x32_bf16 v[92:95], v[52:55], v[40:43], v[92:95]
    ds_read_b64_tr_b16 v[52:53], v32 offset:36864
    ds_read_b64_tr_b16 v[54:55], v32 offset:37120
    s_waitcnt lgkmcnt(6)
    v_mfma_f32_16x16x32_bf16 v[96:99], v[56:59], v[40:43], v[96:99]
    ds_read_b64_tr_b16 v[56:57], v33 offset:36864
    ds_read_b64_tr_b16 v[58:59], v33 offset:37120
    s_waitcnt lgkmcnt(6)
    v_mfma_f32_16x16x32_bf16 v[84:87], v[44:47], v[40:43], v[84:87]
    ds_read_b64_tr_b16 v[44:45], v32 offset:6144
    ds_read_b64_tr_b16 v[46:47], v32 offset:6400
    s_waitcnt lgkmcnt(6)
    v_mfma_f32_16x16x32_bf16 v[88:91], v[48:51], v[40:43], v[88:91]
    ds_read_b64_tr_b16 v[48:49], v33 offset:6144
    ds_read_b64_tr_b16 v[50:51], v33 offset:6400
    s_waitcnt lgkmcnt(6)
    v_mfma_f32_16x16x32_bf16 v[92:95], v[52:55], v[40:43], v[92:95]
    ds_read_b64_tr_b16 v[52:53], v32 offset:38912
    ds_read_b64_tr_b16 v[54:55], v32 offset:39168
    s_waitcnt lgkmcnt(6)
    v_mfma_f32_16x16x32_bf16 v[96:99], v[56:59], v[40:43], v[96:99]
    ds_read_b64_tr_b16 v[56:57], v33 offset:38912
    ds_read_b64_tr_b16 v[58:59], v33 offset:39168
    s_waitcnt lgkmcnt(6)
    v_mfma_f32_16x16x32_bf16 v[84:87], v[44:47], v[40:43], v[84:87]
    ds_read_b64_tr_b16 v[44:45], v32 offset:8192
    ds_read_b64_tr_b16 v[46:47], v32 offset:8448
    s_waitcnt lgkmcnt(6)
    v_mfma_f32_16x16x32_bf16 v[88:91], v[48:51], v[40:43], v[88:91]
    ds_read_b64_tr_b16 v[48:49], v33 offset:8192
    ds_read_b64_tr_b16 v[50:51], v33 offset:8448
    s_waitcnt lgkmcnt(6)
    v_mfma_f32_16x16x32_bf16 v[92:95], v[52:55], v[40:43], v[92:95]
    ds_read_b64_tr_b16 v[52:53], v32 offset:40960
    ds_read_b64_tr_b16 v[54:55], v32 offset:41216
    s_waitcnt lgkmcnt(6)
    v_mfma_f32_16x16x32_bf16 v[96:99], v[56:59], v[40:43], v[96:99]
    ds_read_b64_tr_b16 v[56:57], v33 offset:40960
    ds_read_b64_tr_b16 v[58:59], v33 offset:41216
    s_waitcnt lgkmcnt(6)
    v_mfma_f32_16x16x32_bf16 v[84:87], v[44:47], v[40:43], v[84:87]
    ds_read_b64_tr_b16 v[44:45], v32 offset:10240
    ds_read_b64_tr_b16 v[46:47], v32 offset:10496
    s_waitcnt lgkmcnt(6)
    v_mfma_f32_16x16x32_bf16 v[88:91], v[48:51], v[40:43], v[88:91]
    ds_read_b64_tr_b16 v[48:49], v33 offset:10240
    ds_read_b64_tr_b16 v[50:51], v33 offset:10496
    s_waitcnt lgkmcnt(6)
    v_mfma_f32_16x16x32_bf16 v[92:95], v[52:55], v[40:43], v[92:95]
    ds_read_b64_tr_b16 v[52:53], v32 offset:43008
    ds_read_b64_tr_b16 v[54:55], v32 offset:43264
    s_waitcnt lgkmcnt(6)
    v_mfma_f32_16x16x32_bf16 v[96:99], v[56:59], v[40:43], v[96:99]
    ds_read_b64_tr_b16 v[56:57], v33 offset:43008
    ds_read_b64_tr_b16 v[58:59], v33 offset:43264
    s_waitcnt lgkmcnt(6)
    v_mfma_f32_16x16x32_bf16 v[84:87], v[44:47], v[40:43], v[84:87]
    ds_read_b64_tr_b16 v[44:45], v32 offset:12288
    ds_read_b64_tr_b16 v[46:47], v32 offset:12544
    s_waitcnt lgkmcnt(6)
    v_mfma_f32_16x16x32_bf16 v[88:91], v[48:51], v[40:43], v[88:91]
    ds_read_b64_tr_b16 v[48:49], v33 offset:12288
    ds_read_b64_tr_b16 v[50:51], v33 offset:12544
    s_waitcnt lgkmcnt(6)
    v_mfma_f32_16x16x32_bf16 v[92:95], v[52:55], v[40:43], v[92:95]
    ds_read_b64_tr_b16 v[52:53], v32 offset:45056
    ds_read_b64_tr_b16 v[54:55], v32 offset:45312
    s_waitcnt lgkmcnt(6)
    v_mfma_f32_16x16x32_bf16 v[96:99], v[56:59], v[40:43], v[96:99]
    ds_read_b64_tr_b16 v[56:57], v33 offset:45056
    ds_read_b64_tr_b16 v[58:59], v33 offset:45312
    s_waitcnt lgkmcnt(6)
    v_mfma_f32_16x16x32_bf16 v[84:87], v[44:47], v[40:43], v[84:87]
    ds_read_b64_tr_b16 v[44:45], v32 offset:14336
    ds_read_b64_tr_b16 v[46:47], v32 offset:14592
    s_waitcnt lgkmcnt(6)
    v_mfma_f32_16x16x32_bf16 v[88:91], v[48:51], v[40:43], v[88:91]
    ds_read_b64_tr_b16 v[48:49], v33 offset:14336
    ds_read_b64_tr_b16 v[50:51], v33 offset:14592
    s_waitcnt lgkmcnt(6)
    v_mfma_f32_16x16x32_bf16 v[92:95], v[52:55], v[40:43], v[92:95]
    ds_read_b64_tr_b16 v[52:53], v32 offset:47104
    ds_read_b64_tr_b16 v[54:55], v32 offset:47360
    s_waitcnt lgkmcnt(6)
    v_mfma_f32_16x16x32_bf16 v[96:99], v[56:59], v[40:43], v[96:99]
    ds_read_b64_tr_b16 v[56:57], v33 offset:47104
    ds_read_b64_tr_b16 v[58:59], v33 offset:47360
    s_waitcnt lgkmcnt(6)
    v_mfma_f32_16x16x32_bf16 v[84:87], v[44:47], v[40:43], v[84:87]
    ds_read_b64_tr_b16 v[44:45], v32 offset:16384
    ds_read_b64_tr_b16 v[46:47], v32 offset:16640
    s_waitcnt lgkmcnt(6)
    v_mfma_f32_16x16x32_bf16 v[88:91], v[48:51], v[40:43], v[88:91]
    ds_read_b64_tr_b16 v[48:49], v33 offset:16384
    ds_read_b64_tr_b16 v[50:51], v33 offset:16640
    s_waitcnt lgkmcnt(6)
    v_mfma_f32_16x16x32_bf16 v[92:95], v[52:55], v[40:43], v[92:95]
    ds_read_b64_tr_b16 v[52:53], v32 offset:49152
    ds_read_b64_tr_b16 v[54:55], v32 offset:49408
    s_waitcnt lgkmcnt(6)
    v_mfma_f32_16x16x32_bf16 v[96:99], v[56:59], v[40:43], v[96:99]
    ds_read_b64_tr_b16 v[56:57], v33 offset:49152
    ds_read_b64_tr_b16 v[58:59], v33 offset:49408
    s_waitcnt lgkmcnt(6)
    v_mfma_f32_16x16x32_bf16 v[84:87], v[44:47], v[40:43], v[84:87]
    ds_read_b64_tr_b16 v[44:45], v32 offset:18432
    ds_read_b64_tr_b16 v[46:47], v32 offset:18688
    s_waitcnt lgkmcnt(6)
    v_mfma_f32_16x16x32_bf16 v[88:91], v[48:51], v[40:43], v[88:91]
    ds_read_b64_tr_b16 v[48:49], v33 offset:18432
    ds_read_b64_tr_b16 v[50:51], v33 offset:18688
    s_waitcnt lgkmcnt(6)
    v_mfma_f32_16x16x32_bf16 v[92:95], v[52:55], v[40:43], v[92:95]
    ds_read_b64_tr_b16 v[52:53], v32 offset:51200
    ds_read_b64_tr_b16 v[54:55], v32 offset:51456
    s_waitcnt lgkmcnt(6)
    v_mfma_f32_16x16x32_bf16 v[96:99], v[56:59], v[40:43], v[96:99]
    ds_read_b64_tr_b16 v[56:57], v33 offset:51200
    ds_read_b64_tr_b16 v[58:59], v33 offset:51456
    s_waitcnt lgkmcnt(6)
    v_mfma_f32_16x16x32_bf16 v[84:87], v[44:47], v[40:43], v[84:87]
    ds_read_b64_tr_b16 v[44:45], v32 offset:20480
    ds_read_b64_tr_b16 v[46:47], v32 offset:20736
    s_waitcnt lgkmcnt(6)
    v_mfma_f32_16x16x32_bf16 v[88:91], v[48:51], v[40:43], v[88:91]
    ds_read_b64_tr_b16 v[48:49], v33 offset:20480
    ds_read_b64_tr_b16 v[50:51], v33 offset:20736
    s_waitcnt lgkmcnt(6)
    v_mfma_f32_16x16x32_bf16 v[92:95], v[52:55], v[40:43], v[92:95]
    ds_read_b64_tr_b16 v[52:53], v32 offset:53248
    ds_read_b64_tr_b16 v[54:55], v32 offset:53504
    s_waitcnt lgkmcnt(6)
    v_mfma_f32_16x16x32_bf16 v[96:99], v[56:59], v[40:43], v[96:99]
    ds_read_b64_tr_b16 v[56:57], v33 offset:53248
    ds_read_b64_tr_b16 v[58:59], v33 offset:53504
    s_waitcnt lgkmcnt(6)
    v_mfma_f32_16x16x32_bf16 v[84:87], v[44:47], v[40:43], v[84:87]
    ds_read_b64_tr_b16 v[44:45], v32 offset:22528
    ds_read_b64_tr_b16 v[46:47], v32 offset:22784
    s_waitcnt lgkmcnt(6)
    v_mfma_f32_16x16x32_bf16 v[88:91], v[48:51], v[40:43], v[88:91]
    ds_read_b64_tr_b16 v[48:49], v33 offset:22528
    ds_read_b64_tr_b16 v[50:51], v33 offset:22784
    s_waitcnt lgkmcnt(6)
    v_mfma_f32_16x16x32_bf16 v[92:95], v[52:55], v[40:43], v[92:95]
    ds_read_b64_tr_b16 v[52:53], v32 offset:55296
    ds_read_b64_tr_b16 v[54:55], v32 offset:55552
    s_waitcnt lgkmcnt(6)
    v_mfma_f32_16x16x32_bf16 v[96:99], v[56:59], v[40:43], v[96:99]
    ds_read_b64_tr_b16 v[56:57], v33 offset:55296
    ds_read_b64_tr_b16 v[58:59], v33 offset:55552
    s_waitcnt lgkmcnt(6)
    v_mfma_f32_16x16x32_bf16 v[84:87], v[44:47], v[40:43], v[84:87]
    ds_read_b64_tr_b16 v[44:45], v32 offset:24576
    ds_read_b64_tr_b16 v[46:47], v32 offset:24832
    s_waitcnt lgkmcnt(6)
    v_mfma_f32_16x16x32_bf16 v[88:91], v[48:51], v[40:43], v[88:91]
    ds_read_b64_tr_b16 v[48:49], v33 offset:24576
    ds_read_b64_tr_b16 v[50:51], v33 offset:24832
    s_waitcnt lgkmcnt(6)
    v_mfma_f32_16x16x32_bf16 v[92:95], v[52:55], v[40:43], v[92:95]
    ds_read_b64_tr_b16 v[52:53], v32 offset:57344
    ds_read_b64_tr_b16 v[54:55], v32 offset:57600
    s_waitcnt lgkmcnt(6)
    v_mfma_f32_16x16x32_bf16 v[96:99], v[56:59], v[40:43], v[96:99]
    ds_read_b64_tr_b16 v[56:57], v33 offset:57344
    ds_read_b64_tr_b16 v[58:59], v33 offset:57600
    s_waitcnt lgkmcnt(6)
    v_mfma_f32_16x16x32_bf16 v[84:87], v[44:47], v[40:43], v[84:87]
    ds_read_b64_tr_b16 v[44:45], v32 offset:26624
    ds_read_b64_tr_b16 v[46:47], v32 offset:26880
    s_waitcnt lgkmcnt(6)
    v_mfma_f32_16x16x32_bf16 v[88:91], v[48:51], v[40:43], v[88:91]
    ds_read_b64_tr_b16 v[48:49], v33 offset:26624
    ds_read_b64_tr_b16 v[50:51], v33 offset:26880
    s_waitcnt lgkmcnt(6)
    v_mfma_f32_16x16x32_bf16 v[92:95], v[52:55], v[40:43], v[92:95]
    ds_read_b64_tr_b16 v[52:53], v32 offset:59392
    ds_read_b64_tr_b16 v[54:55], v32 offset:59648
    s_waitcnt lgkmcnt(6)
    v_mfma_f32_16x16x32_bf16 v[96:99], v[56:59], v[40:43], v[96:99]
    ds_read_b64_tr_b16 v[56:57], v33 offset:59392
    ds_read_b64_tr_b16 v[58:59], v33 offset:59648
    s_waitcnt lgkmcnt(6)
    v_mfma_f32_16x16x32_bf16 v[84:87], v[44:47], v[40:43], v[84:87]
    ds_read_b64_tr_b16 v[44:45], v32 offset:28672
    ds_read_b64_tr_b16 v[46:47], v32 offset:28928
    s_waitcnt lgkmcnt(6)
    v_mfma_f32_16x16x32_bf16 v[88:91], v[48:51], v[40:43], v[88:91]
    ds_read_b64_tr_b16 v[48:49], v33 offset:28672
    ds_read_b64_tr_b16 v[50:51], v33 offset:28928
    s_waitcnt lgkmcnt(6)
    v_mfma_f32_16x16x32_bf16 v[92:95], v[52:55], v[40:43], v[92:95]
    ds_read_b64_tr_b16 v[52:53], v32 offset:61440
    ds_read_b64_tr_b16 v[54:55], v32 offset:61696
    s_waitcnt lgkmcnt(6)
    v_mfma_f32_16x16x32_bf16 v[96:99], v[56:59], v[40:43], v[96:99]
    ds_read_b64_tr_b16 v[56:57], v33 offset:61440
    ds_read_b64_tr_b16 v[58:59], v33 offset:61696
    s_waitcnt lgkmcnt(6)
    v_mfma_f32_16x16x32_bf16 v[84:87], v[44:47], v[40:43], v[84:87]
    ds_read_b64_tr_b16 v[44:45], v32 offset:30720
    ds_read_b64_tr_b16 v[46:47], v32 offset:30976
    s_waitcnt lgkmcnt(6)
    v_mfma_f32_16x16x32_bf16 v[88:91], v[48:51], v[40:43], v[88:91]
    ds_read_b64_tr_b16 v[48:49], v33 offset:30720
    ds_read_b64_tr_b16 v[50:51], v33 offset:30976
    s_waitcnt lgkmcnt(6)
    v_mfma_f32_16x16x32_bf16 v[92:95], v[52:55], v[40:43], v[92:95]
    ds_read_b64_tr_b16 v[52:53], v32 offset:63488
    ds_read_b64_tr_b16 v[54:55], v32 offset:63744
    s_waitcnt lgkmcnt(6)
    v_mfma_f32_16x16x32_bf16 v[96:99], v[56:59], v[40:43], v[96:99]
    ds_read_b64_tr_b16 v[56:57], v33 offset:63488
    ds_read_b64_tr_b16 v[58:59], v33 offset:63744
    s_waitcnt lgkmcnt(6)
    v_mfma_f32_16x16x32_bf16 v[84:87], v[44:47], v[40:43], v[84:87]
    s_waitcnt lgkmcnt(4)
    v_mfma_f32_16x16x32_bf16 v[88:91], v[48:51], v[40:43], v[88:91]
    s_waitcnt lgkmcnt(2)
    v_mfma_f32_16x16x32_bf16 v[92:95], v[52:55], v[40:43], v[92:95]
    s_waitcnt lgkmcnt(0)
    v_mfma_f32_16x16x32_bf16 v[96:99], v[56:59], v[40:43], v[96:99]
L_nl3_main_kernel:
    s_barrier
    s_mov_b32 s12, s76
    s_mov_b32 s13, s77
    s_mov_b32 s14, 0x80000
    s_mov_b32 s15, 0x00020000
    s_lshl_b32 s95, s34, 7
    s_add_u32 s37, s95, 0x0
    s_mov_b32 m0, 0x10000
    s_nop 0
    buffer_load_dwordx4 v12, s[12:15], s37 offen lds
    s_add_u32 s37, s95, 0x40
    s_mov_b32 m0, 0x14000
    s_nop 0
    buffer_load_dwordx4 v12, s[12:15], s37 offen lds
    s_add_u32 s37, s95, 0x4000
    s_mov_b32 m0, 0x10400
    s_nop 0
    buffer_load_dwordx4 v12, s[12:15], s37 offen lds
    s_add_u32 s37, s95, 0x4040
    s_mov_b32 m0, 0x14400
    s_nop 0
    buffer_load_dwordx4 v12, s[12:15], s37 offen lds
    s_add_u32 s37, s95, 0x8000
    s_mov_b32 m0, 0x10800
    s_nop 0
    buffer_load_dwordx4 v12, s[12:15], s37 offen lds
    s_add_u32 s37, s95, 0x8040
    s_mov_b32 m0, 0x14800
    s_nop 0
    buffer_load_dwordx4 v12, s[12:15], s37 offen lds
    s_add_u32 s37, s95, 0xc000
    s_mov_b32 m0, 0x10c00
    s_nop 0
    buffer_load_dwordx4 v12, s[12:15], s37 offen lds
    s_add_u32 s37, s95, 0xc040
    s_mov_b32 m0, 0x14c00
    s_nop 0
    buffer_load_dwordx4 v12, s[12:15], s37 offen lds
    s_add_u32 s37, s95, 0x10000
    s_mov_b32 m0, 0x11000
    s_nop 0
    buffer_load_dwordx4 v12, s[12:15], s37 offen lds
    s_add_u32 s37, s95, 0x10040
    s_mov_b32 m0, 0x15000
    s_nop 0
    buffer_load_dwordx4 v12, s[12:15], s37 offen lds
    s_add_u32 s37, s95, 0x14000
    s_mov_b32 m0, 0x11400
    s_nop 0
    buffer_load_dwordx4 v12, s[12:15], s37 offen lds
    s_add_u32 s37, s95, 0x14040
    s_mov_b32 m0, 0x15400
    s_nop 0
    buffer_load_dwordx4 v12, s[12:15], s37 offen lds
    s_add_u32 s37, s95, 0x18000
    s_mov_b32 m0, 0x11800
    s_nop 0
    buffer_load_dwordx4 v12, s[12:15], s37 offen lds
    s_add_u32 s37, s95, 0x18040
    s_mov_b32 m0, 0x15800
    s_nop 0
    buffer_load_dwordx4 v12, s[12:15], s37 offen lds
    s_add_u32 s37, s95, 0x1c000
    s_mov_b32 m0, 0x11c00
    s_nop 0
    buffer_load_dwordx4 v12, s[12:15], s37 offen lds
    s_add_u32 s37, s95, 0x1c040
    s_mov_b32 m0, 0x15c00
    s_nop 0
    buffer_load_dwordx4 v12, s[12:15], s37 offen lds
    s_add_u32 s37, s95, 0x20000
    s_mov_b32 m0, 0x12000
    s_nop 0
    buffer_load_dwordx4 v12, s[12:15], s37 offen lds
    s_add_u32 s37, s95, 0x20040
    s_mov_b32 m0, 0x16000
    s_nop 0
    buffer_load_dwordx4 v12, s[12:15], s37 offen lds
    s_add_u32 s37, s95, 0x24000
    s_mov_b32 m0, 0x12400
    s_nop 0
    buffer_load_dwordx4 v12, s[12:15], s37 offen lds
    s_add_u32 s37, s95, 0x24040
    s_mov_b32 m0, 0x16400
    s_nop 0
    buffer_load_dwordx4 v12, s[12:15], s37 offen lds
    s_add_u32 s37, s95, 0x28000
    s_mov_b32 m0, 0x12800
    s_nop 0
    buffer_load_dwordx4 v12, s[12:15], s37 offen lds
    s_add_u32 s37, s95, 0x28040
    s_mov_b32 m0, 0x16800
    s_nop 0
    buffer_load_dwordx4 v12, s[12:15], s37 offen lds
    s_add_u32 s37, s95, 0x2c000
    s_mov_b32 m0, 0x12c00
    s_nop 0
    buffer_load_dwordx4 v12, s[12:15], s37 offen lds
    s_add_u32 s37, s95, 0x2c040
    s_mov_b32 m0, 0x16c00
    s_nop 0
    buffer_load_dwordx4 v12, s[12:15], s37 offen lds
    s_add_u32 s37, s95, 0x30000
    s_mov_b32 m0, 0x13000
    s_nop 0
    buffer_load_dwordx4 v12, s[12:15], s37 offen lds
    s_add_u32 s37, s95, 0x30040
    s_mov_b32 m0, 0x17000
    s_nop 0
    buffer_load_dwordx4 v12, s[12:15], s37 offen lds
    s_add_u32 s37, s95, 0x34000
    s_mov_b32 m0, 0x13400
    s_nop 0
    buffer_load_dwordx4 v12, s[12:15], s37 offen lds
    s_add_u32 s37, s95, 0x34040
    s_mov_b32 m0, 0x17400
    s_nop 0
    buffer_load_dwordx4 v12, s[12:15], s37 offen lds
    s_add_u32 s37, s95, 0x38000
    s_mov_b32 m0, 0x13800
    s_nop 0
    buffer_load_dwordx4 v12, s[12:15], s37 offen lds
    s_add_u32 s37, s95, 0x38040
    s_mov_b32 m0, 0x17800
    s_nop 0
    buffer_load_dwordx4 v12, s[12:15], s37 offen lds
    s_add_u32 s37, s95, 0x3c000
    s_mov_b32 m0, 0x13c00
    s_nop 0
    buffer_load_dwordx4 v12, s[12:15], s37 offen lds
    s_add_u32 s37, s95, 0x3c040
    s_mov_b32 m0, 0x17c00
    s_nop 0
    buffer_load_dwordx4 v12, s[12:15], s37 offen lds
    s_mul_i32 s38, s35, 352256
    s_lshl_b32 s39, s94, 10
    s_add_u32 s38, s38, s39
    s_add_u32 s4, s38, 0xc00000
    buffer_store_dwordx4 v[28:31], v5, s[52:55], s4 offen offset:0
    s_add_u32 s4, s38, 0xc00400
    buffer_store_dwordx4 v[28:31], v5, s[52:55], s4 offen offset:0
    s_add_u32 s4, s38, 0xc00800
    buffer_store_dwordx4 v[28:31], v5, s[52:55], s4 offen offset:0
    s_add_u32 s4, s38, 0xc0ac00
    buffer_store_dwordx4 v[28:31], v5, s[52:55], s4 offen offset:0
    s_add_u32 s4, s38, 0xc0b000
    buffer_store_dwordx4 v[28:31], v5, s[52:55], s4 offen offset:0
    s_add_u32 s4, s38, 0xc0b400
    buffer_store_dwordx4 v[28:31], v5, s[52:55], s4 offen offset:0
    s_add_u32 s4, s38, 0xc15800
    buffer_store_dwordx4 v[28:31], v5, s[52:55], s4 offen offset:0
    s_add_u32 s4, s38, 0xc15c00
    buffer_store_dwordx4 v[28:31], v5, s[52:55], s4 offen offset:0
    s_add_u32 s4, s38, 0xc16000
    buffer_store_dwordx4 v[28:31], v5, s[52:55], s4 offen offset:0
    s_add_u32 s4, s38, 0xc20400
    buffer_store_dwordx4 v[28:31], v5, s[52:55], s4 offen offset:0
    s_add_u32 s4, s38, 0xc20800
    buffer_store_dwordx4 v[28:31], v5, s[52:55], s4 offen offset:0
    s_add_u32 s4, s38, 0xc20c00
    buffer_store_dwordx4 v[28:31], v5, s[52:55], s4 offen offset:0
    s_add_u32 s4, s38, 0xc2b000
    buffer_store_dwordx4 v[28:31], v5, s[52:55], s4 offen offset:0
    s_add_u32 s4, s38, 0xc2b400
    buffer_store_dwordx4 v[28:31], v5, s[52:55], s4 offen offset:0
    s_add_u32 s4, s38, 0xc2b800
    buffer_store_dwordx4 v[28:31], v5, s[52:55], s4 offen offset:0
    s_add_u32 s4, s38, 0xc35c00
    buffer_store_dwordx4 v[28:31], v5, s[52:55], s4 offen offset:0
    s_add_u32 s4, s38, 0xc36000
    buffer_store_dwordx4 v[28:31], v5, s[52:55], s4 offen offset:0
    s_add_u32 s4, s38, 0xc36400
    buffer_store_dwordx4 v[28:31], v5, s[52:55], s4 offen offset:0
    s_add_u32 s4, s38, 0xc40800
    buffer_store_dwordx4 v[28:31], v5, s[52:55], s4 offen offset:0
    s_add_u32 s4, s38, 0xc40c00
    buffer_store_dwordx4 v[28:31], v5, s[52:55], s4 offen offset:0
    s_add_u32 s4, s38, 0xc41000
    buffer_store_dwordx4 v[28:31], v5, s[52:55], s4 offen offset:0
    s_add_u32 s4, s38, 0xc4b400
    buffer_store_dwordx4 v[28:31], v5, s[52:55], s4 offen offset:0
    s_add_u32 s4, s38, 0xc4b800
    buffer_store_dwordx4 v[28:31], v5, s[52:55], s4 offen offset:0
    s_add_u32 s4, s38, 0xc4bc00
    buffer_store_dwordx4 v[28:31], v5, s[52:55], s4 offen offset:0
    s_waitcnt vmcnt(56)
    s_barrier
    s_nop 7
    s_mov_b32 exec_lo, 0x00010001
    s_mov_b32 exec_hi, 0x00010001
    ds_write_b128 v132, v[84:87] offset:32768
    ds_write_b128 v132, v[88:91] offset:32832
    ds_write_b128 v132, v[92:95] offset:32896
    ds_write_b128 v132, v[96:99] offset:32960
    s_mov_b64 exec, -1
    s_sleep 4
    s_mov_b32 s12, s76
    s_mov_b32 s13, s77
    s_mov_b32 s14, 0x80000
    s_mov_b32 s15, 0x00020000
    s_lshl_b32 s95, s34, 7
    s_add_u32 s37, s95, 0x40000
    s_mov_b32 m0, 0x18000
    s_nop 0
    buffer_load_dwordx4 v12, s[12:15], s37 offen lds
    s_add_u32 s37, s95, 0x40040
    s_mov_b32 m0, 0x1c000
    s_nop 0
    buffer_load_dwordx4 v12, s[12:15], s37 offen lds
    s_add_u32 s37, s95, 0x44000
    s_mov_b32 m0, 0x18400
    s_nop 0
    buffer_load_dwordx4 v12, s[12:15], s37 offen lds
    s_add_u32 s37, s95, 0x44040
    s_mov_b32 m0, 0x1c400
    s_nop 0
    buffer_load_dwordx4 v12, s[12:15], s37 offen lds
    s_add_u32 s37, s95, 0x48000
    s_mov_b32 m0, 0x18800
    s_nop 0
    buffer_load_dwordx4 v12, s[12:15], s37 offen lds
    s_add_u32 s37, s95, 0x48040
    s_mov_b32 m0, 0x1c800
    s_nop 0
    buffer_load_dwordx4 v12, s[12:15], s37 offen lds
    s_add_u32 s37, s95, 0x4c000
    s_mov_b32 m0, 0x18c00
    s_nop 0
    buffer_load_dwordx4 v12, s[12:15], s37 offen lds
    s_add_u32 s37, s95, 0x4c040
    s_mov_b32 m0, 0x1cc00
    s_nop 0
    buffer_load_dwordx4 v12, s[12:15], s37 offen lds
    s_add_u32 s37, s95, 0x50000
    s_mov_b32 m0, 0x19000
    s_nop 0
    buffer_load_dwordx4 v12, s[12:15], s37 offen lds
    s_add_u32 s37, s95, 0x50040
    s_mov_b32 m0, 0x1d000
    s_nop 0
    buffer_load_dwordx4 v12, s[12:15], s37 offen lds
    s_add_u32 s37, s95, 0x54000
    s_mov_b32 m0, 0x19400
    s_nop 0
    buffer_load_dwordx4 v12, s[12:15], s37 offen lds
    s_add_u32 s37, s95, 0x54040
    s_mov_b32 m0, 0x1d400
    s_nop 0
    buffer_load_dwordx4 v12, s[12:15], s37 offen lds
    s_add_u32 s37, s95, 0x58000
    s_mov_b32 m0, 0x19800
    s_nop 0
    buffer_load_dwordx4 v12, s[12:15], s37 offen lds
    s_add_u32 s37, s95, 0x58040
    s_mov_b32 m0, 0x1d800
    s_nop 0
    buffer_load_dwordx4 v12, s[12:15], s37 offen lds
    s_add_u32 s37, s95, 0x5c000
    s_mov_b32 m0, 0x19c00
    s_nop 0
    buffer_load_dwordx4 v12, s[12:15], s37 offen lds
    s_add_u32 s37, s95, 0x5c040
    s_mov_b32 m0, 0x1dc00
    s_nop 0
    buffer_load_dwordx4 v12, s[12:15], s37 offen lds
    s_add_u32 s37, s95, 0x60000
    s_mov_b32 m0, 0x1a000
    s_nop 0
    buffer_load_dwordx4 v12, s[12:15], s37 offen lds
    s_add_u32 s37, s95, 0x60040
    s_mov_b32 m0, 0x1e000
    s_nop 0
    buffer_load_dwordx4 v12, s[12:15], s37 offen lds
    s_add_u32 s37, s95, 0x64000
    s_mov_b32 m0, 0x1a400
    s_nop 0
    buffer_load_dwordx4 v12, s[12:15], s37 offen lds
    s_add_u32 s37, s95, 0x64040
    s_mov_b32 m0, 0x1e400
    s_nop 0
    buffer_load_dwordx4 v12, s[12:15], s37 offen lds
    s_add_u32 s37, s95, 0x68000
    s_mov_b32 m0, 0x1a800
    s_nop 0
    buffer_load_dwordx4 v12, s[12:15], s37 offen lds
    s_add_u32 s37, s95, 0x68040
    s_mov_b32 m0, 0x1e800
    s_nop 0
    buffer_load_dwordx4 v12, s[12:15], s37 offen lds
    s_add_u32 s37, s95, 0x6c000
    s_mov_b32 m0, 0x1ac00
    s_nop 0
    buffer_load_dwordx4 v12, s[12:15], s37 offen lds
    s_add_u32 s37, s95, 0x6c040
    s_mov_b32 m0, 0x1ec00
    s_nop 0
    buffer_load_dwordx4 v12, s[12:15], s37 offen lds
    s_add_u32 s37, s95, 0x70000
    s_mov_b32 m0, 0x1b000
    s_nop 0
    buffer_load_dwordx4 v12, s[12:15], s37 offen lds
    s_add_u32 s37, s95, 0x70040
    s_mov_b32 m0, 0x1f000
    s_nop 0
    buffer_load_dwordx4 v12, s[12:15], s37 offen lds
    s_add_u32 s37, s95, 0x74000
    s_mov_b32 m0, 0x1b400
    s_nop 0
    buffer_load_dwordx4 v12, s[12:15], s37 offen lds
    s_add_u32 s37, s95, 0x74040
    s_mov_b32 m0, 0x1f400
    s_nop 0
    buffer_load_dwordx4 v12, s[12:15], s37 offen lds
    s_add_u32 s37, s95, 0x78000
    s_mov_b32 m0, 0x1b800
    s_nop 0
    buffer_load_dwordx4 v12, s[12:15], s37 offen lds
    s_add_u32 s37, s95, 0x78040
    s_mov_b32 m0, 0x1f800
    s_nop 0
    buffer_load_dwordx4 v12, s[12:15], s37 offen lds
    s_add_u32 s37, s95, 0x7c000
    s_mov_b32 m0, 0x1bc00
    s_nop 0
    buffer_load_dwordx4 v12, s[12:15], s37 offen lds
    s_add_u32 s37, s95, 0x7c040
    s_mov_b32 m0, 0x1fc00
    s_nop 0
    buffer_load_dwordx4 v12, s[12:15], s37 offen lds
    s_waitcnt lgkmcnt(0)
    s_barrier
    s_mov_b32 s12, s78
    s_mov_b32 s13, s79
    s_mov_b32 s14, 0x158000
    s_mov_b32 s15, 0x00020000
    s_lshl_b32 s95, s94, 6
    s_add_u32 s37, s95, 0x0
    s_mov_b32 m0, 0x20000
    s_nop 0
    buffer_load_dwordx4 v14, s[12:15], s37 offen lds
    s_add_u32 s37, s95, 0x40
    s_mov_b32 m0, 0x24000
    s_nop 0
    buffer_load_dwordx4 v14, s[12:15], s37 offen lds
    s_add_u32 s37, s95, 0xac00
    s_mov_b32 m0, 0x20400
    s_nop 0
    buffer_load_dwordx4 v14, s[12:15], s37 offen lds
    s_add_u32 s37, s95, 0xac40
    s_mov_b32 m0, 0x24400
    s_nop 0
    buffer_load_dwordx4 v14, s[12:15], s37 offen lds
    s_add_u32 s37, s95, 0x15800
    s_mov_b32 m0, 0x20800
    s_nop 0
    buffer_load_dwordx4 v14, s[12:15], s37 offen lds
    s_add_u32 s37, s95, 0x15840
    s_mov_b32 m0, 0x24800
    s_nop 0
    buffer_load_dwordx4 v14, s[12:15], s37 offen lds
    s_add_u32 s37, s95, 0x20400
    s_mov_b32 m0, 0x20c00
    s_nop 0
    buffer_load_dwordx4 v14, s[12:15], s37 offen lds
    s_add_u32 s37, s95, 0x20440
    s_mov_b32 m0, 0x24c00
    s_nop 0
    buffer_load_dwordx4 v14, s[12:15], s37 offen lds
    s_add_u32 s37, s95, 0x2b000
    s_mov_b32 m0, 0x21000
    s_nop 0
    buffer_load_dwordx4 v14, s[12:15], s37 offen lds
    s_add_u32 s37, s95, 0x2b040
    s_mov_b32 m0, 0x25000
    s_nop 0
    buffer_load_dwordx4 v14, s[12:15], s37 offen lds
    s_add_u32 s37, s95, 0x35c00
    s_mov_b32 m0, 0x21400
    s_nop 0
    buffer_load_dwordx4 v14, s[12:15], s37 offen lds
    s_add_u32 s37, s95, 0x35c40
    s_mov_b32 m0, 0x25400
    s_nop 0
    buffer_load_dwordx4 v14, s[12:15], s37 offen lds
    s_add_u32 s37, s95, 0x40800
    s_mov_b32 m0, 0x21800
    s_nop 0
    buffer_load_dwordx4 v14, s[12:15], s37 offen lds
    s_add_u32 s37, s95, 0x40840
    s_mov_b32 m0, 0x25800
    s_nop 0
    buffer_load_dwordx4 v14, s[12:15], s37 offen lds
    s_add_u32 s37, s95, 0x4b400
    s_mov_b32 m0, 0x21c00
    s_nop 0
    buffer_load_dwordx4 v14, s[12:15], s37 offen lds
    s_add_u32 s37, s95, 0x4b440
    s_mov_b32 m0, 0x25c00
    s_nop 0
    buffer_load_dwordx4 v14, s[12:15], s37 offen lds
    s_add_u32 s37, s95, 0x56000
    s_mov_b32 m0, 0x22000
    s_nop 0
    buffer_load_dwordx4 v14, s[12:15], s37 offen lds
    s_add_u32 s37, s95, 0x56040
    s_mov_b32 m0, 0x26000
    s_nop 0
    buffer_load_dwordx4 v14, s[12:15], s37 offen lds
    s_add_u32 s37, s95, 0x60c00
    s_mov_b32 m0, 0x22400
    s_nop 0
    buffer_load_dwordx4 v14, s[12:15], s37 offen lds
    s_add_u32 s37, s95, 0x60c40
    s_mov_b32 m0, 0x26400
    s_nop 0
    buffer_load_dwordx4 v14, s[12:15], s37 offen lds
    s_add_u32 s37, s95, 0x6b800
    s_mov_b32 m0, 0x22800
    s_nop 0
    buffer_load_dwordx4 v14, s[12:15], s37 offen lds
    s_add_u32 s37, s95, 0x6b840
    s_mov_b32 m0, 0x26800
    s_nop 0
    buffer_load_dwordx4 v14, s[12:15], s37 offen lds
    s_add_u32 s37, s95, 0x76400
    s_mov_b32 m0, 0x22c00
    s_nop 0
    buffer_load_dwordx4 v14, s[12:15], s37 offen lds
    s_add_u32 s37, s95, 0x76440
    s_mov_b32 m0, 0x26c00
    s_nop 0
    buffer_load_dwordx4 v14, s[12:15], s37 offen lds
    s_waitcnt vmcnt(24)
    s_barrier
    s_sleep 16
    s_mov_b32 s12, s78
    s_mov_b32 s13, s79
    s_mov_b32 s14, 0x158000
    s_mov_b32 s15, 0x00020000
    s_lshl_b32 s95, s94, 6
    s_add_u32 s37, s95, 0x81000
    s_mov_b32 m0, 0x23000
    s_nop 0
    buffer_load_dwordx4 v14, s[12:15], s37 offen lds
    s_add_u32 s37, s95, 0x81040
    s_mov_b32 m0, 0x27000
    s_nop 0
    buffer_load_dwordx4 v14, s[12:15], s37 offen lds
    s_add_u32 s37, s95, 0x8bc00
    s_mov_b32 m0, 0x23400
    s_nop 0
    buffer_load_dwordx4 v14, s[12:15], s37 offen lds
    s_add_u32 s37, s95, 0x8bc40
    s_mov_b32 m0, 0x27400
    s_nop 0
    buffer_load_dwordx4 v14, s[12:15], s37 offen lds
    s_add_u32 s37, s95, 0x96800
    s_mov_b32 m0, 0x23800
    s_nop 0
    buffer_load_dwordx4 v14, s[12:15], s37 offen lds
    s_add_u32 s37, s95, 0x96840
    s_mov_b32 m0, 0x27800
    s_nop 0
    buffer_load_dwordx4 v14, s[12:15], s37 offen lds
    s_add_u32 s37, s95, 0xa1400
    s_mov_b32 m0, 0x23c00
    s_nop 0
    buffer_load_dwordx4 v14, s[12:15], s37 offen lds
    s_add_u32 s37, s95, 0xa1440
    s_mov_b32 m0, 0x27c00
    s_nop 0
    buffer_load_dwordx4 v14, s[12:15], s37 offen lds
    s_mov_b32 s12, s78
    s_mov_b32 s13, s79
    s_mov_b32 s14, 0x158000
    s_mov_b32 s15, 0x00020000
    s_lshl_b32 s95, s94, 6
    s_add_u32 s37, s95, 0xac000
    s_mov_b32 m0, 0x0
    s_nop 0
    buffer_load_dwordx4 v14, s[12:15], s37 offen lds
    s_add_u32 s37, s95, 0xac040
    s_mov_b32 m0, 0x4000
    s_nop 0
    buffer_load_dwordx4 v14, s[12:15], s37 offen lds
    s_add_u32 s37, s95, 0xac080
    s_mov_b32 m0, 0xc000
    s_nop 0
    buffer_load_dwordx4 v14, s[12:15], s37 offen lds
    s_add_u32 s37, s95, 0xb6c00
    s_mov_b32 m0, 0x400
    s_nop 0
    buffer_load_dwordx4 v14, s[12:15], s37 offen lds
    s_add_u32 s37, s95, 0xb6c40
    s_mov_b32 m0, 0x4400
    s_nop 0
    buffer_load_dwordx4 v14, s[12:15], s37 offen lds
    s_add_u32 s37, s95, 0xb6c80
    s_mov_b32 m0, 0xc400
    s_nop 0
    buffer_load_dwordx4 v14, s[12:15], s37 offen lds
    s_add_u32 s37, s95, 0xc1800
    s_mov_b32 m0, 0x800
    s_nop 0
    buffer_load_dwordx4 v14, s[12:15], s37 offen lds
    s_add_u32 s37, s95, 0xc1840
    s_mov_b32 m0, 0x4800
    s_nop 0
    buffer_load_dwordx4 v14, s[12:15], s37 offen lds
    s_add_u32 s37, s95, 0xc1880
    s_mov_b32 m0, 0xc800
    s_nop 0
    buffer_load_dwordx4 v14, s[12:15], s37 offen lds
    s_add_u32 s37, s95, 0xcc400
    s_mov_b32 m0, 0xc00
    s_nop 0
    buffer_load_dwordx4 v14, s[12:15], s37 offen lds
    s_add_u32 s37, s95, 0xcc440
    s_mov_b32 m0, 0x4c00
    s_nop 0
    buffer_load_dwordx4 v14, s[12:15], s37 offen lds
    s_add_u32 s37, s95, 0xcc480
    s_mov_b32 m0, 0xcc00
    s_nop 0
    buffer_load_dwordx4 v14, s[12:15], s37 offen lds
    s_add_u32 s37, s95, 0xd7000
    s_mov_b32 m0, 0x1000
    s_nop 0
    buffer_load_dwordx4 v14, s[12:15], s37 offen lds
    s_add_u32 s37, s95, 0xd7040
    s_mov_b32 m0, 0x5000
    s_nop 0
    buffer_load_dwordx4 v14, s[12:15], s37 offen lds
    s_add_u32 s37, s95, 0xd7080
    s_mov_b32 m0, 0xd000
    s_nop 0
    buffer_load_dwordx4 v14, s[12:15], s37 offen lds
    s_add_u32 s37, s95, 0xe1c00
    s_mov_b32 m0, 0x1400
    s_nop 0
    buffer_load_dwordx4 v14, s[12:15], s37 offen lds
    s_add_u32 s37, s95, 0xe1c40
    s_mov_b32 m0, 0x5400
    s_nop 0
    buffer_load_dwordx4 v14, s[12:15], s37 offen lds
    s_add_u32 s37, s95, 0xe1c80
    s_mov_b32 m0, 0xd400
    s_nop 0
    buffer_load_dwordx4 v14, s[12:15], s37 offen lds
    s_add_u32 s37, s95, 0xec800
    s_mov_b32 m0, 0x1800
    s_nop 0
    buffer_load_dwordx4 v14, s[12:15], s37 offen lds
    s_add_u32 s37, s95, 0xec840
    s_mov_b32 m0, 0x5800
    s_nop 0
    buffer_load_dwordx4 v14, s[12:15], s37 offen lds
    s_add_u32 s37, s95, 0xec880
    s_mov_b32 m0, 0xd800
    s_nop 0
    buffer_load_dwordx4 v14, s[12:15], s37 offen lds
    s_add_u32 s37, s95, 0xf7400
    s_mov_b32 m0, 0x1c00
    s_nop 0
    buffer_load_dwordx4 v14, s[12:15], s37 offen lds
    s_add_u32 s37, s95, 0xf7440
    s_mov_b32 m0, 0x5c00
    s_nop 0
    buffer_load_dwordx4 v14, s[12:15], s37 offen lds
    s_add_u32 s37, s95, 0xf7480
    s_mov_b32 m0, 0xdc00
    s_nop 0
    buffer_load_dwordx4 v14, s[12:15], s37 offen lds
    s_add_u32 s37, s95, 0x102000
    s_mov_b32 m0, 0x2000
    s_nop 0
    buffer_load_dwordx4 v14, s[12:15], s37 offen lds
    s_add_u32 s37, s95, 0x102040
    s_mov_b32 m0, 0x6000
    s_nop 0
    buffer_load_dwordx4 v14, s[12:15], s37 offen lds
    s_add_u32 s37, s95, 0x102080
    s_mov_b32 m0, 0xe000
    s_nop 0
    buffer_load_dwordx4 v14, s[12:15], s37 offen lds
    s_add_u32 s37, s95, 0x10cc00
    s_mov_b32 m0, 0x2400
    s_nop 0
    buffer_load_dwordx4 v14, s[12:15], s37 offen lds
    s_add_u32 s37, s95, 0x10cc40
    s_mov_b32 m0, 0x6400
    s_nop 0
    buffer_load_dwordx4 v14, s[12:15], s37 offen lds
    s_add_u32 s37, s95, 0x10cc80
    s_mov_b32 m0, 0xe400
    s_nop 0
    buffer_load_dwordx4 v14, s[12:15], s37 offen lds
    s_add_u32 s37, s95, 0x117800
    s_mov_b32 m0, 0x2800
    s_nop 0
    buffer_load_dwordx4 v14, s[12:15], s37 offen lds
    s_add_u32 s37, s95, 0x117840
    s_mov_b32 m0, 0x6800
    s_nop 0
    buffer_load_dwordx4 v14, s[12:15], s37 offen lds
    s_add_u32 s37, s95, 0x117880
    s_mov_b32 m0, 0xe800
    s_nop 0
    buffer_load_dwordx4 v14, s[12:15], s37 offen lds
    s_add_u32 s37, s95, 0x122400
    s_mov_b32 m0, 0x2c00
    s_nop 0
    buffer_load_dwordx4 v14, s[12:15], s37 offen lds
    s_add_u32 s37, s95, 0x122440
    s_mov_b32 m0, 0x6c00
    s_nop 0
    buffer_load_dwordx4 v14, s[12:15], s37 offen lds
    s_add_u32 s37, s95, 0x122480
    s_mov_b32 m0, 0xec00
    s_nop 0
    buffer_load_dwordx4 v14, s[12:15], s37 offen lds
    s_add_u32 s37, s95, 0x12d000
    s_mov_b32 m0, 0x3000
    s_nop 0
    buffer_load_dwordx4 v14, s[12:15], s37 offen lds
    s_add_u32 s37, s95, 0x12d040
    s_mov_b32 m0, 0x7000
    s_nop 0
    buffer_load_dwordx4 v14, s[12:15], s37 offen lds
    s_add_u32 s37, s95, 0x12d080
    s_mov_b32 m0, 0xf000
    s_nop 0
    buffer_load_dwordx4 v14, s[12:15], s37 offen lds
    s_add_u32 s37, s95, 0x137c00
    s_mov_b32 m0, 0x3400
    s_nop 0
    buffer_load_dwordx4 v14, s[12:15], s37 offen lds
    s_add_u32 s37, s95, 0x137c40
    s_mov_b32 m0, 0x7400
    s_nop 0
    buffer_load_dwordx4 v14, s[12:15], s37 offen lds
    s_add_u32 s37, s95, 0x137c80
    s_mov_b32 m0, 0xf400
    s_nop 0
    buffer_load_dwordx4 v14, s[12:15], s37 offen lds
    s_add_u32 s37, s95, 0x142800
    s_mov_b32 m0, 0x3800
    s_nop 0
    buffer_load_dwordx4 v14, s[12:15], s37 offen lds
    s_add_u32 s37, s95, 0x142840
    s_mov_b32 m0, 0x7800
    s_nop 0
    buffer_load_dwordx4 v14, s[12:15], s37 offen lds
    s_add_u32 s37, s95, 0x142880
    s_mov_b32 m0, 0xf800
    s_nop 0
    buffer_load_dwordx4 v14, s[12:15], s37 offen lds
    s_add_u32 s37, s95, 0x14d400
    s_mov_b32 m0, 0x3c00
    s_nop 0
    buffer_load_dwordx4 v14, s[12:15], s37 offen lds
    s_add_u32 s37, s95, 0x14d440
    s_mov_b32 m0, 0x7c00
    s_nop 0
    buffer_load_dwordx4 v14, s[12:15], s37 offen lds
    s_add_u32 s37, s95, 0x14d480
    s_mov_b32 m0, 0xfc00
    s_nop 0
    buffer_load_dwordx4 v14, s[12:15], s37 offen lds
    s_cmp_lg_u32 s62, 0
    s_cbranch_scc1 L_nl4_main_kernel
    s_lshl_b32 s38, s33, 16
    s_lshl_b32 s39, s34, 11
    s_add_u32 s38, s38, s39
    s_add_u32 s4, s38, 0x2000000
    buffer_store_dwordx4 v[28:31], v5, s[52:55], s4 offen offset:0
    s_add_u32 s4, s38, 0x2000400
    buffer_store_dwordx4 v[28:31], v5, s[52:55], s4 offen offset:0
    s_add_u32 s4, s38, 0x2004000
    buffer_store_dwordx4 v[28:31], v5, s[52:55], s4 offen offset:0
    s_add_u32 s4, s38, 0x2004400
    buffer_store_dwordx4 v[28:31], v5, s[52:55], s4 offen offset:0
    s_add_u32 s4, s38, 0x2008000
    buffer_store_dwordx4 v[28:31], v5, s[52:55], s4 offen offset:0
    s_add_u32 s4, s38, 0x2008400
    buffer_store_dwordx4 v[28:31], v5, s[52:55], s4 offen offset:0
    s_add_u32 s4, s38, 0x200c000
    buffer_store_dwordx4 v[28:31], v5, s[52:55], s4 offen offset:0
    s_add_u32 s4, s38, 0x200c400
    buffer_store_dwordx4 v[28:31], v5, s[52:55], s4 offen offset:0
    s_lshl_b32 s38, s34, 14
    s_lshl_b32 s39, s33, 9
    s_add_u32 s38, s38, s39
    s_mov_b64 exec, 0xffffffff
    s_add_u32 s4, s38, 0x3200000
    buffer_store_dwordx4 v[28:31], v5, s[52:55], s4 offen offset:0
    s_mov_b64 exec, -1
L_nl4_main_kernel:
    s_waitcnt vmcnt(0)
    s_barrier
    s_sleep 4
    s_mov_b32 s12, s78
    s_mov_b32 s13, s79
    s_mov_b32 s14, 0x158000
    s_mov_b32 s15, 0x00020000
    s_lshl_b32 s95, s94, 6
    s_add_u32 s37, s95, 0x80
    s_mov_b32 m0, 0x8000
    s_nop 0
    buffer_load_dwordx4 v14, s[12:15], s37 offen lds
    s_add_u32 s37, s95, 0xac80
    s_mov_b32 m0, 0x8400
    s_nop 0
    buffer_load_dwordx4 v14, s[12:15], s37 offen lds
    s_add_u32 s37, s95, 0x15880
    s_mov_b32 m0, 0x8800
    s_nop 0
    buffer_load_dwordx4 v14, s[12:15], s37 offen lds
    s_add_u32 s37, s95, 0x20480
    s_mov_b32 m0, 0x8c00
    s_nop 0
    buffer_load_dwordx4 v14, s[12:15], s37 offen lds
    s_add_u32 s37, s95, 0x2b080
    s_mov_b32 m0, 0x9000
    s_nop 0
    buffer_load_dwordx4 v14, s[12:15], s37 offen lds
    s_add_u32 s37, s95, 0x35c80
    s_mov_b32 m0, 0x9400
    s_nop 0
    buffer_load_dwordx4 v14, s[12:15], s37 offen lds
    s_add_u32 s37, s95, 0x40880
    s_mov_b32 m0, 0x9800
    s_nop 0
    buffer_load_dwordx4 v14, s[12:15], s37 offen lds
    s_add_u32 s37, s95, 0x4b480
    s_mov_b32 m0, 0x9c00
    s_nop 0
    buffer_load_dwordx4 v14, s[12:15], s37 offen lds
    s_add_u32 s37, s95, 0x56080
    s_mov_b32 m0, 0xa000
    s_nop 0
    buffer_load_dwordx4 v14, s[12:15], s37 offen lds
    s_add_u32 s37, s95, 0x60c80
    s_mov_b32 m0, 0xa400
    s_nop 0
    buffer_load_dwordx4 v14, s[12:15], s37 offen lds
    s_add_u32 s37, s95, 0x6b880
    s_mov_b32 m0, 0xa800
    s_nop 0
    buffer_load_dwordx4 v14, s[12:15], s37 offen lds
    s_add_u32 s37, s95, 0x76480
    s_mov_b32 m0, 0xac00
    s_nop 0
    buffer_load_dwordx4 v14, s[12:15], s37 offen lds
    s_add_u32 s37, s95, 0x81080
    s_mov_b32 m0, 0xb000
    s_nop 0
    buffer_load_dwordx4 v14, s[12:15], s37 offen lds
    s_add_u32 s37, s95, 0x8bc80
    s_mov_b32 m0, 0xb400
    s_nop 0
    buffer_load_dwordx4 v14, s[12:15], s37 offen lds
    s_add_u32 s37, s95, 0x96880
    s_mov_b32 m0, 0xb800
    s_nop 0
    buffer_load_dwordx4 v14, s[12:15], s37 offen lds
    s_add_u32 s37, s95, 0xa1480
    s_mov_b32 m0, 0xbc00
    s_nop 0
    buffer_load_dwordx4 v14, s[12:15], s37 offen lds
    s_cmp_lg_u32 s62, 0
    s_cbranch_scc1 L_nl5_main_kernel
    ds_read_b64_tr_b16 v[44:45], v36 offset:0
    ds_read_b64_tr_b16 v[46:47], v36 offset:256
    ds_read_b64_tr_b16 v[48:49], v37 offset:0
    ds_read_b64_tr_b16 v[50:51], v37 offset:256
    ds_read_b64_tr_b16 v[52:53], v36 offset:16384
    ds_read_b64_tr_b16 v[54:55], v36 offset:16640
    ds_read_b64_tr_b16 v[56:57], v37 offset:16384
    ds_read_b64_tr_b16 v[58:59], v37 offset:16640
    s_waitcnt lgkmcnt(6)
    v_mfma_f32_16x16x32_bf16 v[100:103], v[44:47], v[40:43], 0
    ds_read_b64_tr_b16 v[44:45], v36 offset:2048
    ds_read_b64_tr_b16 v[46:47], v36 offset:2304
    s_waitcnt lgkmcnt(6)
    v_mfma_f32_16x16x32_bf16 v[104:107], v[48:51], v[40:43], 0
    ds_read_b64_tr_b16 v[48:49], v37 offset:2048
    ds_read_b64_tr_b16 v[50:51], v37 offset:2304
    s_waitcnt lgkmcnt(6)
    v_mfma_f32_16x16x32_bf16 v[108:111], v[52:55], v[40:43], 0
    ds_read_b64_tr_b16 v[52:53], v36 offset:18432
    ds_read_b64_tr_b16 v[54:55], v36 offset:18688
    s_waitcnt lgkmcnt(6)
    v_mfma_f32_16x16x32_bf16 v[112:115], v[56:59], v[40:43], 0
    ds_read_b64_tr_b16 v[56:57], v37 offset:18432
    ds_read_b64_tr_b16 v[58:59], v37 offset:18688
    s_waitcnt lgkmcnt(6)
    v_mfma_f32_16x16x32_bf16 v[100:103], v[44:47], v[40:43], v[100:103]
    ds_read_b64_tr_b16 v[44:45], v36 offset:4096
    ds_read_b64_tr_b16 v[46:47], v36 offset:4352
    s_waitcnt lgkmcnt(6)
    v_mfma_f32_16x16x32_bf16 v[104:107], v[48:51], v[40:43], v[104:107]
    ds_read_b64_tr_b16 v[48:49], v37 offset:4096
    ds_read_b64_tr_b16 v[50:51], v37 offset:4352
    s_waitcnt lgkmcnt(6)
    v_mfma_f32_16x16x32_bf16 v[108:111], v[52:55], v[40:43], v[108:111]
    ds_read_b64_tr_b16 v[52:53], v36 offset:20480
    ds_read_b64_tr_b16 v[54:55], v36 offset:20736
    s_waitcnt lgkmcnt(6)
    v_mfma_f32_16x16x32_bf16 v[112:115], v[56:59], v[40:43], v[112:115]
    ds_read_b64_tr_b16 v[56:57], v37 offset:20480
    ds_read_b64_tr_b16 v[58:59], v37 offset:20736
    s_waitcnt lgkmcnt(6)
    v_mfma_f32_16x16x32_bf16 v[100:103], v[44:47], v[40:43], v[100:103]
    ds_read_b64_tr_b16 v[44:45], v36 offset:6144
    ds_read_b64_tr_b16 v[46:47], v36 offset:6400
    s_waitcnt lgkmcnt(6)
    v_mfma_f32_16x16x32_bf16 v[104:107], v[48:51], v[40:43], v[104:107]
    ds_read_b64_tr_b16 v[48:49], v37 offset:6144
    ds_read_b64_tr_b16 v[50:51], v37 offset:6400
    s_waitcnt lgkmcnt(6)
    v_mfma_f32_16x16x32_bf16 v[108:111], v[52:55], v[40:43], v[108:111]
    ds_read_b64_tr_b16 v[52:53], v36 offset:22528
    ds_read_b64_tr_b16 v[54:55], v36 offset:22784
    s_waitcnt lgkmcnt(6)
    v_mfma_f32_16x16x32_bf16 v[112:115], v[56:59], v[40:43], v[112:115]
    ds_read_b64_tr_b16 v[56:57], v37 offset:22528
    ds_read_b64_tr_b16 v[58:59], v37 offset:22784
    s_waitcnt lgkmcnt(6)
    v_mfma_f32_16x16x32_bf16 v[100:103], v[44:47], v[40:43], v[100:103]
    ds_read_b64_tr_b16 v[44:45], v36 offset:8192
    ds_read_b64_tr_b16 v[46:47], v36 offset:8448
    s_waitcnt lgkmcnt(6)
    v_mfma_f32_16x16x32_bf16 v[104:107], v[48:51], v[40:43], v[104:107]
    ds_read_b64_tr_b16 v[48:49], v37 offset:8192
    ds_read_b64_tr_b16 v[50:51], v37 offset:8448
    s_waitcnt lgkmcnt(6)
    v_mfma_f32_16x16x32_bf16 v[108:111], v[52:55], v[40:43], v[108:111]
    ds_read_b64_tr_b16 v[52:53], v36 offset:24576
    ds_read_b64_tr_b16 v[54:55], v36 offset:24832
    s_waitcnt lgkmcnt(6)
    v_mfma_f32_16x16x32_bf16 v[112:115], v[56:59], v[40:43], v[112:115]
    ds_read_b64_tr_b16 v[56:57], v37 offset:24576
    ds_read_b64_tr_b16 v[58:59], v37 offset:24832
    s_waitcnt lgkmcnt(6)
    v_mfma_f32_16x16x32_bf16 v[100:103], v[44:47], v[40:43], v[100:103]
    ds_read_b64_tr_b16 v[44:45], v36 offset:10240
    ds_read_b64_tr_b16 v[46:47], v36 offset:10496
    s_waitcnt lgkmcnt(6)
    v_mfma_f32_16x16x32_bf16 v[104:107], v[48:51], v[40:43], v[104:107]
    ds_read_b64_tr_b16 v[48:49], v37 offset:10240
    ds_read_b64_tr_b16 v[50:51], v37 offset:10496
    s_waitcnt lgkmcnt(6)
    v_mfma_f32_16x16x32_bf16 v[108:111], v[52:55], v[40:43], v[108:111]
    ds_read_b64_tr_b16 v[52:53], v36 offset:26624
    ds_read_b64_tr_b16 v[54:55], v36 offset:26880
    s_waitcnt lgkmcnt(6)
    v_mfma_f32_16x16x32_bf16 v[112:115], v[56:59], v[40:43], v[112:115]
    ds_read_b64_tr_b16 v[56:57], v37 offset:26624
    ds_read_b64_tr_b16 v[58:59], v37 offset:26880
    s_waitcnt lgkmcnt(6)
    v_mfma_f32_16x16x32_bf16 v[100:103], v[44:47], v[40:43], v[100:103]
    ds_read_b64_tr_b16 v[44:45], v36 offset:12288
    ds_read_b64_tr_b16 v[46:47], v36 offset:12544
    s_waitcnt lgkmcnt(6)
    v_mfma_f32_16x16x32_bf16 v[104:107], v[48:51], v[40:43], v[104:107]
    ds_read_b64_tr_b16 v[48:49], v37 offset:12288
    ds_read_b64_tr_b16 v[50:51], v37 offset:12544
    s_waitcnt lgkmcnt(6)
    v_mfma_f32_16x16x32_bf16 v[108:111], v[52:55], v[40:43], v[108:111]
    ds_read_b64_tr_b16 v[52:53], v36 offset:28672
    ds_read_b64_tr_b16 v[54:55], v36 offset:28928
    s_waitcnt lgkmcnt(6)
    v_mfma_f32_16x16x32_bf16 v[112:115], v[56:59], v[40:43], v[112:115]
    ds_read_b64_tr_b16 v[56:57], v37 offset:28672
    ds_read_b64_tr_b16 v[58:59], v37 offset:28928
    s_waitcnt lgkmcnt(6)
    v_mfma_f32_16x16x32_bf16 v[100:103], v[44:47], v[40:43], v[100:103]
    ds_read_b64_tr_b16 v[44:45], v36 offset:14336
    ds_read_b64_tr_b16 v[46:47], v36 offset:14592
    s_waitcnt lgkmcnt(6)
    v_mfma_f32_16x16x32_bf16 v[104:107], v[48:51], v[40:43], v[104:107]
    ds_read_b64_tr_b16 v[48:49], v37 offset:14336
    ds_read_b64_tr_b16 v[50:51], v37 offset:14592
    s_waitcnt lgkmcnt(6)
    v_mfma_f32_16x16x32_bf16 v[108:111], v[52:55], v[40:43], v[108:111]
    ds_read_b64_tr_b16 v[52:53], v36 offset:30720
    ds_read_b64_tr_b16 v[54:55], v36 offset:30976
    s_waitcnt lgkmcnt(6)
    v_mfma_f32_16x16x32_bf16 v[112:115], v[56:59], v[40:43], v[112:115]
    ds_read_b64_tr_b16 v[56:57], v37 offset:30720
    ds_read_b64_tr_b16 v[58:59], v37 offset:30976
    s_waitcnt lgkmcnt(6)
    v_mfma_f32_16x16x32_bf16 v[100:103], v[44:47], v[40:43], v[100:103]
    ds_read_b64_tr_b16 v[44:45], v32 offset:0
    ds_read_b64_tr_b16 v[46:47], v32 offset:256
    s_waitcnt lgkmcnt(6)
    v_mfma_f32_16x16x32_bf16 v[104:107], v[48:51], v[40:43], v[104:107]
    ds_read_b64_tr_b16 v[48:49], v33 offset:0
    ds_read_b64_tr_b16 v[50:51], v33 offset:256
    s_waitcnt lgkmcnt(6)
    v_mfma_f32_16x16x32_bf16 v[108:111], v[52:55], v[40:43], v[108:111]
    ds_read_b64_tr_b16 v[52:53], v32 offset:16384
    ds_read_b64_tr_b16 v[54:55], v32 offset:16640
    s_waitcnt lgkmcnt(6)
    v_mfma_f32_16x16x32_bf16 v[112:115], v[56:59], v[40:43], v[112:115]
    ds_read_b64_tr_b16 v[56:57], v33 offset:16384
    ds_read_b64_tr_b16 v[58:59], v33 offset:16640
    s_waitcnt lgkmcnt(6)
    v_mfma_f32_16x16x32_bf16 v[100:103], v[44:47], v[40:43], v[100:103]
    ds_read_b64_tr_b16 v[44:45], v32 offset:49152
    ds_read_b64_tr_b16 v[46:47], v32 offset:49408
    s_waitcnt lgkmcnt(6)
    v_mfma_f32_16x16x32_bf16 v[104:107], v[48:51], v[40:43], v[104:107]
    ds_read_b64_tr_b16 v[48:49], v33 offset:49152
    ds_read_b64_tr_b16 v[50:51], v33 offset:49408
    s_waitcnt lgkmcnt(6)
    v_mfma_f32_16x16x32_bf16 v[108:111], v[52:55], v[40:43], v[108:111]
    ds_read_b64_tr_b16 v[52:53], v32 offset:2048
    ds_read_b64_tr_b16 v[54:55], v32 offset:2304
    s_waitcnt lgkmcnt(6)
    v_mfma_f32_16x16x32_bf16 v[112:115], v[56:59], v[40:43], v[112:115]
    ds_read_b64_tr_b16 v[56:57], v33 offset:2048
    ds_read_b64_tr_b16 v[58:59], v33 offset:2304
    s_waitcnt lgkmcnt(6)
    v_mfma_f32_16x16x32_bf16 v[116:119], v[44:47], v[40:43], 0
    ds_read_b64_tr_b16 v[44:45], v32 offset:18432
    ds_read_b64_tr_b16 v[46:47], v32 offset:18688
    s_waitcnt lgkmcnt(6)
    v_mfma_f32_16x16x32_bf16 v[120:123], v[48:51], v[40:43], 0
    ds_read_b64_tr_b16 v[48:49], v33 offset:18432
    ds_read_b64_tr_b16 v[50:51], v33 offset:18688
    s_waitcnt lgkmcnt(6)
    v_mfma_f32_16x16x32_bf16 v[100:103], v[52:55], v[40:43], v[100:103]
    ds_read_b64_tr_b16 v[52:53], v32 offset:51200
    ds_read_b64_tr_b16 v[54:55], v32 offset:51456
    s_waitcnt lgkmcnt(6)
    v_mfma_f32_16x16x32_bf16 v[104:107], v[56:59], v[40:43], v[104:107]
    ds_read_b64_tr_b16 v[56:57], v33 offset:51200
    ds_read_b64_tr_b16 v[58:59], v33 offset:51456
    s_waitcnt lgkmcnt(6)
    v_mfma_f32_16x16x32_bf16 v[108:111], v[44:47], v[40:43], v[108:111]
    ds_read_b64_tr_b16 v[44:45], v32 offset:4096
    ds_read_b64_tr_b16 v[46:47], v32 offset:4352
    s_waitcnt lgkmcnt(6)
    v_mfma_f32_16x16x32_bf16 v[112:115], v[48:51], v[40:43], v[112:115]
    ds_read_b64_tr_b16 v[48:49], v33 offset:4096
    ds_read_b64_tr_b16 v[50:51], v33 offset:4352
    s_waitcnt lgkmcnt(6)
    v_mfma_f32_16x16x32_bf16 v[116:119], v[52:55], v[40:43], v[116:119]
    ds_read_b64_tr_b16 v[52:53], v32 offset:20480
    ds_read_b64_tr_b16 v[54:55], v32 offset:20736
    s_waitcnt lgkmcnt(6)
    v_mfma_f32_16x16x32_bf16 v[120:123], v[56:59], v[40:43], v[120:123]
    ds_read_b64_tr_b16 v[56:57], v33 offset:20480
    ds_read_b64_tr_b16 v[58:59], v33 offset:20736
    s_waitcnt lgkmcnt(6)
    v_mfma_f32_16x16x32_bf16 v[100:103], v[44:47], v[40:43], v[100:103]
    ds_read_b64_tr_b16 v[44:45], v32 offset:53248
    ds_read_b64_tr_b16 v[46:47], v32 offset:53504
    s_waitcnt lgkmcnt(6)
    v_mfma_f32_16x16x32_bf16 v[104:107], v[48:51], v[40:43], v[104:107]
    ds_read_b64_tr_b16 v[48:49], v33 offset:53248
    ds_read_b64_tr_b16 v[50:51], v33 offset:53504
    s_waitcnt lgkmcnt(6)
    v_mfma_f32_16x16x32_bf16 v[108:111], v[52:55], v[40:43], v[108:111]
    ds_read_b64_tr_b16 v[52:53], v32 offset:6144
    ds_read_b64_tr_b16 v[54:55], v32 offset:6400
    s_waitcnt lgkmcnt(6)
    v_mfma_f32_16x16x32_bf16 v[112:115], v[56:59], v[40:43], v[112:115]
    ds_read_b64_tr_b16 v[56:57], v33 offset:6144
    ds_read_b64_tr_b16 v[58:59], v33 offset:6400
    s_waitcnt lgkmcnt(6)
    v_mfma_f32_16x16x32_bf16 v[116:119], v[44:47], v[40:43], v[116:119]
    ds_read_b64_tr_b16 v[44:45], v32 offset:22528
    ds_read_b64_tr_b16 v[46:47], v32 offset:22784
    s_waitcnt lgkmcnt(6)
    v_mfma_f32_16x16x32_bf16 v[120:123], v[48:51], v[40:43], v[120:123]
    ds_read_b64_tr_b16 v[48:49], v33 offset:22528
    ds_read_b64_tr_b16 v[50:51], v33 offset:22784
    s_waitcnt lgkmcnt(6)
    v_mfma_f32_16x16x32_bf16 v[100:103], v[52:55], v[40:43], v[100:103]
    ds_read_b64_tr_b16 v[52:53], v32 offset:55296
    ds_read_b64_tr_b16 v[54:55], v32 offset:55552
    s_waitcnt lgkmcnt(6)
    v_mfma_f32_16x16x32_bf16 v[104:107], v[56:59], v[40:43], v[104:107]
    ds_read_b64_tr_b16 v[56:57], v33 offset:55296
    ds_read_b64_tr_b16 v[58:59], v33 offset:55552
    s_waitcnt lgkmcnt(6)
    v_mfma_f32_16x16x32_bf16 v[108:111], v[44:47], v[40:43], v[108:111]
    ds_read_b64_tr_b16 v[44:45], v32 offset:8192
    ds_read_b64_tr_b16 v[46:47], v32 offset:8448
    s_waitcnt lgkmcnt(6)
    v_mfma_f32_16x16x32_bf16 v[112:115], v[48:51], v[40:43], v[112:115]
    ds_read_b64_tr_b16 v[48:49], v33 offset:8192
    ds_read_b64_tr_b16 v[50:51], v33 offset:8448
    s_waitcnt lgkmcnt(6)
    v_mfma_f32_16x16x32_bf16 v[116:119], v[52:55], v[40:43], v[116:119]
    ds_read_b64_tr_b16 v[52:53], v32 offset:24576
    ds_read_b64_tr_b16 v[54:55], v32 offset:24832
    s_waitcnt lgkmcnt(6)
    v_mfma_f32_16x16x32_bf16 v[120:123], v[56:59], v[40:43], v[120:123]
    ds_read_b64_tr_b16 v[56:57], v33 offset:24576
    ds_read_b64_tr_b16 v[58:59], v33 offset:24832
    s_waitcnt lgkmcnt(6)
    v_mfma_f32_16x16x32_bf16 v[100:103], v[44:47], v[40:43], v[100:103]
    ds_read_b64_tr_b16 v[44:45], v32 offset:57344
    ds_read_b64_tr_b16 v[46:47], v32 offset:57600
    s_waitcnt lgkmcnt(6)
    v_mfma_f32_16x16x32_bf16 v[104:107], v[48:51], v[40:43], v[104:107]
    ds_read_b64_tr_b16 v[48:49], v33 offset:57344
    ds_read_b64_tr_b16 v[50:51], v33 offset:57600
    s_waitcnt lgkmcnt(6)
    v_mfma_f32_16x16x32_bf16 v[108:111], v[52:55], v[40:43], v[108:111]
    ds_read_b64_tr_b16 v[52:53], v32 offset:10240
    ds_read_b64_tr_b16 v[54:55], v32 offset:10496
    s_waitcnt lgkmcnt(6)
    v_mfma_f32_16x16x32_bf16 v[112:115], v[56:59], v[40:43], v[112:115]
    ds_read_b64_tr_b16 v[56:57], v33 offset:10240
    ds_read_b64_tr_b16 v[58:59], v33 offset:10496
    s_waitcnt lgkmcnt(6)
    v_mfma_f32_16x16x32_bf16 v[116:119], v[44:47], v[40:43], v[116:119]
    ds_read_b64_tr_b16 v[44:45], v32 offset:26624
    ds_read_b64_tr_b16 v[46:47], v32 offset:26880
    s_waitcnt lgkmcnt(6)
    v_mfma_f32_16x16x32_bf16 v[120:123], v[48:51], v[40:43], v[120:123]
    ds_read_b64_tr_b16 v[48:49], v33 offset:26624
    ds_read_b64_tr_b16 v[50:51], v33 offset:26880
    s_waitcnt lgkmcnt(6)
    v_mfma_f32_16x16x32_bf16 v[100:103], v[52:55], v[40:43], v[100:103]
    ds_read_b64_tr_b16 v[52:53], v32 offset:59392
    ds_read_b64_tr_b16 v[54:55], v32 offset:59648
    s_waitcnt lgkmcnt(6)
    v_mfma_f32_16x16x32_bf16 v[104:107], v[56:59], v[40:43], v[104:107]
    ds_read_b64_tr_b16 v[56:57], v33 offset:59392
    ds_read_b64_tr_b16 v[58:59], v33 offset:59648
    s_waitcnt lgkmcnt(6)
    v_mfma_f32_16x16x32_bf16 v[108:111], v[44:47], v[40:43], v[108:111]
    ds_read_b64_tr_b16 v[44:45], v32 offset:12288
    ds_read_b64_tr_b16 v[46:47], v32 offset:12544
    s_waitcnt lgkmcnt(6)
    v_mfma_f32_16x16x32_bf16 v[112:115], v[48:51], v[40:43], v[112:115]
    ds_read_b64_tr_b16 v[48:49], v33 offset:12288
    ds_read_b64_tr_b16 v[50:51], v33 offset:12544
    s_waitcnt lgkmcnt(6)
    v_mfma_f32_16x16x32_bf16 v[116:119], v[52:55], v[40:43], v[116:119]
    ds_read_b64_tr_b16 v[52:53], v32 offset:28672
    ds_read_b64_tr_b16 v[54:55], v32 offset:28928
    s_waitcnt lgkmcnt(6)
    v_mfma_f32_16x16x32_bf16 v[120:123], v[56:59], v[40:43], v[120:123]
    ds_read_b64_tr_b16 v[56:57], v33 offset:28672
    ds_read_b64_tr_b16 v[58:59], v33 offset:28928
    s_waitcnt lgkmcnt(6)
    v_mfma_f32_16x16x32_bf16 v[100:103], v[44:47], v[40:43], v[100:103]
    ds_read_b64_tr_b16 v[44:45], v32 offset:61440
    ds_read_b64_tr_b16 v[46:47], v32 offset:61696
    s_waitcnt lgkmcnt(6)
    v_mfma_f32_16x16x32_bf16 v[104:107], v[48:51], v[40:43], v[104:107]
    ds_read_b64_tr_b16 v[48:49], v33 offset:61440
    ds_read_b64_tr_b16 v[50:51], v33 offset:61696
    s_waitcnt lgkmcnt(6)
    v_mfma_f32_16x16x32_bf16 v[108:111], v[52:55], v[40:43], v[108:111]
    ds_read_b64_tr_b16 v[52:53], v32 offset:14336
    ds_read_b64_tr_b16 v[54:55], v32 offset:14592
    s_waitcnt lgkmcnt(6)
    v_mfma_f32_16x16x32_bf16 v[112:115], v[56:59], v[40:43], v[112:115]
    ds_read_b64_tr_b16 v[56:57], v33 offset:14336
    ds_read_b64_tr_b16 v[58:59], v33 offset:14592
    s_waitcnt lgkmcnt(6)
    v_mfma_f32_16x16x32_bf16 v[116:119], v[44:47], v[40:43], v[116:119]
    ds_read_b64_tr_b16 v[44:45], v32 offset:30720
    ds_read_b64_tr_b16 v[46:47], v32 offset:30976
    s_waitcnt lgkmcnt(6)
    v_mfma_f32_16x16x32_bf16 v[120:123], v[48:51], v[40:43], v[120:123]
    ds_read_b64_tr_b16 v[48:49], v33 offset:30720
    ds_read_b64_tr_b16 v[50:51], v33 offset:30976
    s_waitcnt lgkmcnt(6)
    v_mfma_f32_16x16x32_bf16 v[100:103], v[52:55], v[40:43], v[100:103]
    ds_read_b64_tr_b16 v[52:53], v32 offset:63488
    ds_read_b64_tr_b16 v[54:55], v32 offset:63744
    s_waitcnt lgkmcnt(6)
    v_mfma_f32_16x16x32_bf16 v[104:107], v[56:59], v[40:43], v[104:107]
    ds_read_b64_tr_b16 v[56:57], v33 offset:63488
    ds_read_b64_tr_b16 v[58:59], v33 offset:63744
    s_waitcnt lgkmcnt(6)
    v_mfma_f32_16x16x32_bf16 v[108:111], v[44:47], v[40:43], v[108:111]
    s_waitcnt lgkmcnt(4)
    v_mfma_f32_16x16x32_bf16 v[112:115], v[48:51], v[40:43], v[112:115]
    s_waitcnt lgkmcnt(2)
    v_mfma_f32_16x16x32_bf16 v[116:119], v[52:55], v[40:43], v[116:119]
    s_waitcnt lgkmcnt(0)
    v_mfma_f32_16x16x32_bf16 v[120:123], v[56:59], v[40:43], v[120:123]
    s_waitcnt vmcnt(0)
    ds_read_b64_tr_b16 v[44:45], v32 offset:32768
    ds_read_b64_tr_b16 v[46:47], v32 offset:33024
    ds_read_b64_tr_b16 v[48:49], v33 offset:32768
    ds_read_b64_tr_b16 v[50:51], v33 offset:33024
    ds_read_b64_tr_b16 v[52:53], v32 offset:34816
    ds_read_b64_tr_b16 v[54:55], v32 offset:35072
    ds_read_b64_tr_b16 v[56:57], v33 offset:34816
    ds_read_b64_tr_b16 v[58:59], v33 offset:35072
    s_waitcnt lgkmcnt(6)
    v_mfma_f32_16x16x32_bf16 v[116:119], v[44:47], v[40:43], v[116:119]
    ds_read_b64_tr_b16 v[44:45], v32 offset:36864
    ds_read_b64_tr_b16 v[46:47], v32 offset:37120
    s_waitcnt lgkmcnt(6)
    v_mfma_f32_16x16x32_bf16 v[120:123], v[48:51], v[40:43], v[120:123]
    ds_read_b64_tr_b16 v[48:49], v33 offset:36864
    ds_read_b64_tr_b16 v[50:51], v33 offset:37120
    s_waitcnt lgkmcnt(6)
    v_mfma_f32_16x16x32_bf16 v[116:119], v[52:55], v[40:43], v[116:119]
    ds_read_b64_tr_b16 v[52:53], v32 offset:38912
    ds_read_b64_tr_b16 v[54:55], v32 offset:39168
    s_waitcnt lgkmcnt(6)
    v_mfma_f32_16x16x32_bf16 v[120:123], v[56:59], v[40:43], v[120:123]
    ds_read_b64_tr_b16 v[56:57], v33 offset:38912
    ds_read_b64_tr_b16 v[58:59], v33 offset:39168
    s_waitcnt lgkmcnt(6)
    v_mfma_f32_16x16x32_bf16 v[116:119], v[44:47], v[40:43], v[116:119]
    ds_read_b64_tr_b16 v[44:45], v32 offset:40960
    ds_read_b64_tr_b16 v[46:47], v32 offset:41216
    s_waitcnt lgkmcnt(6)
    v_mfma_f32_16x16x32_bf16 v[120:123], v[48:51], v[40:43], v[120:123]
    ds_read_b64_tr_b16 v[48:49], v33 offset:40960
    ds_read_b64_tr_b16 v[50:51], v33 offset:41216
    s_waitcnt lgkmcnt(6)
    v_mfma_f32_16x16x32_bf16 v[116:119], v[52:55], v[40:43], v[116:119]
    ds_read_b64_tr_b16 v[52:53], v32 offset:43008
    ds_read_b64_tr_b16 v[54:55], v32 offset:43264
    s_waitcnt lgkmcnt(6)
    v_mfma_f32_16x16x32_bf16 v[120:123], v[56:59], v[40:43], v[120:123]
    ds_read_b64_tr_b16 v[56:57], v33 offset:43008
    ds_read_b64_tr_b16 v[58:59], v33 offset:43264
    s_waitcnt lgkmcnt(6)
    v_mfma_f32_16x16x32_bf16 v[116:119], v[44:47], v[40:43], v[116:119]
    ds_read_b64_tr_b16 v[44:45], v32 offset:45056
    ds_read_b64_tr_b16 v[46:47], v32 offset:45312
    s_waitcnt lgkmcnt(6)
    v_mfma_f32_16x16x32_bf16 v[120:123], v[48:51], v[40:43], v[120:123]
    ds_read_b64_tr_b16 v[48:49], v33 offset:45056
    ds_read_b64_tr_b16 v[50:51], v33 offset:45312
    s_waitcnt lgkmcnt(6)
    v_mfma_f32_16x16x32_bf16 v[116:119], v[52:55], v[40:43], v[116:119]
    ds_read_b64_tr_b16 v[52:53], v32 offset:47104
    ds_read_b64_tr_b16 v[54:55], v32 offset:47360
    s_waitcnt lgkmcnt(6)
    v_mfma_f32_16x16x32_bf16 v[120:123], v[56:59], v[40:43], v[120:123]
    ds_read_b64_tr_b16 v[56:57], v33 offset:47104
    ds_read_b64_tr_b16 v[58:59], v33 offset:47360
    s_waitcnt lgkmcnt(6)
    v_mfma_f32_16x16x32_bf16 v[116:119], v[44:47], v[40:43], v[116:119]
    s_waitcnt lgkmcnt(4)
    v_mfma_f32_16x16x32_bf16 v[120:123], v[48:51], v[40:43], v[120:123]
    s_waitcnt lgkmcnt(2)
    v_mfma_f32_16x16x32_bf16 v[116:119], v[52:55], v[40:43], v[116:119]
    s_waitcnt lgkmcnt(0)
    v_mfma_f32_16x16x32_bf16 v[120:123], v[56:59], v[40:43], v[120:123]
L_nl5_main_kernel:
    s_nop 7
    s_mov_b32 exec_lo, 0x00010001
    s_mov_b32 exec_hi, 0x00010001
    ds_write_b128 v132, v[100:103] offset:0
    ds_write_b128 v132, v[104:107] offset:64
    ds_write_b128 v132, v[108:111] offset:128
    ds_write_b128 v132, v[112:115] offset:192
    ds_write_b128 v132, v[116:119] offset:256
    ds_write_b128 v132, v[120:123] offset:320
    s_mov_b64 exec, -1
    s_waitcnt vmcnt(0) lgkmcnt(0)
    s_barrier
    s_barrier
    s_mov_b32 s12, s80
    s_mov_b32 s13, s81
    s_mov_b32 s14, 0x158000
    s_mov_b32 s15, 0x00020000
    s_lshl_b32 s95, s34, 7
    s_add_u32 s37, s95, 0x0
    s_mov_b32 m0, 0x10000
    s_nop 0
    buffer_load_dwordx4 v12, s[12:15], s37 offen lds
    s_add_u32 s37, s95, 0x40
    s_mov_b32 m0, 0x14000
    s_nop 0
    buffer_load_dwordx4 v12, s[12:15], s37 offen lds
    s_add_u32 s37, s95, 0x4000
    s_mov_b32 m0, 0x10400
    s_nop 0
    buffer_load_dwordx4 v12, s[12:15], s37 offen lds
    s_add_u32 s37, s95, 0x4040
    s_mov_b32 m0, 0x14400
    s_nop 0
    buffer_load_dwordx4 v12, s[12:15], s37 offen lds
    s_add_u32 s37, s95, 0x8000
    s_mov_b32 m0, 0x10800
    s_nop 0
    buffer_load_dwordx4 v12, s[12:15], s37 offen lds
    s_add_u32 s37, s95, 0x8040
    s_mov_b32 m0, 0x14800
    s_nop 0
    buffer_load_dwordx4 v12, s[12:15], s37 offen lds
    s_add_u32 s37, s95, 0xc000
    s_mov_b32 m0, 0x10c00
    s_nop 0
    buffer_load_dwordx4 v12, s[12:15], s37 offen lds
    s_add_u32 s37, s95, 0xc040
    s_mov_b32 m0, 0x14c00
    s_nop 0
    buffer_load_dwordx4 v12, s[12:15], s37 offen lds
    s_add_u32 s37, s95, 0x10000
    s_mov_b32 m0, 0x11000
    s_nop 0
    buffer_load_dwordx4 v12, s[12:15], s37 offen lds
    s_add_u32 s37, s95, 0x10040
    s_mov_b32 m0, 0x15000
    s_nop 0
    buffer_load_dwordx4 v12, s[12:15], s37 offen lds
    s_add_u32 s37, s95, 0x14000
    s_mov_b32 m0, 0x11400
    s_nop 0
    buffer_load_dwordx4 v12, s[12:15], s37 offen lds
    s_add_u32 s37, s95, 0x14040
    s_mov_b32 m0, 0x15400
    s_nop 0
    buffer_load_dwordx4 v12, s[12:15], s37 offen lds
    s_add_u32 s37, s95, 0x18000
    s_mov_b32 m0, 0x11800
    s_nop 0
    buffer_load_dwordx4 v12, s[12:15], s37 offen lds
    s_add_u32 s37, s95, 0x18040
    s_mov_b32 m0, 0x15800
    s_nop 0
    buffer_load_dwordx4 v12, s[12:15], s37 offen lds
    s_add_u32 s37, s95, 0x1c000
    s_mov_b32 m0, 0x11c00
    s_nop 0
    buffer_load_dwordx4 v12, s[12:15], s37 offen lds
    s_add_u32 s37, s95, 0x1c040
    s_mov_b32 m0, 0x15c00
    s_nop 0
    buffer_load_dwordx4 v12, s[12:15], s37 offen lds
    s_add_u32 s37, s95, 0x20000
    s_mov_b32 m0, 0x12000
    s_nop 0
    buffer_load_dwordx4 v12, s[12:15], s37 offen lds
    s_add_u32 s37, s95, 0x20040
    s_mov_b32 m0, 0x16000
    s_nop 0
    buffer_load_dwordx4 v12, s[12:15], s37 offen lds
    s_add_u32 s37, s95, 0x24000
    s_mov_b32 m0, 0x12400
    s_nop 0
    buffer_load_dwordx4 v12, s[12:15], s37 offen lds
    s_add_u32 s37, s95, 0x24040
    s_mov_b32 m0, 0x16400
    s_nop 0
    buffer_load_dwordx4 v12, s[12:15], s37 offen lds
    s_add_u32 s37, s95, 0x28000
    s_mov_b32 m0, 0x12800
    s_nop 0
    buffer_load_dwordx4 v12, s[12:15], s37 offen lds
    s_add_u32 s37, s95, 0x28040
    s_mov_b32 m0, 0x16800
    s_nop 0
    buffer_load_dwordx4 v12, s[12:15], s37 offen lds
    s_add_u32 s37, s95, 0x2c000
    s_mov_b32 m0, 0x12c00
    s_nop 0
    buffer_load_dwordx4 v12, s[12:15], s37 offen lds
    s_add_u32 s37, s95, 0x2c040
    s_mov_b32 m0, 0x16c00
    s_nop 0
    buffer_load_dwordx4 v12, s[12:15], s37 offen lds
    s_add_u32 s37, s95, 0x30000
    s_mov_b32 m0, 0x13000
    s_nop 0
    buffer_load_dwordx4 v12, s[12:15], s37 offen lds
    s_add_u32 s37, s95, 0x30040
    s_mov_b32 m0, 0x17000
    s_nop 0
    buffer_load_dwordx4 v12, s[12:15], s37 offen lds
    s_add_u32 s37, s95, 0x34000
    s_mov_b32 m0, 0x13400
    s_nop 0
    buffer_load_dwordx4 v12, s[12:15], s37 offen lds
    s_add_u32 s37, s95, 0x34040
    s_mov_b32 m0, 0x17400
    s_nop 0
    buffer_load_dwordx4 v12, s[12:15], s37 offen lds
    s_add_u32 s37, s95, 0x38000
    s_mov_b32 m0, 0x13800
    s_nop 0
    buffer_load_dwordx4 v12, s[12:15], s37 offen lds
    s_add_u32 s37, s95, 0x38040
    s_mov_b32 m0, 0x17800
    s_nop 0
    buffer_load_dwordx4 v12, s[12:15], s37 offen lds
    s_add_u32 s37, s95, 0x3c000
    s_mov_b32 m0, 0x13c00
    s_nop 0
    buffer_load_dwordx4 v12, s[12:15], s37 offen lds
    s_add_u32 s37, s95, 0x3c040
    s_mov_b32 m0, 0x17c00
    s_nop 0
    buffer_load_dwordx4 v12, s[12:15], s37 offen lds
    s_add_u32 s37, s95, 0x40000
    s_mov_b32 m0, 0x18000
    s_nop 0
    buffer_load_dwordx4 v12, s[12:15], s37 offen lds
    s_add_u32 s37, s95, 0x40040
    s_mov_b32 m0, 0x1c000
    s_nop 0
    buffer_load_dwordx4 v12, s[12:15], s37 offen lds
    s_add_u32 s37, s95, 0x44000
    s_mov_b32 m0, 0x18400
    s_nop 0
    buffer_load_dwordx4 v12, s[12:15], s37 offen lds
    s_add_u32 s37, s95, 0x44040
    s_mov_b32 m0, 0x1c400
    s_nop 0
    buffer_load_dwordx4 v12, s[12:15], s37 offen lds
    s_add_u32 s37, s95, 0x48000
    s_mov_b32 m0, 0x18800
    s_nop 0
    buffer_load_dwordx4 v12, s[12:15], s37 offen lds
    s_add_u32 s37, s95, 0x48040
    s_mov_b32 m0, 0x1c800
    s_nop 0
    buffer_load_dwordx4 v12, s[12:15], s37 offen lds
    s_add_u32 s37, s95, 0x4c000
    s_mov_b32 m0, 0x18c00
    s_nop 0
    buffer_load_dwordx4 v12, s[12:15], s37 offen lds
    s_add_u32 s37, s95, 0x4c040
    s_mov_b32 m0, 0x1cc00
    s_nop 0
    buffer_load_dwordx4 v12, s[12:15], s37 offen lds
    s_add_u32 s37, s95, 0x50000
    s_mov_b32 m0, 0x19000
    s_nop 0
    buffer_load_dwordx4 v12, s[12:15], s37 offen lds
    s_add_u32 s37, s95, 0x50040
    s_mov_b32 m0, 0x1d000
    s_nop 0
    buffer_load_dwordx4 v12, s[12:15], s37 offen lds
    s_add_u32 s37, s95, 0x54000
    s_mov_b32 m0, 0x19400
    s_nop 0
    buffer_load_dwordx4 v12, s[12:15], s37 offen lds
    s_add_u32 s37, s95, 0x54040
    s_mov_b32 m0, 0x1d400
    s_nop 0
    buffer_load_dwordx4 v12, s[12:15], s37 offen lds
    s_add_u32 s37, s95, 0x58000
    s_mov_b32 m0, 0x19800
    s_nop 0
    buffer_load_dwordx4 v12, s[12:15], s37 offen lds
    s_add_u32 s37, s95, 0x58040
    s_mov_b32 m0, 0x1d800
    s_nop 0
    buffer_load_dwordx4 v12, s[12:15], s37 offen lds
    s_add_u32 s37, s95, 0x5c000
    s_mov_b32 m0, 0x19c00
    s_nop 0
    buffer_load_dwordx4 v12, s[12:15], s37 offen lds
    s_add_u32 s37, s95, 0x5c040
    s_mov_b32 m0, 0x1dc00
    s_nop 0
    buffer_load_dwordx4 v12, s[12:15], s37 offen lds
    s_add_u32 s37, s95, 0x60000
    s_mov_b32 m0, 0x1a000
    s_nop 0
    buffer_load_dwordx4 v12, s[12:15], s37 offen lds
    s_add_u32 s37, s95, 0x60040
    s_mov_b32 m0, 0x1e000
    s_nop 0
    buffer_load_dwordx4 v12, s[12:15], s37 offen lds
    s_add_u32 s37, s95, 0x64000
    s_mov_b32 m0, 0x1a400
    s_nop 0
    buffer_load_dwordx4 v12, s[12:15], s37 offen lds
    s_add_u32 s37, s95, 0x64040
    s_mov_b32 m0, 0x1e400
    s_nop 0
    buffer_load_dwordx4 v12, s[12:15], s37 offen lds
    s_add_u32 s37, s95, 0x68000
    s_mov_b32 m0, 0x1a800
    s_nop 0
    buffer_load_dwordx4 v12, s[12:15], s37 offen lds
    s_add_u32 s37, s95, 0x68040
    s_mov_b32 m0, 0x1e800
    s_nop 0
    buffer_load_dwordx4 v12, s[12:15], s37 offen lds
    s_add_u32 s37, s95, 0x6c000
    s_mov_b32 m0, 0x1ac00
    s_nop 0
    buffer_load_dwordx4 v12, s[12:15], s37 offen lds
    s_add_u32 s37, s95, 0x6c040
    s_mov_b32 m0, 0x1ec00
    s_nop 0
    buffer_load_dwordx4 v12, s[12:15], s37 offen lds
    s_add_u32 s37, s95, 0x70000
    s_mov_b32 m0, 0x1b000
    s_nop 0
    buffer_load_dwordx4 v12, s[12:15], s37 offen lds
    s_add_u32 s37, s95, 0x70040
    s_mov_b32 m0, 0x1f000
    s_nop 0
    buffer_load_dwordx4 v12, s[12:15], s37 offen lds
    s_add_u32 s37, s95, 0x74000
    s_mov_b32 m0, 0x1b400
    s_nop 0
    buffer_load_dwordx4 v12, s[12:15], s37 offen lds
    s_add_u32 s37, s95, 0x74040
    s_mov_b32 m0, 0x1f400
    s_nop 0
    buffer_load_dwordx4 v12, s[12:15], s37 offen lds
    s_add_u32 s37, s95, 0x78000
    s_mov_b32 m0, 0x1b800
    s_nop 0
    buffer_load_dwordx4 v12, s[12:15], s37 offen lds
    s_add_u32 s37, s95, 0x78040
    s_mov_b32 m0, 0x1f800
    s_nop 0
    buffer_load_dwordx4 v12, s[12:15], s37 offen lds
    s_add_u32 s37, s95, 0x7c000
    s_mov_b32 m0, 0x1bc00
    s_nop 0
    buffer_load_dwordx4 v12, s[12:15], s37 offen lds
    s_add_u32 s37, s95, 0x7c040
    s_mov_b32 m0, 0x1fc00
    s_nop 0
    buffer_load_dwordx4 v12, s[12:15], s37 offen lds
    s_add_u32 s37, s95, 0x80000
    s_mov_b32 m0, 0x0
    s_nop 0
    buffer_load_dwordx4 v12, s[12:15], s37 offen lds
    s_add_u32 s37, s95, 0x80040
    s_mov_b32 m0, 0x4000
    s_nop 0
    buffer_load_dwordx4 v12, s[12:15], s37 offen lds
    s_add_u32 s37, s95, 0x84000
    s_mov_b32 m0, 0x400
    s_nop 0
    buffer_load_dwordx4 v12, s[12:15], s37 offen lds
    s_add_u32 s37, s95, 0x84040
    s_mov_b32 m0, 0x4400
    s_nop 0
    buffer_load_dwordx4 v12, s[12:15], s37 offen lds
    s_add_u32 s37, s95, 0x88000
    s_mov_b32 m0, 0x800
    s_nop 0
    buffer_load_dwordx4 v12, s[12:15], s37 offen lds
    s_add_u32 s37, s95, 0x88040
    s_mov_b32 m0, 0x4800
    s_nop 0
    buffer_load_dwordx4 v12, s[12:15], s37 offen lds
    s_add_u32 s37, s95, 0x8c000
    s_mov_b32 m0, 0xc00
    s_nop 0
    buffer_load_dwordx4 v12, s[12:15], s37 offen lds
    s_add_u32 s37, s95, 0x8c040
    s_mov_b32 m0, 0x4c00
    s_nop 0
    buffer_load_dwordx4 v12, s[12:15], s37 offen lds
    s_add_u32 s37, s95, 0x90000
    s_mov_b32 m0, 0x1000
    s_nop 0
    buffer_load_dwordx4 v12, s[12:15], s37 offen lds
    s_add_u32 s37, s95, 0x90040
    s_mov_b32 m0, 0x5000
    s_nop 0
    buffer_load_dwordx4 v12, s[12:15], s37 offen lds
    s_add_u32 s37, s95, 0x94000
    s_mov_b32 m0, 0x1400
    s_nop 0
    buffer_load_dwordx4 v12, s[12:15], s37 offen lds
    s_add_u32 s37, s95, 0x94040
    s_mov_b32 m0, 0x5400
    s_nop 0
    buffer_load_dwordx4 v12, s[12:15], s37 offen lds
    s_add_u32 s37, s95, 0x98000
    s_mov_b32 m0, 0x1800
    s_nop 0
    buffer_load_dwordx4 v12, s[12:15], s37 offen lds
    s_add_u32 s37, s95, 0x98040
    s_mov_b32 m0, 0x5800
    s_nop 0
    buffer_load_dwordx4 v12, s[12:15], s37 offen lds
    s_add_u32 s37, s95, 0x9c000
    s_mov_b32 m0, 0x1c00
    s_nop 0
    buffer_load_dwordx4 v12, s[12:15], s37 offen lds
    s_add_u32 s37, s95, 0x9c040
    s_mov_b32 m0, 0x5c00
    s_nop 0
    buffer_load_dwordx4 v12, s[12:15], s37 offen lds
    s_add_u32 s37, s95, 0xa0000
    s_mov_b32 m0, 0x2000
    s_nop 0
    buffer_load_dwordx4 v12, s[12:15], s37 offen lds
    s_add_u32 s37, s95, 0xa0040
    s_mov_b32 m0, 0x6000
    s_nop 0
    buffer_load_dwordx4 v12, s[12:15], s37 offen lds
    s_add_u32 s37, s95, 0xa4000
    s_mov_b32 m0, 0x2400
    s_nop 0
    buffer_load_dwordx4 v12, s[12:15], s37 offen lds
    s_add_u32 s37, s95, 0xa4040
    s_mov_b32 m0, 0x6400
    s_nop 0
    buffer_load_dwordx4 v12, s[12:15], s37 offen lds
    s_add_u32 s37, s95, 0xa8000
    s_mov_b32 m0, 0x2800
    s_nop 0
    buffer_load_dwordx4 v12, s[12:15], s37 offen lds
    s_add_u32 s37, s95, 0xa8040
    s_mov_b32 m0, 0x6800
    s_nop 0
    buffer_load_dwordx4 v12, s[12:15], s37 offen lds
    s_add_u32 s37, s95, 0xac000
    s_mov_b32 m0, 0x2c00
    s_nop 0
    buffer_load_dwordx4 v12, s[12:15], s37 offen lds
    s_add_u32 s37, s95, 0xac040
    s_mov_b32 m0, 0x6c00
    s_nop 0
    buffer_load_dwordx4 v12, s[12:15], s37 offen lds
    s_add_u32 s37, s95, 0xb0000
    s_mov_b32 m0, 0x3000
    s_nop 0
    buffer_load_dwordx4 v12, s[12:15], s37 offen lds
    s_add_u32 s37, s95, 0xb0040
    s_mov_b32 m0, 0x7000
    s_nop 0
    buffer_load_dwordx4 v12, s[12:15], s37 offen lds
    s_add_u32 s37, s95, 0xb4000
    s_mov_b32 m0, 0x3400
    s_nop 0
    buffer_load_dwordx4 v12, s[12:15], s37 offen lds
    s_add_u32 s37, s95, 0xb4040
    s_mov_b32 m0, 0x7400
    s_nop 0
    buffer_load_dwordx4 v12, s[12:15], s37 offen lds
    s_add_u32 s37, s95, 0xb8000
    s_mov_b32 m0, 0x3800
    s_nop 0
    buffer_load_dwordx4 v12, s[12:15], s37 offen lds
    s_add_u32 s37, s95, 0xb8040
    s_mov_b32 m0, 0x7800
    s_nop 0
    buffer_load_dwordx4 v12, s[12:15], s37 offen lds
    s_add_u32 s37, s95, 0xbc000
    s_mov_b32 m0, 0x3c00
    s_nop 0
    buffer_load_dwordx4 v12, s[12:15], s37 offen lds
    s_add_u32 s37, s95, 0xbc040
    s_mov_b32 m0, 0x7c00
    s_nop 0
    buffer_load_dwordx4 v12, s[12:15], s37 offen lds
    s_add_u32 s37, s95, 0xc0000
    s_mov_b32 m0, 0x20000
    s_nop 0
    buffer_load_dwordx4 v12, s[12:15], s37 offen lds
    s_add_u32 s37, s95, 0xc0040
    s_mov_b32 m0, 0x24000
    s_nop 0
    buffer_load_dwordx4 v12, s[12:15], s37 offen lds
    s_add_u32 s37, s95, 0xc4000
    s_mov_b32 m0, 0x20400
    s_nop 0
    buffer_load_dwordx4 v12, s[12:15], s37 offen lds
    s_add_u32 s37, s95, 0xc4040
    s_mov_b32 m0, 0x24400
    s_nop 0
    buffer_load_dwordx4 v12, s[12:15], s37 offen lds
    s_add_u32 s37, s95, 0xc8000
    s_mov_b32 m0, 0x20800
    s_nop 0
    buffer_load_dwordx4 v12, s[12:15], s37 offen lds
    s_add_u32 s37, s95, 0xc8040
    s_mov_b32 m0, 0x24800
    s_nop 0
    buffer_load_dwordx4 v12, s[12:15], s37 offen lds
    s_add_u32 s37, s95, 0xcc000
    s_mov_b32 m0, 0x20c00
    s_nop 0
    buffer_load_dwordx4 v12, s[12:15], s37 offen lds
    s_add_u32 s37, s95, 0xcc040
    s_mov_b32 m0, 0x24c00
    s_nop 0
    buffer_load_dwordx4 v12, s[12:15], s37 offen lds
    s_add_u32 s37, s95, 0xd0000
    s_mov_b32 m0, 0x21000
    s_nop 0
    buffer_load_dwordx4 v12, s[12:15], s37 offen lds
    s_add_u32 s37, s95, 0xd0040
    s_mov_b32 m0, 0x25000
    s_nop 0
    buffer_load_dwordx4 v12, s[12:15], s37 offen lds
    s_add_u32 s37, s95, 0xd4000
    s_mov_b32 m0, 0x21400
    s_nop 0
    buffer_load_dwordx4 v12, s[12:15], s37 offen lds
    s_add_u32 s37, s95, 0xd4040
    s_mov_b32 m0, 0x25400
    s_nop 0
    buffer_load_dwordx4 v12, s[12:15], s37 offen lds
    s_add_u32 s37, s95, 0xd8000
    s_mov_b32 m0, 0x21800
    s_nop 0
    buffer_load_dwordx4 v12, s[12:15], s37 offen lds
    s_add_u32 s37, s95, 0xd8040
    s_mov_b32 m0, 0x25800
    s_nop 0
    buffer_load_dwordx4 v12, s[12:15], s37 offen lds
    s_add_u32 s37, s95, 0xdc000
    s_mov_b32 m0, 0x21c00
    s_nop 0
    buffer_load_dwordx4 v12, s[12:15], s37 offen lds
    s_add_u32 s37, s95, 0xdc040
    s_mov_b32 m0, 0x25c00
    s_nop 0
    buffer_load_dwordx4 v12, s[12:15], s37 offen lds
    s_waitcnt vmcnt(63)
    s_barrier
    s_mov_b32 s12, s80
    s_mov_b32 s13, s81
    s_mov_b32 s14, 0x158000
    s_mov_b32 s15, 0x00020000
    s_lshl_b32 s95, s34, 7
    s_add_u32 s37, s95, 0xe0000
    s_mov_b32 m0, 0x22000
    s_nop 0
    buffer_load_dwordx4 v12, s[12:15], s37 offen lds
    s_add_u32 s37, s95, 0xe0040
    s_mov_b32 m0, 0x26000
    s_nop 0
    buffer_load_dwordx4 v12, s[12:15], s37 offen lds
    s_add_u32 s37, s95, 0xe4000
    s_mov_b32 m0, 0x22400
    s_nop 0
    buffer_load_dwordx4 v12, s[12:15], s37 offen lds
    s_add_u32 s37, s95, 0xe4040
    s_mov_b32 m0, 0x26400
    s_nop 0
    buffer_load_dwordx4 v12, s[12:15], s37 offen lds
    s_add_u32 s37, s95, 0xe8000
    s_mov_b32 m0, 0x22800
    s_nop 0
    buffer_load_dwordx4 v12, s[12:15], s37 offen lds
    s_add_u32 s37, s95, 0xe8040
    s_mov_b32 m0, 0x26800
    s_nop 0
    buffer_load_dwordx4 v12, s[12:15], s37 offen lds
    s_add_u32 s37, s95, 0xec000
    s_mov_b32 m0, 0x22c00
    s_nop 0
    buffer_load_dwordx4 v12, s[12:15], s37 offen lds
    s_add_u32 s37, s95, 0xec040
    s_mov_b32 m0, 0x26c00
    s_nop 0
    buffer_load_dwordx4 v12, s[12:15], s37 offen lds
    s_add_u32 s37, s95, 0xf0000
    s_mov_b32 m0, 0x23000
    s_nop 0
    buffer_load_dwordx4 v12, s[12:15], s37 offen lds
    s_add_u32 s37, s95, 0xf0040
    s_mov_b32 m0, 0x27000
    s_nop 0
    buffer_load_dwordx4 v12, s[12:15], s37 offen lds
    s_add_u32 s37, s95, 0xf4000
    s_mov_b32 m0, 0x23400
    s_nop 0
    buffer_load_dwordx4 v12, s[12:15], s37 offen lds
    s_add_u32 s37, s95, 0xf4040
    s_mov_b32 m0, 0x27400
    s_nop 0
    buffer_load_dwordx4 v12, s[12:15], s37 offen lds
    s_add_u32 s37, s95, 0xf8000
    s_mov_b32 m0, 0x23800
    s_nop 0
    buffer_load_dwordx4 v12, s[12:15], s37 offen lds
    s_add_u32 s37, s95, 0xf8040
    s_mov_b32 m0, 0x27800
    s_nop 0
    buffer_load_dwordx4 v12, s[12:15], s37 offen lds
    s_add_u32 s37, s95, 0xfc000
    s_mov_b32 m0, 0x23c00
    s_nop 0
    buffer_load_dwordx4 v12, s[12:15], s37 offen lds
    s_add_u32 s37, s95, 0xfc040
    s_mov_b32 m0, 0x27c00
    s_nop 0
    buffer_load_dwordx4 v12, s[12:15], s37 offen lds
    s_add_u32 s37, s95, 0x100000
    s_mov_b32 m0, 0x8000
    s_nop 0
    buffer_load_dwordx4 v12, s[12:15], s37 offen lds
    s_add_u32 s37, s95, 0x100040
    s_mov_b32 m0, 0xc000
    s_nop 0
    buffer_load_dwordx4 v12, s[12:15], s37 offen lds
    s_add_u32 s37, s95, 0x104000
    s_mov_b32 m0, 0x8400
    s_nop 0
    buffer_load_dwordx4 v12, s[12:15], s37 offen lds
    s_add_u32 s37, s95, 0x104040
    s_mov_b32 m0, 0xc400
    s_nop 0
    buffer_load_dwordx4 v12, s[12:15], s37 offen lds
    s_add_u32 s37, s95, 0x108000
    s_mov_b32 m0, 0x8800
    s_nop 0
    buffer_load_dwordx4 v12, s[12:15], s37 offen lds
    s_add_u32 s37, s95, 0x108040
    s_mov_b32 m0, 0xc800
    s_nop 0
    buffer_load_dwordx4 v12, s[12:15], s37 offen lds
    s_add_u32 s37, s95, 0x10c000
    s_mov_b32 m0, 0x8c00
    s_nop 0
    buffer_load_dwordx4 v12, s[12:15], s37 offen lds
    s_add_u32 s37, s95, 0x10c040
    s_mov_b32 m0, 0xcc00
    s_nop 0
    buffer_load_dwordx4 v12, s[12:15], s37 offen lds
    s_add_u32 s37, s95, 0x110000
    s_mov_b32 m0, 0x9000
    s_nop 0
    buffer_load_dwordx4 v12, s[12:15], s37 offen lds
    s_add_u32 s37, s95, 0x110040
    s_mov_b32 m0, 0xd000
    s_nop 0
    buffer_load_dwordx4 v12, s[12:15], s37 offen lds
    s_add_u32 s37, s95, 0x114000
    s_mov_b32 m0, 0x9400
    s_nop 0
    buffer_load_dwordx4 v12, s[12:15], s37 offen lds
    s_add_u32 s37, s95, 0x114040
    s_mov_b32 m0, 0xd400
    s_nop 0
    buffer_load_dwordx4 v12, s[12:15], s37 offen lds
    s_add_u32 s37, s95, 0x118000
    s_mov_b32 m0, 0x9800
    s_nop 0
    buffer_load_dwordx4 v12, s[12:15], s37 offen lds
    s_add_u32 s37, s95, 0x118040
    s_mov_b32 m0, 0xd800
    s_nop 0
    buffer_load_dwordx4 v12, s[12:15], s37 offen lds
    s_add_u32 s37, s95, 0x11c000
    s_mov_b32 m0, 0x9c00
    s_nop 0
    buffer_load_dwordx4 v12, s[12:15], s37 offen lds
    s_add_u32 s37, s95, 0x11c040
    s_mov_b32 m0, 0xdc00
    s_nop 0
    buffer_load_dwordx4 v12, s[12:15], s37 offen lds
    s_add_u32 s37, s95, 0x120000
    s_mov_b32 m0, 0xa000
    s_nop 0
    buffer_load_dwordx4 v12, s[12:15], s37 offen lds
    s_add_u32 s37, s95, 0x120040
    s_mov_b32 m0, 0xe000
    s_nop 0
    buffer_load_dwordx4 v12, s[12:15], s37 offen lds
    s_add_u32 s37, s95, 0x124000
    s_mov_b32 m0, 0xa400
    s_nop 0
    buffer_load_dwordx4 v12, s[12:15], s37 offen lds
    s_add_u32 s37, s95, 0x124040
    s_mov_b32 m0, 0xe400
    s_nop 0
    buffer_load_dwordx4 v12, s[12:15], s37 offen lds
    s_add_u32 s37, s95, 0x128000
    s_mov_b32 m0, 0xa800
    s_nop 0
    buffer_load_dwordx4 v12, s[12:15], s37 offen lds
    s_add_u32 s37, s95, 0x128040
    s_mov_b32 m0, 0xe800
    s_nop 0
    buffer_load_dwordx4 v12, s[12:15], s37 offen lds
    s_add_u32 s37, s95, 0x12c000
    s_mov_b32 m0, 0xac00
    s_nop 0
    buffer_load_dwordx4 v12, s[12:15], s37 offen lds
    s_add_u32 s37, s95, 0x12c040
    s_mov_b32 m0, 0xec00
    s_nop 0
    buffer_load_dwordx4 v12, s[12:15], s37 offen lds
    s_add_u32 s37, s95, 0x130000
    s_mov_b32 m0, 0xb000
    s_nop 0
    buffer_load_dwordx4 v12, s[12:15], s37 offen lds
    s_add_u32 s37, s95, 0x130040
    s_mov_b32 m0, 0xf000
    s_nop 0
    buffer_load_dwordx4 v12, s[12:15], s37 offen lds
    s_add_u32 s37, s95, 0x134000
    s_mov_b32 m0, 0xb400
    s_nop 0
    buffer_load_dwordx4 v12, s[12:15], s37 offen lds
    s_add_u32 s37, s95, 0x134040
    s_mov_b32 m0, 0xf400
    s_nop 0
    buffer_load_dwordx4 v12, s[12:15], s37 offen lds
    s_add_u32 s37, s95, 0x138000
    s_mov_b32 m0, 0xb800
    s_nop 0
    buffer_load_dwordx4 v12, s[12:15], s37 offen lds
    s_add_u32 s37, s95, 0x138040
    s_mov_b32 m0, 0xf800
    s_nop 0
    buffer_load_dwordx4 v12, s[12:15], s37 offen lds
    s_add_u32 s37, s95, 0x13c000
    s_mov_b32 m0, 0xbc00
    s_nop 0
    buffer_load_dwordx4 v12, s[12:15], s37 offen lds
    s_add_u32 s37, s95, 0x13c040
    s_mov_b32 m0, 0xfc00
    s_nop 0
    buffer_load_dwordx4 v12, s[12:15], s37 offen lds
    s_waitcnt vmcnt(63)
    s_barrier
    s_waitcnt vmcnt(0)
    s_cmp_lg_u32 s62, 0
    s_cbranch_scc1 L_nl6_main_kernel
    s_mov_b32 s12, s66
    s_mov_b32 s13, s67
    s_mov_b32 s14, 0x180000
    s_mov_b32 s15, 0x00020000
    s_lshl_b32 s95, s36, 6
    s_add_u32 s37, s95, 0x800
    s_mov_b32 m0, 0x10000
    s_nop 0
    buffer_load_dwordx4 v11, s[12:15], s37 offen lds
    s_add_u32 s37, s95, 0xc800
    s_mov_b32 m0, 0x10400
    s_nop 0
    buffer_load_dwordx4 v11, s[12:15], s37 offen lds
    s_add_u32 s37, s95, 0x18800
    s_mov_b32 m0, 0x10800
    s_nop 0
    buffer_load_dwordx4 v11, s[12:15], s37 offen lds
    s_add_u32 s37, s95, 0x24800
    s_mov_b32 m0, 0x10c00
    s_nop 0
    buffer_load_dwordx4 v11, s[12:15], s37 offen lds
    s_add_u32 s37, s95, 0x30800
    s_mov_b32 m0, 0x11000
    s_nop 0
    buffer_load_dwordx4 v11, s[12:15], s37 offen lds
    s_add_u32 s37, s95, 0x3c800
    s_mov_b32 m0, 0x11400
    s_nop 0
    buffer_load_dwordx4 v11, s[12:15], s37 offen lds
    s_add_u32 s37, s95, 0x48800
    s_mov_b32 m0, 0x11800
    s_nop 0
    buffer_load_dwordx4 v11, s[12:15], s37 offen lds
    s_add_u32 s37, s95, 0x54800
    s_mov_b32 m0, 0x11c00
    s_nop 0
    buffer_load_dwordx4 v11, s[12:15], s37 offen lds
    s_add_u32 s37, s95, 0x60800
    s_mov_b32 m0, 0x12000
    s_nop 0
    buffer_load_dwordx4 v11, s[12:15], s37 offen lds
    s_add_u32 s37, s95, 0x6c800
    s_mov_b32 m0, 0x12400
    s_nop 0
    buffer_load_dwordx4 v11, s[12:15], s37 offen lds
    s_add_u32 s37, s95, 0x78800
    s_mov_b32 m0, 0x12800
    s_nop 0
    buffer_load_dwordx4 v11, s[12:15], s37 offen lds
    s_add_u32 s37, s95, 0x84800
    s_mov_b32 m0, 0x12c00
    s_nop 0
    buffer_load_dwordx4 v11, s[12:15], s37 offen lds
    s_add_u32 s37, s95, 0x90800
    s_mov_b32 m0, 0x13000
    s_nop 0
    buffer_load_dwordx4 v11, s[12:15], s37 offen lds
    s_add_u32 s37, s95, 0x9c800
    s_mov_b32 m0, 0x13400
    s_nop 0
    buffer_load_dwordx4 v11, s[12:15], s37 offen lds
    s_add_u32 s37, s95, 0xa8800
    s_mov_b32 m0, 0x13800
    s_nop 0
    buffer_load_dwordx4 v11, s[12:15], s37 offen lds
    s_add_u32 s37, s95, 0xb4800
    s_mov_b32 m0, 0x13c00
    s_nop 0
    buffer_load_dwordx4 v11, s[12:15], s37 offen lds
L_nl6_main_kernel:
    s_barrier
    s_mov_b32 s12, s80
    s_mov_b32 s13, s81
    s_mov_b32 s14, 0x158000
    s_mov_b32 s15, 0x00020000
    s_lshl_b32 s95, s34, 7
    s_add_u32 s37, s95, 0x140000
    s_mov_b32 m0, 0x18000
    s_nop 0
    buffer_load_dwordx4 v12, s[12:15], s37 offen lds
    s_add_u32 s37, s95, 0x140040
    s_mov_b32 m0, 0x1c000
    s_nop 0
    buffer_load_dwordx4 v12, s[12:15], s37 offen lds
    s_add_u32 s37, s95, 0x144000
    s_mov_b32 m0, 0x18400
    s_nop 0
    buffer_load_dwordx4 v12, s[12:15], s37 offen lds
    s_add_u32 s37, s95, 0x144040
    s_mov_b32 m0, 0x1c400
    s_nop 0
    buffer_load_dwordx4 v12, s[12:15], s37 offen lds
    s_add_u32 s37, s95, 0x148000
    s_mov_b32 m0, 0x18800
    s_nop 0
    buffer_load_dwordx4 v12, s[12:15], s37 offen lds
    s_add_u32 s37, s95, 0x148040
    s_mov_b32 m0, 0x1c800
    s_nop 0
    buffer_load_dwordx4 v12, s[12:15], s37 offen lds
    s_add_u32 s37, s95, 0x14c000
    s_mov_b32 m0, 0x18c00
    s_nop 0
    buffer_load_dwordx4 v12, s[12:15], s37 offen lds
    s_add_u32 s37, s95, 0x14c040
    s_mov_b32 m0, 0x1cc00
    s_nop 0
    buffer_load_dwordx4 v12, s[12:15], s37 offen lds
    s_add_u32 s37, s95, 0x150000
    s_mov_b32 m0, 0x19000
    s_nop 0
    buffer_load_dwordx4 v12, s[12:15], s37 offen lds
    s_add_u32 s37, s95, 0x150040
    s_mov_b32 m0, 0x1d000
    s_nop 0
    buffer_load_dwordx4 v12, s[12:15], s37 offen lds
    s_add_u32 s37, s95, 0x154000
    s_mov_b32 m0, 0x19400
    s_nop 0
    buffer_load_dwordx4 v12, s[12:15], s37 offen lds
    s_add_u32 s37, s95, 0x154040
    s_mov_b32 m0, 0x1d400
    s_nop 0
    buffer_load_dwordx4 v12, s[12:15], s37 offen lds
    s_barrier
    s_cmp_lg_u32 s62, 0
    s_cbranch_scc1 L_nl7_main_kernel
    s_mov_b32 s12, s66
    s_mov_b32 s13, s67
    s_mov_b32 s14, 0x180000
    s_mov_b32 s15, 0x00020000
    s_lshl_b32 s95, s36, 6
    s_add_u32 s37, s95, 0x400
    s_mov_b32 m0, 0x0
    s_nop 0
    buffer_load_dwordx4 v11, s[12:15], s37 offen lds
    s_add_u32 s37, s95, 0xc400
    s_mov_b32 m0, 0x400
    s_nop 0
    buffer_load_dwordx4 v11, s[12:15], s37 offen lds
    s_add_u32 s37, s95, 0x18400
    s_mov_b32 m0, 0x800
    s_nop 0
    buffer_load_dwordx4 v11, s[12:15], s37 offen lds
    s_add_u32 s37, s95, 0x24400
    s_mov_b32 m0, 0xc00
    s_nop 0
    buffer_load_dwordx4 v11, s[12:15], s37 offen lds
    s_add_u32 s37, s95, 0x30400
    s_mov_b32 m0, 0x1000
    s_nop 0
    buffer_load_dwordx4 v11, s[12:15], s37 offen lds
    s_add_u32 s37, s95, 0x3c400
    s_mov_b32 m0, 0x1400
    s_nop 0
    buffer_load_dwordx4 v11, s[12:15], s37 offen lds
    s_add_u32 s37, s95, 0x48400
    s_mov_b32 m0, 0x1800
    s_nop 0
    buffer_load_dwordx4 v11, s[12:15], s37 offen lds
    s_add_u32 s37, s95, 0x54400
    s_mov_b32 m0, 0x1c00
    s_nop 0
    buffer_load_dwordx4 v11, s[12:15], s37 offen lds
    s_add_u32 s37, s95, 0x60400
    s_mov_b32 m0, 0x2000
    s_nop 0
    buffer_load_dwordx4 v11, s[12:15], s37 offen lds
    s_add_u32 s37, s95, 0x6c400
    s_mov_b32 m0, 0x2400
    s_nop 0
    buffer_load_dwordx4 v11, s[12:15], s37 offen lds
    s_add_u32 s37, s95, 0x78400
    s_mov_b32 m0, 0x2800
    s_nop 0
    buffer_load_dwordx4 v11, s[12:15], s37 offen lds
    s_add_u32 s37, s95, 0x84400
    s_mov_b32 m0, 0x2c00
    s_nop 0
    buffer_load_dwordx4 v11, s[12:15], s37 offen lds
    s_add_u32 s37, s95, 0x90400
    s_mov_b32 m0, 0x3000
    s_nop 0
    buffer_load_dwordx4 v11, s[12:15], s37 offen lds
    s_add_u32 s37, s95, 0x9c400
    s_mov_b32 m0, 0x3400
    s_nop 0
    buffer_load_dwordx4 v11, s[12:15], s37 offen lds
    s_add_u32 s37, s95, 0xa8400
    s_mov_b32 m0, 0x3800
    s_nop 0
    buffer_load_dwordx4 v11, s[12:15], s37 offen lds
    s_add_u32 s37, s95, 0xb4400
    s_mov_b32 m0, 0x3c00
    s_nop 0
    buffer_load_dwordx4 v11, s[12:15], s37 offen lds
L_nl7_main_kernel:
    s_barrier
    s_cmp_lg_u32 s62, 0
    s_cbranch_scc1 L_lw_main_kernel
    s_waitcnt vmcnt(16)
    s_barrier
    s_waitcnt vmcnt(0)
    s_barrier
    s_mov_b32 s12, s66
    s_mov_b32 s13, s67
    s_mov_b32 s14, 0x180000
    s_mov_b32 s15, 0x00020000
    s_lshl_b32 s95, s36, 6
    s_add_u32 s37, s95, 0xc0400
    s_mov_b32 m0, 0x4000
    s_nop 0
    buffer_load_dwordx4 v11, s[12:15], s37 offen lds
    s_add_u32 s37, s95, 0xc0800
    s_mov_b32 m0, 0x14000
    s_nop 0
    buffer_load_dwordx4 v11, s[12:15], s37 offen lds
    s_add_u32 s37, s95, 0xcc400
    s_mov_b32 m0, 0x4400
    s_nop 0
    buffer_load_dwordx4 v11, s[12:15], s37 offen lds
    s_add_u32 s37, s95, 0xcc800
    s_mov_b32 m0, 0x14400
    s_nop 0
    buffer_load_dwordx4 v11, s[12:15], s37 offen lds
    s_add_u32 s37, s95, 0xd8400
    s_mov_b32 m0, 0x4800
    s_nop 0
    buffer_load_dwordx4 v11, s[12:15], s37 offen lds
    s_add_u32 s37, s95, 0xd8800
    s_mov_b32 m0, 0x14800
    s_nop 0
    buffer_load_dwordx4 v11, s[12:15], s37 offen lds
    s_add_u32 s37, s95, 0xe4400
    s_mov_b32 m0, 0x4c00
    s_nop 0
    buffer_load_dwordx4 v11, s[12:15], s37 offen lds
    s_add_u32 s37, s95, 0xe4800
    s_mov_b32 m0, 0x14c00
    s_nop 0
    buffer_load_dwordx4 v11, s[12:15], s37 offen lds
    s_add_u32 s37, s95, 0xf0400
    s_mov_b32 m0, 0x5000
    s_nop 0
    buffer_load_dwordx4 v11, s[12:15], s37 offen lds
    s_add_u32 s37, s95, 0xf0800
    s_mov_b32 m0, 0x15000
    s_nop 0
    buffer_load_dwordx4 v11, s[12:15], s37 offen lds
    s_add_u32 s37, s95, 0xfc400
    s_mov_b32 m0, 0x5400
    s_nop 0
    buffer_load_dwordx4 v11, s[12:15], s37 offen lds
    s_add_u32 s37, s95, 0xfc800
    s_mov_b32 m0, 0x15400
    s_nop 0
    buffer_load_dwordx4 v11, s[12:15], s37 offen lds
    s_add_u32 s37, s95, 0x108400
    s_mov_b32 m0, 0x5800
    s_nop 0
    buffer_load_dwordx4 v11, s[12:15], s37 offen lds
    s_add_u32 s37, s95, 0x108800
    s_mov_b32 m0, 0x15800
    s_nop 0
    buffer_load_dwordx4 v11, s[12:15], s37 offen lds
    s_add_u32 s37, s95, 0x114400
    s_mov_b32 m0, 0x5c00
    s_nop 0
    buffer_load_dwordx4 v11, s[12:15], s37 offen lds
    s_add_u32 s37, s95, 0x114800
    s_mov_b32 m0, 0x15c00
    s_nop 0
    buffer_load_dwordx4 v11, s[12:15], s37 offen lds
    s_add_u32 s37, s95, 0x120400
    s_mov_b32 m0, 0x6000
    s_nop 0
    buffer_load_dwordx4 v11, s[12:15], s37 offen lds
    s_add_u32 s37, s95, 0x120800
    s_mov_b32 m0, 0x16000
    s_nop 0
    buffer_load_dwordx4 v11, s[12:15], s37 offen lds
    s_add_u32 s37, s95, 0x12c400
    s_mov_b32 m0, 0x6400
    s_nop 0
    buffer_load_dwordx4 v11, s[12:15], s37 offen lds
    s_add_u32 s37, s95, 0x12c800
    s_mov_b32 m0, 0x16400
    s_nop 0
    buffer_load_dwordx4 v11, s[12:15], s37 offen lds
    s_add_u32 s37, s95, 0x138400
    s_mov_b32 m0, 0x6800
    s_nop 0
    buffer_load_dwordx4 v11, s[12:15], s37 offen lds
    s_add_u32 s37, s95, 0x138800
    s_mov_b32 m0, 0x16800
    s_nop 0
    buffer_load_dwordx4 v11, s[12:15], s37 offen lds
    s_add_u32 s37, s95, 0x144400
    s_mov_b32 m0, 0x6c00
    s_nop 0
    buffer_load_dwordx4 v11, s[12:15], s37 offen lds
    s_add_u32 s37, s95, 0x144800
    s_mov_b32 m0, 0x16c00
    s_nop 0
    buffer_load_dwordx4 v11, s[12:15], s37 offen lds
    s_add_u32 s37, s95, 0x150400
    s_mov_b32 m0, 0x7000
    s_nop 0
    buffer_load_dwordx4 v11, s[12:15], s37 offen lds
    s_add_u32 s37, s95, 0x150800
    s_mov_b32 m0, 0x17000
    s_nop 0
    buffer_load_dwordx4 v11, s[12:15], s37 offen lds
    s_add_u32 s37, s95, 0x15c400
    s_mov_b32 m0, 0x7400
    s_nop 0
    buffer_load_dwordx4 v11, s[12:15], s37 offen lds
    s_add_u32 s37, s95, 0x15c800
    s_mov_b32 m0, 0x17400
    s_nop 0
    buffer_load_dwordx4 v11, s[12:15], s37 offen lds
    s_add_u32 s37, s95, 0x168400
    s_mov_b32 m0, 0x7800
    s_nop 0
    buffer_load_dwordx4 v11, s[12:15], s37 offen lds
    s_add_u32 s37, s95, 0x168800
    s_mov_b32 m0, 0x17800
    s_nop 0
    buffer_load_dwordx4 v11, s[12:15], s37 offen lds
    s_add_u32 s37, s95, 0x174400
    s_mov_b32 m0, 0x7c00
    s_nop 0
    buffer_load_dwordx4 v11, s[12:15], s37 offen lds
    s_add_u32 s37, s95, 0x174800
    s_mov_b32 m0, 0x17c00
    s_nop 0
    buffer_load_dwordx4 v11, s[12:15], s37 offen lds
    s_mov_b32 s12, s66
    s_mov_b32 s13, s67
    s_mov_b32 s14, 0x180000
    s_mov_b32 s15, 0x00020000
    s_lshl_b32 s95, s36, 6
    s_add_u32 s37, s95, 0x0
    s_mov_b32 m0, 0x8000
    s_nop 0
    buffer_load_dwordx4 v11, s[12:15], s37 offen lds
    s_add_u32 s37, s95, 0xc000
    s_mov_b32 m0, 0x8400
    s_nop 0
    buffer_load_dwordx4 v11, s[12:15], s37 offen lds
    s_add_u32 s37, s95, 0x18000
    s_mov_b32 m0, 0x8800
    s_nop 0
    buffer_load_dwordx4 v11, s[12:15], s37 offen lds
    s_add_u32 s37, s95, 0x24000
    s_mov_b32 m0, 0x8c00
    s_nop 0
    buffer_load_dwordx4 v11, s[12:15], s37 offen lds
    s_add_u32 s37, s95, 0x30000
    s_mov_b32 m0, 0x9000
    s_nop 0
    buffer_load_dwordx4 v11, s[12:15], s37 offen lds
    s_add_u32 s37, s95, 0x3c000
    s_mov_b32 m0, 0x9400
    s_nop 0
    buffer_load_dwordx4 v11, s[12:15], s37 offen lds
    s_add_u32 s37, s95, 0x48000
    s_mov_b32 m0, 0x9800
    s_nop 0
    buffer_load_dwordx4 v11, s[12:15], s37 offen lds
    s_add_u32 s37, s95, 0x54000
    s_mov_b32 m0, 0x9c00
    s_nop 0
    buffer_load_dwordx4 v11, s[12:15], s37 offen lds
    s_add_u32 s37, s95, 0x60000
    s_mov_b32 m0, 0xa000
    s_nop 0
    buffer_load_dwordx4 v11, s[12:15], s37 offen lds
    s_add_u32 s37, s95, 0x6c000
    s_mov_b32 m0, 0xa400
    s_nop 0
    buffer_load_dwordx4 v11, s[12:15], s37 offen lds
    s_add_u32 s37, s95, 0x78000
    s_mov_b32 m0, 0xa800
    s_nop 0
    buffer_load_dwordx4 v11, s[12:15], s37 offen lds
    s_add_u32 s37, s95, 0x84000
    s_mov_b32 m0, 0xac00
    s_nop 0
    buffer_load_dwordx4 v11, s[12:15], s37 offen lds
    s_add_u32 s37, s95, 0x90000
    s_mov_b32 m0, 0xb000
    s_nop 0
    buffer_load_dwordx4 v11, s[12:15], s37 offen lds
    s_add_u32 s37, s95, 0x9c000
    s_mov_b32 m0, 0xb400
    s_nop 0
    buffer_load_dwordx4 v11, s[12:15], s37 offen lds
    s_add_u32 s37, s95, 0xa8000
    s_mov_b32 m0, 0xb800
    s_nop 0
    buffer_load_dwordx4 v11, s[12:15], s37 offen lds
    s_add_u32 s37, s95, 0xb4000
    s_mov_b32 m0, 0xbc00
    s_nop 0
    buffer_load_dwordx4 v11, s[12:15], s37 offen lds
    s_add_u32 s37, s95, 0xc0000
    s_mov_b32 m0, 0xc000
    s_nop 0
    buffer_load_dwordx4 v11, s[12:15], s37 offen lds
    s_add_u32 s37, s95, 0xcc000
    s_mov_b32 m0, 0xc400
    s_nop 0
    buffer_load_dwordx4 v11, s[12:15], s37 offen lds
    s_add_u32 s37, s95, 0xd8000
    s_mov_b32 m0, 0xc800
    s_nop 0
    buffer_load_dwordx4 v11, s[12:15], s37 offen lds
    s_add_u32 s37, s95, 0xe4000
    s_mov_b32 m0, 0xcc00
    s_nop 0
    buffer_load_dwordx4 v11, s[12:15], s37 offen lds
    s_add_u32 s37, s95, 0xf0000
    s_mov_b32 m0, 0xd000
    s_nop 0
    buffer_load_dwordx4 v11, s[12:15], s37 offen lds
    s_add_u32 s37, s95, 0xfc000
    s_mov_b32 m0, 0xd400
    s_nop 0
    buffer_load_dwordx4 v11, s[12:15], s37 offen lds
    s_add_u32 s37, s95, 0x108000
    s_mov_b32 m0, 0xd800
    s_nop 0
    buffer_load_dwordx4 v11, s[12:15], s37 offen lds
    s_add_u32 s37, s95, 0x114000
    s_mov_b32 m0, 0xdc00
    s_nop 0
    buffer_load_dwordx4 v11, s[12:15], s37 offen lds
    s_add_u32 s37, s95, 0x120000
    s_mov_b32 m0, 0xe000
    s_nop 0
    buffer_load_dwordx4 v11, s[12:15], s37 offen lds
    s_add_u32 s37, s95, 0x12c000
    s_mov_b32 m0, 0xe400
    s_nop 0
    buffer_load_dwordx4 v11, s[12:15], s37 offen lds
    s_add_u32 s37, s95, 0x138000
    s_mov_b32 m0, 0xe800
    s_nop 0
    buffer_load_dwordx4 v11, s[12:15], s37 offen lds
    s_add_u32 s37, s95, 0x144000
    s_mov_b32 m0, 0xec00
    s_nop 0
    buffer_load_dwordx4 v11, s[12:15], s37 offen lds
    s_add_u32 s37, s95, 0x150000
    s_mov_b32 m0, 0xf000
    s_nop 0
    buffer_load_dwordx4 v11, s[12:15], s37 offen lds
    s_add_u32 s37, s95, 0x15c000
    s_mov_b32 m0, 0xf400
    s_nop 0
    buffer_load_dwordx4 v11, s[12:15], s37 offen lds
    s_add_u32 s37, s95, 0x168000
    s_mov_b32 m0, 0xf800
    s_nop 0
    buffer_load_dwordx4 v11, s[12:15], s37 offen lds
    s_add_u32 s37, s95, 0x174000
    s_mov_b32 m0, 0xfc00
    s_nop 0
    buffer_load_dwordx4 v11, s[12:15], s37 offen lds
    s_add_u32 s60, s60, 0x2000000
    s_addc_u32 s61, s61, 0
    s_mov_b32 s62, 1
    s_branch L_llayer_main_kernel
L_lw_main_kernel:
    s_waitcnt vmcnt(0)
    s_barrier
    s_barrier
    s_and_b32 s37, s33, 3
    s_or_b32 s37, s37, s34
    s_cmp_lg_u32 s37, 0
    s_cbranch_scc1 L_end_main_kernel
    s_add_u32 s28, s86, 0x1400000
    s_addc_u32 s29, s87, 0
    s_mov_b32 s30, 0x20000
    s_mov_b32 s31, 0x00020000
    s_lshl_b32 s37, s33, 5
    s_add_u32 s37, s37, 0xe000
    v_mov_b32 v15, 96
    s_mov_b64 exec, 1
    buffer_atomic_add v15, v10, s[28:31], s37 offen
    s_branch L_end_main_kernel
L_pl0_main_kernel:
    s_cmp_eq_u32 s3, 0
    s_cbranch_scc1 L_px0_main_kernel
    s_sub_u32 s3, s3, 1
    buffer_load_dwordx2 v[20:21], v16, s[48:51], 0 offen offset:0 sc1
    buffer_load_dwordx2 v[22:23], v16, s[48:51], s96 offen offset:0 sc1
    buffer_load_dwordx2 v[24:25], v16, s[48:51], 0 offen offset:128 sc1
    buffer_load_dwordx2 v[26:27], v16, s[48:51], s96 offen offset:128 sc1
    s_add_u32 s38, s45, 0x0
    buffer_load_dwordx4 v[32:35], v5, s[8:11], s38 offen offset:0 sc1
    s_add_u32 s39, s45, 0x4000
    buffer_load_dwordx4 v[96:99], v5, s[8:11], s39 offen offset:0 sc1
    buffer_load_dwordx4 v[36:39], v5, s[8:11], s38 offen offset:1024 sc1
    buffer_load_dwordx4 v[100:103], v5, s[8:11], s39 offen offset:1024 sc1
    buffer_load_dwordx4 v[40:43], v5, s[8:11], s38 offen offset:2048 sc1
    buffer_load_dwordx4 v[104:107], v5, s[8:11], s39 offen offset:2048 sc1
    buffer_load_dwordx4 v[44:47], v5, s[8:11], s38 offen offset:3072 sc1
    buffer_load_dwordx4 v[108:111], v5, s[8:11], s39 offen offset:3072 sc1
    s_waitcnt vmcnt(8)
    v_max_u32 v7, v21, v23
    v_max3_u32 v7, v7, v25, v27
    v_cmp_eq_u32 vcc, -1, v7
    s_cbranch_vccnz L_pl0_main_kernel
    s_add_u32 s38, s45, 0x1000
    buffer_load_dwordx4 v[48:51], v5, s[8:11], s38 offen offset:0 sc1
    s_add_u32 s39, s45, 0x5000
    buffer_load_dwordx4 v[112:115], v5, s[8:11], s39 offen offset:0 sc1
    buffer_load_dwordx4 v[52:55], v5, s[8:11], s38 offen offset:1024 sc1
    buffer_load_dwordx4 v[116:119], v5, s[8:11], s39 offen offset:1024 sc1
    s_branch L_go0_main_kernel
L_px0_main_kernel:
    s_mov_b64 exec, -1
    s_add_u32 s38, s45, 0x0
    buffer_load_dwordx4 v[32:35], v5, s[8:11], s38 offen offset:0 sc1
    s_add_u32 s39, s45, 0x4000
    buffer_load_dwordx4 v[96:99], v5, s[8:11], s39 offen offset:0 sc1
    buffer_load_dwordx4 v[36:39], v5, s[8:11], s38 offen offset:1024 sc1
    buffer_load_dwordx4 v[100:103], v5, s[8:11], s39 offen offset:1024 sc1
    buffer_load_dwordx4 v[40:43], v5, s[8:11], s38 offen offset:2048 sc1
    buffer_load_dwordx4 v[104:107], v5, s[8:11], s39 offen offset:2048 sc1
    buffer_load_dwordx4 v[44:47], v5, s[8:11], s38 offen offset:3072 sc1
    buffer_load_dwordx4 v[108:111], v5, s[8:11], s39 offen offset:3072 sc1
    s_add_u32 s38, s45, 0x1000
    buffer_load_dwordx4 v[48:51], v5, s[8:11], s38 offen offset:0 sc1
    s_add_u32 s39, s45, 0x5000
    buffer_load_dwordx4 v[112:115], v5, s[8:11], s39 offen offset:0 sc1
    buffer_load_dwordx4 v[52:55], v5, s[8:11], s38 offen offset:1024 sc1
    buffer_load_dwordx4 v[116:119], v5, s[8:11], s39 offen offset:1024 sc1
    s_branch L_go0_main_kernel
L_rt1_main_kernel:
    s_cmp_eq_u32 s3, 0
    s_cbranch_scc1 L_ok1_main_kernel
    s_sub_u32 s3, s3, 1
    s_add_u32 s4, s45, 0x0
    buffer_load_dwordx4 v[32:35], v5, s[8:11], s4 offen offset:0 sc1
    s_add_u32 s4, s45, 0x4000
    buffer_load_dwordx4 v[96:99], v5, s[8:11], s4 offen offset:0 sc1
    s_waitcnt vmcnt(0)
    v_max_u32 v7, v35, v99
    v_cmp_eq_u32 vcc, -1, v7
    s_and_b64 vcc, vcc, s[100:101]
    s_cbranch_vccnz L_rt1_main_kernel
    s_branch L_ok1_main_kernel
L_rt2_main_kernel:
    s_cmp_eq_u32 s3, 0
    s_cbranch_scc1 L_ok2_main_kernel
    s_sub_u32 s3, s3, 1
    s_add_u32 s4, s45, 0x0
    buffer_load_dwordx4 v[36:39], v5, s[8:11], s4 offen offset:1024 sc1
    s_add_u32 s4, s45, 0x4000
    buffer_load_dwordx4 v[100:103], v5, s[8:11], s4 offen offset:1024 sc1
    s_add_u32 s4, s45, 0x0
    buffer_load_dwordx4 v[40:43], v5, s[8:11], s4 offen offset:2048 sc1
    s_add_u32 s4, s45, 0x4000
    buffer_load_dwordx4 v[104:107], v5, s[8:11], s4 offen offset:2048 sc1
    s_waitcnt vmcnt(0)
    v_max3_u32 v7, v39, v103, v43
    v_max_u32 v7, v7, v107
    v_cmp_eq_u32 vcc, -1, v7
    s_and_b64 vcc, vcc, s[100:101]
    s_cbranch_vccnz L_rt2_main_kernel
    s_branch L_ok2_main_kernel
L_rt3_main_kernel:
    s_cmp_eq_u32 s3, 0
    s_cbranch_scc1 L_ok3_main_kernel
    s_sub_u32 s3, s3, 1
    s_add_u32 s4, s45, 0x0
    buffer_load_dwordx4 v[44:47], v5, s[8:11], s4 offen offset:3072 sc1
    s_add_u32 s4, s45, 0x4000
    buffer_load_dwordx4 v[108:111], v5, s[8:11], s4 offen offset:3072 sc1
    s_add_u32 s4, s45, 0x1000
    buffer_load_dwordx4 v[48:51], v5, s[8:11], s4 offen offset:0 sc1
    s_add_u32 s4, s45, 0x5000
    buffer_load_dwordx4 v[112:115], v5, s[8:11], s4 offen offset:0 sc1
    s_waitcnt vmcnt(0)
    v_max3_u32 v7, v47, v111, v51
    v_max_u32 v7, v7, v115
    v_cmp_eq_u32 vcc, -1, v7
    s_and_b64 vcc, vcc, s[100:101]
    s_cbranch_vccnz L_rt3_main_kernel
    s_branch L_ok3_main_kernel
L_rt4_main_kernel:
    s_cmp_eq_u32 s3, 0
    s_cbranch_scc1 L_ok4_main_kernel
    s_sub_u32 s3, s3, 1
    s_add_u32 s4, s45, 0x1000
    buffer_load_dwordx4 v[52:55], v5, s[8:11], s4 offen offset:1024 sc1
    s_add_u32 s4, s45, 0x5000
    buffer_load_dwordx4 v[116:119], v5, s[8:11], s4 offen offset:1024 sc1
    s_add_u32 s4, s45, 0x1000
    buffer_load_dwordx4 v[56:59], v5, s[8:11], s4 offen offset:2048 sc1
    s_add_u32 s4, s45, 0x5000
    buffer_load_dwordx4 v[120:123], v5, s[8:11], s4 offen offset:2048 sc1
    s_waitcnt vmcnt(0)
    v_max3_u32 v7, v55, v119, v59
    v_max_u32 v7, v7, v123
    v_cmp_eq_u32 vcc, -1, v7
    s_and_b64 vcc, vcc, s[100:101]
    s_cbranch_vccnz L_rt4_main_kernel
    s_branch L_ok4_main_kernel
L_rt5_main_kernel:
    s_cmp_eq_u32 s3, 0
    s_cbranch_scc1 L_ok5_main_kernel
    s_sub_u32 s3, s3, 1
    s_add_u32 s4, s45, 0x1000
    buffer_load_dwordx4 v[60:63], v5, s[8:11], s4 offen offset:3072 sc1
    s_add_u32 s4, s45, 0x5000
    buffer_load_dwordx4 v[124:127], v5, s[8:11], s4 offen offset:3072 sc1
    s_add_u32 s4, s45, 0x2000
    buffer_load_dwordx4 v[64:67], v5, s[8:11], s4 offen offset:0 sc1
    s_add_u32 s4, s45, 0x6000
    buffer_load_dwordx4 v[128:131], v5, s[8:11], s4 offen offset:0 sc1
    s_waitcnt vmcnt(0)
    v_max3_u32 v7, v63, v127, v67
    v_max_u32 v7, v7, v131
    v_cmp_eq_u32 vcc, -1, v7
    s_and_b64 vcc, vcc, s[100:101]
    s_cbranch_vccnz L_rt5_main_kernel
    s_branch L_ok5_main_kernel
L_rt6_main_kernel:
    s_cmp_eq_u32 s3, 0
    s_cbranch_scc1 L_ok6_main_kernel
    s_sub_u32 s3, s3, 1
    s_add_u32 s4, s45, 0x2000
    buffer_load_dwordx4 v[68:71], v5, s[8:11], s4 offen offset:1024 sc1
    s_add_u32 s4, s45, 0x6000
    buffer_load_dwordx4 v[132:135], v5, s[8:11], s4 offen offset:1024 sc1
    s_add_u32 s4, s45, 0x2000
    buffer_load_dwordx4 v[72:75], v5, s[8:11], s4 offen offset:2048 sc1
    s_add_u32 s4, s45, 0x6000
    buffer_load_dwordx4 v[136:139], v5, s[8:11], s4 offen offset:2048 sc1
    s_waitcnt vmcnt(0)
    v_max3_u32 v7, v71, v135, v75
    v_max_u32 v7, v7, v139
    v_cmp_eq_u32 vcc, -1, v7
    s_and_b64 vcc, vcc, s[100:101]
    s_cbranch_vccnz L_rt6_main_kernel
    s_branch L_ok6_main_kernel
L_rt7_main_kernel:
    s_cmp_eq_u32 s3, 0
    s_cbranch_scc1 L_ok7_main_kernel
    s_sub_u32 s3, s3, 1
    s_add_u32 s4, s45, 0x2000
    buffer_load_dwordx4 v[76:79], v5, s[8:11], s4 offen offset:3072 sc1
    s_add_u32 s4, s45, 0x6000
    buffer_load_dwordx4 v[140:143], v5, s[8:11], s4 offen offset:3072 sc1
    s_add_u32 s4, s45, 0x3000
    buffer_load_dwordx4 v[80:83], v5, s[8:11], s4 offen offset:0 sc1
    s_add_u32 s4, s45, 0x7000
    buffer_load_dwordx4 v[144:147], v5, s[8:11], s4 offen offset:0 sc1
    s_waitcnt vmcnt(0)
    v_max3_u32 v7, v79, v143, v83
    v_max_u32 v7, v7, v147
    v_cmp_eq_u32 vcc, -1, v7
    s_and_b64 vcc, vcc, s[100:101]
    s_cbranch_vccnz L_rt7_main_kernel
    s_branch L_ok7_main_kernel
L_rt8_main_kernel:
    s_cmp_eq_u32 s3, 0
    s_cbranch_scc1 L_ok8_main_kernel
    s_sub_u32 s3, s3, 1
    s_add_u32 s4, s45, 0x3000
    buffer_load_dwordx4 v[84:87], v5, s[8:11], s4 offen offset:1024 sc1
    s_add_u32 s4, s45, 0x7000
    buffer_load_dwordx4 v[148:151], v5, s[8:11], s4 offen offset:1024 sc1
    s_add_u32 s4, s45, 0x3000
    buffer_load_dwordx4 v[88:91], v5, s[8:11], s4 offen offset:2048 sc1
    s_add_u32 s4, s45, 0x7000
    buffer_load_dwordx4 v[152:155], v5, s[8:11], s4 offen offset:2048 sc1
    s_waitcnt vmcnt(0)
    v_max3_u32 v7, v87, v151, v91
    v_max_u32 v7, v7, v155
    v_cmp_eq_u32 vcc, -1, v7
    s_and_b64 vcc, vcc, s[100:101]
    s_cbranch_vccnz L_rt8_main_kernel
    s_branch L_ok8_main_kernel
L_rt9_main_kernel:
    s_cmp_eq_u32 s3, 0
    s_cbranch_scc1 L_ok9_main_kernel
    s_sub_u32 s3, s3, 1
    s_add_u32 s4, s45, 0x3000
    buffer_load_dwordx4 v[92:95], v5, s[8:11], s4 offen offset:3072 sc1
    s_add_u32 s4, s45, 0x7000
    buffer_load_dwordx4 v[156:159], v5, s[8:11], s4 offen offset:3072 sc1
    s_waitcnt vmcnt(0)
    v_max_u32 v7, v95, v159
    v_cmp_eq_u32 vcc, -1, v7
    s_and_b64 vcc, vcc, s[100:101]
    s_cbranch_vccnz L_rt9_main_kernel
    s_branch L_ok9_main_kernel
L_zr_main_kernel:
    s_cmp_eq_u32 s3, 0
    s_cbranch_scc1 L_zo_main_kernel
    s_sub_u32 s3, s3, 1
    buffer_load_dwordx4 v[96:99], v178, s[24:27], s38 offen sc1
    s_waitcnt vmcnt(0)
    v_cmp_eq_u32 vcc, -1, v99
    s_cbranch_vccnz L_zr_main_kernel
    buffer_load_dwordx2 v[128:129], v15, s[24:27], s37 offen offset:0 sc1
    buffer_load_dwordx2 v[130:131], v15, s[24:27], s37 offen offset:512 sc1
    buffer_load_dwordx2 v[132:133], v15, s[24:27], s37 offen offset:1024 sc1
    buffer_load_dwordx2 v[134:135], v15, s[24:27], s37 offen offset:1536 sc1
    buffer_load_dwordx2 v[136:137], v15, s[24:27], s37 offen offset:2048 sc1
    buffer_load_dwordx2 v[138:139], v15, s[24:27], s37 offen offset:2560 sc1
    buffer_load_dwordx2 v[140:141], v15, s[24:27], s37 offen offset:3072 sc1
    buffer_load_dwordx2 v[142:143], v15, s[24:27], s37 offen offset:3584 sc1
    buffer_load_dwordx2 v[144:145], v15, s[24:27], s5 offen offset:0 sc1
    buffer_load_dwordx2 v[146:147], v15, s[24:27], s5 offen offset:512 sc1
    buffer_load_dwordx2 v[148:149], v15, s[24:27], s5 offen offset:1024 sc1
    buffer_load_dwordx2 v[150:151], v15, s[24:27], s5 offen offset:1536 sc1
    buffer_load_dwordx2 v[152:153], v15, s[24:27], s5 offen offset:2048 sc1
    buffer_load_dwordx2 v[154:155], v15, s[24:27], s5 offen offset:2560 sc1
    buffer_load_dwordx2 v[156:157], v15, s[24:27], s5 offen offset:3072 sc1
    buffer_load_dwordx2 v[158:159], v15, s[24:27], s5 offen offset:3584 sc1
    s_branch L_zo_main_kernel
L_kr_main_kernel:
    s_cmp_eq_u32 s3, 0
    s_cbranch_scc1 L_ko_main_kernel
    s_sub_u32 s3, s3, 1
    buffer_load_dwordx2 v[128:129], v15, s[24:27], s37 offen offset:0 sc1
    buffer_load_dwordx2 v[130:131], v15, s[24:27], s37 offen offset:512 sc1
    buffer_load_dwordx2 v[132:133], v15, s[24:27], s37 offen offset:1024 sc1
    buffer_load_dwordx2 v[134:135], v15, s[24:27], s37 offen offset:1536 sc1
    buffer_load_dwordx2 v[136:137], v15, s[24:27], s37 offen offset:2048 sc1
    buffer_load_dwordx2 v[138:139], v15, s[24:27], s37 offen offset:2560 sc1
    buffer_load_dwordx2 v[140:141], v15, s[24:27], s37 offen offset:3072 sc1
    buffer_load_dwordx2 v[142:143], v15, s[24:27], s37 offen offset:3584 sc1
    buffer_load_dwordx2 v[144:145], v15, s[24:27], s5 offen offset:0 sc1
    buffer_load_dwordx2 v[146:147], v15, s[24:27], s5 offen offset:512 sc1
    buffer_load_dwordx2 v[148:149], v15, s[24:27], s5 offen offset:1024 sc1
    buffer_load_dwordx2 v[150:151], v15, s[24:27], s5 offen offset:1536 sc1
    buffer_load_dwordx2 v[152:153], v15, s[24:27], s5 offen offset:2048 sc1
    buffer_load_dwordx2 v[154:155], v15, s[24:27], s5 offen offset:2560 sc1
    buffer_load_dwordx2 v[156:157], v15, s[24:27], s5 offen offset:3072 sc1
    buffer_load_dwordx2 v[158:159], v15, s[24:27], s5 offen offset:3584 sc1
    s_branch L_ks_main_kernel
L_rt11_main_kernel:
    s_cmp_eq_u32 s3, 0
    s_cbranch_scc1 L_rt11_main_kernelx
    s_sub_u32 s3, s3, 1
    s_add_u32 s4, s45, 0x0
    buffer_load_dwordx4 v[16:19], v5, s[8:11], s4 offen offset:0 sc1
    s_add_u32 s4, s45, 0x0
    buffer_load_dwordx4 v[20:23], v5, s[8:11], s4 offen offset:1024 sc1
    s_add_u32 s4, s45, 0x0
    buffer_load_dwordx4 v[24:27], v5, s[8:11], s4 offen offset:2048 sc1
    s_waitcnt vmcnt(2)
    v_cmp_eq_u32 vcc, -1, v19
    s_cbranch_vccnz L_rt11_main_kernel
L_rt11_main_kernelx:
    s_add_u32 s4, s45, 0x0
    buffer_load_dwordx4 v[28:31], v5, s[8:11], s4 offen offset:3072 sc1
    s_add_u32 s4, s45, 0x1000
    buffer_load_dwordx4 v[32:35], v5, s[8:11], s4 offen offset:0 sc1
    s_add_u32 s4, s45, 0x1000
    buffer_load_dwordx4 v[36:39], v5, s[8:11], s4 offen offset:1024 sc1
    s_add_u32 s4, s45, 0x1000
    buffer_load_dwordx4 v[40:43], v5, s[8:11], s4 offen offset:2048 sc1
    s_add_u32 s4, s45, 0x1000
    buffer_load_dwordx4 v[44:47], v5, s[8:11], s4 offen offset:3072 sc1
    s_add_u32 s4, s45, 0x2000
    buffer_load_dwordx4 v[48:51], v5, s[8:11], s4 offen offset:0 sc1
    s_add_u32 s4, s45, 0x2000
    buffer_load_dwordx4 v[52:55], v5, s[8:11], s4 offen offset:1024 sc1
    s_add_u32 s4, s45, 0x2000
    buffer_load_dwordx4 v[56:59], v5, s[8:11], s4 offen offset:2048 sc1
    s_add_u32 s4, s45, 0x2000
    buffer_load_dwordx4 v[60:63], v5, s[8:11], s4 offen offset:3072 sc1
    s_branch L_ok11_main_kernel
L_rt12_main_kernel:
    s_cmp_eq_u32 s3, 0
    s_cbranch_scc1 L_rt12_main_kernelx
    s_sub_u32 s3, s3, 1
    s_add_u32 s4, s45, 0x0
    buffer_load_dwordx4 v[20:23], v5, s[8:11], s4 offen offset:1024 sc1
    s_add_u32 s4, s45, 0x0
    buffer_load_dwordx4 v[24:27], v5, s[8:11], s4 offen offset:2048 sc1
    s_add_u32 s4, s45, 0x0
    buffer_load_dwordx4 v[28:31], v5, s[8:11], s4 offen offset:3072 sc1
    s_waitcnt vmcnt(0)
    v_max3_u32 v7, v23, v27, v31
    v_cmp_eq_u32 vcc, -1, v7
    s_cbranch_vccnz L_rt12_main_kernel
L_rt12_main_kernelx:
    s_add_u32 s4, s45, 0x1000
    buffer_load_dwordx4 v[32:35], v5, s[8:11], s4 offen offset:0 sc1
    s_add_u32 s4, s45, 0x1000
    buffer_load_dwordx4 v[36:39], v5, s[8:11], s4 offen offset:1024 sc1
    s_add_u32 s4, s45, 0x1000
    buffer_load_dwordx4 v[40:43], v5, s[8:11], s4 offen offset:2048 sc1
    s_add_u32 s4, s45, 0x1000
    buffer_load_dwordx4 v[44:47], v5, s[8:11], s4 offen offset:3072 sc1
    s_add_u32 s4, s45, 0x2000
    buffer_load_dwordx4 v[48:51], v5, s[8:11], s4 offen offset:0 sc1
    s_add_u32 s4, s45, 0x2000
    buffer_load_dwordx4 v[52:55], v5, s[8:11], s4 offen offset:1024 sc1
    s_add_u32 s4, s45, 0x2000
    buffer_load_dwordx4 v[56:59], v5, s[8:11], s4 offen offset:2048 sc1
    s_add_u32 s4, s45, 0x2000
    buffer_load_dwordx4 v[60:63], v5, s[8:11], s4 offen offset:3072 sc1
    s_add_u32 s4, s45, 0x3000
    buffer_load_dwordx4 v[64:67], v5, s[8:11], s4 offen offset:0 sc1
    s_branch L_ok12_main_kernel
L_rt13_main_kernel:
    s_cmp_eq_u32 s3, 0
    s_cbranch_scc1 L_rt13_main_kernelx
    s_sub_u32 s3, s3, 1
    s_add_u32 s4, s45, 0x1000
    buffer_load_dwordx4 v[32:35], v5, s[8:11], s4 offen offset:0 sc1
    s_add_u32 s4, s45, 0x1000
    buffer_load_dwordx4 v[36:39], v5, s[8:11], s4 offen offset:1024 sc1
    s_add_u32 s4, s45, 0x1000
    buffer_load_dwordx4 v[40:43], v5, s[8:11], s4 offen offset:2048 sc1
    s_waitcnt vmcnt(0)
    v_max3_u32 v7, v35, v39, v43
    v_cmp_eq_u32 vcc, -1, v7
    s_cbranch_vccnz L_rt13_main_kernel
L_rt13_main_kernelx:
    s_add_u32 s4, s45, 0x1000
    buffer_load_dwordx4 v[44:47], v5, s[8:11], s4 offen offset:3072 sc1
    s_add_u32 s4, s45, 0x2000
    buffer_load_dwordx4 v[48:51], v5, s[8:11], s4 offen offset:0 sc1
    s_add_u32 s4, s45, 0x2000
    buffer_load_dwordx4 v[52:55], v5, s[8:11], s4 offen offset:1024 sc1
    s_add_u32 s4, s45, 0x2000
    buffer_load_dwordx4 v[56:59], v5, s[8:11], s4 offen offset:2048 sc1
    s_add_u32 s4, s45, 0x2000
    buffer_load_dwordx4 v[60:63], v5, s[8:11], s4 offen offset:3072 sc1
    s_add_u32 s4, s45, 0x3000
    buffer_load_dwordx4 v[64:67], v5, s[8:11], s4 offen offset:0 sc1
    s_add_u32 s4, s45, 0x3000
    buffer_load_dwordx4 v[68:71], v5, s[8:11], s4 offen offset:1024 sc1
    s_add_u32 s4, s45, 0x3000
    buffer_load_dwordx4 v[72:75], v5, s[8:11], s4 offen offset:2048 sc1
    s_add_u32 s4, s45, 0x3000
    buffer_load_dwordx4 v[76:79], v5, s[8:11], s4 offen offset:3072 sc1
    s_branch L_ok13_main_kernel
L_rt14_main_kernel:
    s_cmp_eq_u32 s3, 0
    s_cbranch_scc1 L_rt14_main_kernelx
    s_sub_u32 s3, s3, 1
    s_add_u32 s4, s45, 0x1000
    buffer_load_dwordx4 v[44:47], v5, s[8:11], s4 offen offset:3072 sc1
    s_add_u32 s4, s45, 0x2000
    buffer_load_dwordx4 v[48:51], v5, s[8:11], s4 offen offset:0 sc1
    s_add_u32 s4, s45, 0x2000
    buffer_load_dwordx4 v[52:55], v5, s[8:11], s4 offen offset:1024 sc1
    s_waitcnt vmcnt(0)
    v_max3_u32 v7, v47, v51, v55
    v_cmp_eq_u32 vcc, -1, v7
    s_cbranch_vccnz L_rt14_main_kernel
L_rt14_main_kernelx:
    s_add_u32 s4, s45, 0x2000
    buffer_load_dwordx4 v[56:59], v5, s[8:11], s4 offen offset:2048 sc1
    s_add_u32 s4, s45, 0x2000
    buffer_load_dwordx4 v[60:63], v5, s[8:11], s4 offen offset:3072 sc1
    s_add_u32 s4, s45, 0x3000
    buffer_load_dwordx4 v[64:67], v5, s[8:11], s4 offen offset:0 sc1
    s_add_u32 s4, s45, 0x3000
    buffer_load_dwordx4 v[68:71], v5, s[8:11], s4 offen offset:1024 sc1
    s_add_u32 s4, s45, 0x3000
    buffer_load_dwordx4 v[72:75], v5, s[8:11], s4 offen offset:2048 sc1
    s_add_u32 s4, s45, 0x3000
    buffer_load_dwordx4 v[76:79], v5, s[8:11], s4 offen offset:3072 sc1
    s_branch L_ok14_main_kernel
L_rt15_main_kernel:
    s_cmp_eq_u32 s3, 0
    s_cbranch_scc1 L_rt15_main_kernelx
    s_sub_u32 s3, s3, 1
    s_add_u32 s4, s45, 0x2000
    buffer_load_dwordx4 v[56:59], v5, s[8:11], s4 offen offset:2048 sc1
    s_add_u32 s4, s45, 0x2000
    buffer_load_dwordx4 v[60:63], v5, s[8:11], s4 offen offset:3072 sc1
    s_add_u32 s4, s45, 0x3000
    buffer_load_dwordx4 v[64:67], v5, s[8:11], s4 offen offset:0 sc1
    s_waitcnt vmcnt(0)
    v_max3_u32 v7, v59, v63, v67
    v_cmp_eq_u32 vcc, -1, v7
    s_cbranch_vccnz L_rt15_main_kernel
L_rt15_main_kernelx:
    s_add_u32 s4, s45, 0x3000
    buffer_load_dwordx4 v[68:71], v5, s[8:11], s4 offen offset:1024 sc1
    s_add_u32 s4, s45, 0x3000
    buffer_load_dwordx4 v[72:75], v5, s[8:11], s4 offen offset:2048 sc1
    s_add_u32 s4, s45, 0x3000
    buffer_load_dwordx4 v[76:79], v5, s[8:11], s4 offen offset:3072 sc1
    s_branch L_ok15_main_kernel
L_rt16_main_kernel:
    s_cmp_eq_u32 s3, 0
    s_cbranch_scc1 L_rt16_main_kernelx
    s_sub_u32 s3, s3, 1
    s_add_u32 s4, s45, 0x3000
    buffer_load_dwordx4 v[68:71], v5, s[8:11], s4 offen offset:1024 sc1
    s_add_u32 s4, s45, 0x3000
    buffer_load_dwordx4 v[72:75], v5, s[8:11], s4 offen offset:2048 sc1
    s_add_u32 s4, s45, 0x3000
    buffer_load_dwordx4 v[76:79], v5, s[8:11], s4 offen offset:3072 sc1
    s_waitcnt vmcnt(0)
    v_max3_u32 v7, v71, v75, v79
    v_cmp_eq_u32 vcc, -1, v7
    s_cbranch_vccnz L_rt16_main_kernel
L_rt16_main_kernelx:
    s_branch L_ok16_main_kernel
L_pl17_main_kernel:
    s_cmp_eq_u32 s3, 0
    s_cbranch_scc1 L_px17_main_kernel
    s_sub_u32 s3, s3, 1
    buffer_load_dwordx2 v[100:101], v96, s[48:51], 0 offen offset:0 sc1
    buffer_load_dwordx2 v[102:103], v96, s[48:51], s96 offen offset:0 sc1
    s_add_u32 s38, s45, 0x0
    buffer_load_dwordx4 v[16:19], v5, s[8:11], s38 offen offset:0 sc1
    buffer_load_dwordx4 v[20:23], v5, s[8:11], s38 offen offset:1024 sc1
    buffer_load_dwordx4 v[24:27], v5, s[8:11], s38 offen offset:2048 sc1
    buffer_load_dwordx4 v[28:31], v5, s[8:11], s38 offen offset:3072 sc1
    s_waitcnt vmcnt(4)
    v_max_u32 v7, v101, v103
    v_cmp_eq_u32 vcc, -1, v7
    s_cbranch_vccnz L_pl17_main_kernel
    s_add_u32 s38, s45, 0x1000
    buffer_load_dwordx4 v[32:35], v5, s[8:11], s38 offen offset:0 sc1
    buffer_load_dwordx4 v[36:39], v5, s[8:11], s38 offen offset:1024 sc1
    buffer_load_dwordx4 v[40:43], v5, s[8:11], s38 offen offset:2048 sc1
    buffer_load_dwordx4 v[44:47], v5, s[8:11], s38 offen offset:3072 sc1
    s_add_u32 s38, s45, 0x2000
    buffer_load_dwordx4 v[48:51], v5, s[8:11], s38 offen offset:0 sc1
    buffer_load_dwordx4 v[52:55], v5, s[8:11], s38 offen offset:1024 sc1
    buffer_load_dwordx4 v[56:59], v5, s[8:11], s38 offen offset:2048 sc1
    buffer_load_dwordx4 v[60:63], v5, s[8:11], s38 offen offset:3072 sc1
    s_branch L_go17_main_kernel
L_px17_main_kernel:
    s_mov_b64 exec, -1
    s_add_u32 s38, s45, 0x0
    buffer_load_dwordx4 v[16:19], v5, s[8:11], s38 offen offset:0 sc1
    buffer_load_dwordx4 v[20:23], v5, s[8:11], s38 offen offset:1024 sc1
    buffer_load_dwordx4 v[24:27], v5, s[8:11], s38 offen offset:2048 sc1
    buffer_load_dwordx4 v[28:31], v5, s[8:11], s38 offen offset:3072 sc1
    s_add_u32 s38, s45, 0x1000
    buffer_load_dwordx4 v[32:35], v5, s[8:11], s38 offen offset:0 sc1
    buffer_load_dwordx4 v[36:39], v5, s[8:11], s38 offen offset:1024 sc1
    buffer_load_dwordx4 v[40:43], v5, s[8:11], s38 offen offset:2048 sc1
    buffer_load_dwordx4 v[44:47], v5, s[8:11], s38 offen offset:3072 sc1
    s_add_u32 s38, s45, 0x2000
    buffer_load_dwordx4 v[48:51], v5, s[8:11], s38 offen offset:0 sc1
    buffer_load_dwordx4 v[52:55], v5, s[8:11], s38 offen offset:1024 sc1
    buffer_load_dwordx4 v[56:59], v5, s[8:11], s38 offen offset:2048 sc1
    buffer_load_dwordx4 v[60:63], v5, s[8:11], s38 offen offset:3072 sc1
    s_branch L_go17_main_kernel
L_rt18_main_kernel:
    s_cmp_eq_u32 s3, 0
    s_cbranch_scc1 L_ok18_main_kernel
    s_sub_u32 s3, s3, 1
    s_add_u32 s4, s45, 0x0
    buffer_load_dwordx4 v[16:19], v5, s[8:11], s4 offen offset:0 sc1
    s_waitcnt vmcnt(0)
    v_cmp_eq_u32 vcc, -1, v19
    s_cbranch_vccnz L_rt18_main_kernel
    s_branch L_ok18_main_kernel
L_rt19_main_kernel:
    s_cmp_eq_u32 s3, 0
    s_cbranch_scc1 L_ok19_main_kernel
    s_sub_u32 s3, s3, 1
    s_add_u32 s4, s45, 0x0
    buffer_load_dwordx4 v[20:23], v5, s[8:11], s4 offen offset:1024 sc1
    s_add_u32 s4, s45, 0x0
    buffer_load_dwordx4 v[24:27], v5, s[8:11], s4 offen offset:2048 sc1
    s_add_u32 s4, s45, 0x0
    buffer_load_dwordx4 v[28:31], v5, s[8:11], s4 offen offset:3072 sc1
    s_waitcnt vmcnt(0)
    v_max3_u32 v7, v23, v27, v31
    v_cmp_eq_u32 vcc, -1, v7
    s_cbranch_vccnz L_rt19_main_kernel
    s_branch L_ok19_main_kernel
L_rt20_main_kernel:
    s_cmp_eq_u32 s3, 0
    s_cbranch_scc1 L_ok20_main_kernel
    s_sub_u32 s3, s3, 1
    s_add_u32 s4, s45, 0x1000
    buffer_load_dwordx4 v[32:35], v5, s[8:11], s4 offen offset:0 sc1
    s_add_u32 s4, s45, 0x1000
    buffer_load_dwordx4 v[36:39], v5, s[8:11], s4 offen offset:1024 sc1
    s_add_u32 s4, s45, 0x1000
    buffer_load_dwordx4 v[40:43], v5, s[8:11], s4 offen offset:2048 sc1
    s_waitcnt vmcnt(0)
    v_max3_u32 v7, v35, v39, v43
    v_cmp_eq_u32 vcc, -1, v7
    s_cbranch_vccnz L_rt20_main_kernel
    s_branch L_ok20_main_kernel
L_rt21_main_kernel:
    s_cmp_eq_u32 s3, 0
    s_cbranch_scc1 L_ok21_main_kernel
    s_sub_u32 s3, s3, 1
    s_add_u32 s4, s45, 0x1000
    buffer_load_dwordx4 v[44:47], v5, s[8:11], s4 offen offset:3072 sc1
    s_add_u32 s4, s45, 0x2000
    buffer_load_dwordx4 v[48:51], v5, s[8:11], s4 offen offset:0 sc1
    s_add_u32 s4, s45, 0x2000
    buffer_load_dwordx4 v[52:55], v5, s[8:11], s4 offen offset:1024 sc1
    s_waitcnt vmcnt(0)
    v_max3_u32 v7, v47, v51, v55
    v_cmp_eq_u32 vcc, -1, v7
    s_cbranch_vccnz L_rt21_main_kernel
    s_branch L_ok21_main_kernel
L_rt22_main_kernel:
    s_cmp_eq_u32 s3, 0
    s_cbranch_scc1 L_ok22_main_kernel
    s_sub_u32 s3, s3, 1
    s_add_u32 s4, s45, 0x2000
    buffer_load_dwordx4 v[56:59], v5, s[8:11], s4 offen offset:2048 sc1
    s_add_u32 s4, s45, 0x2000
    buffer_load_dwordx4 v[60:63], v5, s[8:11], s4 offen offset:3072 sc1
    s_add_u32 s4, s45, 0x3000
    buffer_load_dwordx4 v[64:67], v5, s[8:11], s4 offen offset:0 sc1
    s_waitcnt vmcnt(0)
    v_max3_u32 v7, v59, v63, v67
    v_cmp_eq_u32 vcc, -1, v7
    s_cbranch_vccnz L_rt22_main_kernel
    s_branch L_ok22_main_kernel
L_rt23_main_kernel:
    s_cmp_eq_u32 s3, 0
    s_cbranch_scc1 L_ok23_main_kernel
    s_sub_u32 s3, s3, 1
    s_add_u32 s4, s45, 0x3000
    buffer_load_dwordx4 v[68:71], v5, s[8:11], s4 offen offset:1024 sc1
    s_add_u32 s4, s45, 0x3000
    buffer_load_dwordx4 v[72:75], v5, s[8:11], s4 offen offset:2048 sc1
    s_add_u32 s4, s45, 0x3000
    buffer_load_dwordx4 v[76:79], v5, s[8:11], s4 offen offset:3072 sc1
    s_waitcnt vmcnt(0)
    v_max3_u32 v7, v71, v75, v79
    v_cmp_eq_u32 vcc, -1, v7
    s_cbranch_vccnz L_rt23_main_kernel
    s_branch L_ok23_main_kernel
L_rt25_main_kernel:
    s_cmp_eq_u32 s3, 0
    s_cbranch_scc1 L_rt25_main_kernelx
    s_sub_u32 s3, s3, 1
    buffer_load_dwordx4 v[16:19], v113, s[8:11], 0 offen offset:0 sc1
    buffer_load_dwordx4 v[20:23], v113, s[8:11], 0 offen offset:1024 sc1
    buffer_load_dwordx4 v[24:27], v113, s[8:11], 0 offen offset:2048 sc1
    s_waitcnt vmcnt(2)
    v_cmp_eq_u32 vcc, -1, v19
    s_cbranch_vccnz L_rt25_main_kernel
L_rt25_main_kernelx:
    buffer_load_dwordx4 v[28:31], v113, s[8:11], 0 offen offset:3072 sc1
    buffer_load_dwordx4 v[32:35], v114, s[8:11], 0 offen offset:0 sc1
    buffer_load_dwordx4 v[36:39], v114, s[8:11], 0 offen offset:1024 sc1
    buffer_load_dwordx4 v[40:43], v114, s[8:11], 0 offen offset:2048 sc1
    buffer_load_dwordx4 v[44:47], v114, s[8:11], 0 offen offset:3072 sc1
    buffer_load_dwordx4 v[48:51], v115, s[8:11], 0 offen offset:0 sc1
    buffer_load_dwordx4 v[52:55], v115, s[8:11], 0 offen offset:1024 sc1
    buffer_load_dwordx4 v[56:59], v115, s[8:11], 0 offen offset:2048 sc1
    buffer_load_dwordx4 v[60:63], v115, s[8:11], 0 offen offset:3072 sc1
    s_branch L_ok25_main_kernel
L_rt26_main_kernel:
    s_cmp_eq_u32 s3, 0
    s_cbranch_scc1 L_rt26_main_kernelx
    s_sub_u32 s3, s3, 1
    buffer_load_dwordx4 v[20:23], v113, s[8:11], 0 offen offset:1024 sc1
    buffer_load_dwordx4 v[24:27], v113, s[8:11], 0 offen offset:2048 sc1
    buffer_load_dwordx4 v[28:31], v113, s[8:11], 0 offen offset:3072 sc1
    s_waitcnt vmcnt(0)
    v_max3_u32 v7, v23, v27, v31
    v_cmp_eq_u32 vcc, -1, v7
    s_cbranch_vccnz L_rt26_main_kernel
L_rt26_main_kernelx:
    buffer_load_dwordx4 v[32:35], v114, s[8:11], 0 offen offset:0 sc1
    buffer_load_dwordx4 v[36:39], v114, s[8:11], 0 offen offset:1024 sc1
    buffer_load_dwordx4 v[40:43], v114, s[8:11], 0 offen offset:2048 sc1
    buffer_load_dwordx4 v[44:47], v114, s[8:11], 0 offen offset:3072 sc1
    buffer_load_dwordx4 v[48:51], v115, s[8:11], 0 offen offset:0 sc1
    buffer_load_dwordx4 v[52:55], v115, s[8:11], 0 offen offset:1024 sc1
    buffer_load_dwordx4 v[56:59], v115, s[8:11], 0 offen offset:2048 sc1
    buffer_load_dwordx4 v[60:63], v115, s[8:11], 0 offen offset:3072 sc1
    buffer_load_dwordx4 v[64:67], v116, s[8:11], 0 offen offset:0 sc1
    s_branch L_ok26_main_kernel
L_rt27_main_kernel:
    s_cmp_eq_u32 s3, 0
    s_cbranch_scc1 L_rt27_main_kernelx
    s_sub_u32 s3, s3, 1
    buffer_load_dwordx4 v[32:35], v114, s[8:11], 0 offen offset:0 sc1
    buffer_load_dwordx4 v[36:39], v114, s[8:11], 0 offen offset:1024 sc1
    buffer_load_dwordx4 v[40:43], v114, s[8:11], 0 offen offset:2048 sc1
    s_waitcnt vmcnt(0)
    v_max3_u32 v7, v35, v39, v43
    v_cmp_eq_u32 vcc, -1, v7
    s_cbranch_vccnz L_rt27_main_kernel
L_rt27_main_kernelx:
    buffer_load_dwordx4 v[44:47], v114, s[8:11], 0 offen offset:3072 sc1
    buffer_load_dwordx4 v[48:51], v115, s[8:11], 0 offen offset:0 sc1
    buffer_load_dwordx4 v[52:55], v115, s[8:11], 0 offen offset:1024 sc1
    buffer_load_dwordx4 v[56:59], v115, s[8:11], 0 offen offset:2048 sc1
    buffer_load_dwordx4 v[60:63], v115, s[8:11], 0 offen offset:3072 sc1
    buffer_load_dwordx4 v[64:67], v116, s[8:11], 0 offen offset:0 sc1
    buffer_load_dwordx4 v[68:71], v116, s[8:11], 0 offen offset:1024 sc1
    buffer_load_dwordx4 v[72:75], v116, s[8:11], 0 offen offset:2048 sc1
    buffer_load_dwordx4 v[76:79], v116, s[8:11], 0 offen offset:3072 sc1
    s_branch L_ok27_main_kernel
L_rt28_main_kernel:
    s_cmp_eq_u32 s3, 0
    s_cbranch_scc1 L_rt28_main_kernelx
    s_sub_u32 s3, s3, 1
    buffer_load_dwordx4 v[44:47], v114, s[8:11], 0 offen offset:3072 sc1
    buffer_load_dwordx4 v[48:51], v115, s[8:11], 0 offen offset:0 sc1
    buffer_load_dwordx4 v[52:55], v115, s[8:11], 0 offen offset:1024 sc1
    s_waitcnt vmcnt(0)
    v_max3_u32 v7, v47, v51, v55
    v_cmp_eq_u32 vcc, -1, v7
    s_cbranch_vccnz L_rt28_main_kernel
L_rt28_main_kernelx:
    buffer_load_dwordx4 v[56:59], v115, s[8:11], 0 offen offset:2048 sc1
    buffer_load_dwordx4 v[60:63], v115, s[8:11], 0 offen offset:3072 sc1
    buffer_load_dwordx4 v[64:67], v116, s[8:11], 0 offen offset:0 sc1
    buffer_load_dwordx4 v[68:71], v116, s[8:11], 0 offen offset:1024 sc1
    buffer_load_dwordx4 v[72:75], v116, s[8:11], 0 offen offset:2048 sc1
    buffer_load_dwordx4 v[76:79], v116, s[8:11], 0 offen offset:3072 sc1
    s_branch L_ok28_main_kernel
L_rt29_main_kernel:
    s_cmp_eq_u32 s3, 0
    s_cbranch_scc1 L_rt29_main_kernelx
    s_sub_u32 s3, s3, 1
    buffer_load_dwordx4 v[56:59], v115, s[8:11], 0 offen offset:2048 sc1
    buffer_load_dwordx4 v[60:63], v115, s[8:11], 0 offen offset:3072 sc1
    buffer_load_dwordx4 v[64:67], v116, s[8:11], 0 offen offset:0 sc1
    s_waitcnt vmcnt(0)
    v_max3_u32 v7, v59, v63, v67
    v_cmp_eq_u32 vcc, -1, v7
    s_cbranch_vccnz L_rt29_main_kernel
L_rt29_main_kernelx:
    buffer_load_dwordx4 v[68:71], v116, s[8:11], 0 offen offset:1024 sc1
    buffer_load_dwordx4 v[72:75], v116, s[8:11], 0 offen offset:2048 sc1
    buffer_load_dwordx4 v[76:79], v116, s[8:11], 0 offen offset:3072 sc1
    s_branch L_ok29_main_kernel
L_rt30_main_kernel:
    s_cmp_eq_u32 s3, 0
    s_cbranch_scc1 L_rt30_main_kernelx
    s_sub_u32 s3, s3, 1
    buffer_load_dwordx4 v[68:71], v116, s[8:11], 0 offen offset:1024 sc1
    buffer_load_dwordx4 v[72:75], v116, s[8:11], 0 offen offset:2048 sc1
    buffer_load_dwordx4 v[76:79], v116, s[8:11], 0 offen offset:3072 sc1
    s_waitcnt vmcnt(0)
    v_max3_u32 v7, v71, v75, v79
    v_cmp_eq_u32 vcc, -1, v7
    s_cbranch_vccnz L_rt30_main_kernel
L_rt30_main_kernelx:
    s_branch L_ok30_main_kernel
L_pl31_main_kernel:
    s_cmp_eq_u32 s3, 0
    s_cbranch_scc1 L_px31_main_kernel
    s_sub_u32 s3, s3, 1
    buffer_load_dwordx2 v[16:17], v15, s[48:51], 0 offen offset:0 sc1
    buffer_load_dwordx2 v[18:19], v15, s[48:51], s96 offen offset:0 sc1
    buffer_load_dwordx2 v[20:21], v15, s[48:51], 0 offen offset:128 sc1
    buffer_load_dwordx2 v[22:23], v15, s[48:51], s96 offen offset:128 sc1
    s_add_u32 s38, s45, 0x0
    buffer_load_dwordx4 v[28:31], v5, s[8:11], s38 offen offset:0 sc1
    s_add_u32 s39, s45, 0x4000
    buffer_load_dwordx4 v[92:95], v5, s[8:11], s39 offen offset:0 sc1
    buffer_load_dwordx4 v[32:35], v5, s[8:11], s38 offen offset:1024 sc1
    buffer_load_dwordx4 v[96:99], v5, s[8:11], s39 offen offset:1024 sc1
    buffer_load_dwordx4 v[36:39], v5, s[8:11], s38 offen offset:2048 sc1
    buffer_load_dwordx4 v[100:103], v5, s[8:11], s39 offen offset:2048 sc1
    buffer_load_dwordx4 v[40:43], v5, s[8:11], s38 offen offset:3072 sc1
    buffer_load_dwordx4 v[104:107], v5, s[8:11], s39 offen offset:3072 sc1
    s_waitcnt vmcnt(8)
    v_max_u32 v7, v17, v19
    v_max3_u32 v7, v7, v21, v23
    v_cmp_eq_u32 vcc, -1, v7
    s_cbranch_vccnz L_pl31_main_kernel
    s_add_u32 s38, s45, 0x1000
    buffer_load_dwordx4 v[44:47], v5, s[8:11], s38 offen offset:0 sc1
    s_add_u32 s39, s45, 0x5000
    buffer_load_dwordx4 v[108:111], v5, s[8:11], s39 offen offset:0 sc1
    buffer_load_dwordx4 v[48:51], v5, s[8:11], s38 offen offset:1024 sc1
    buffer_load_dwordx4 v[112:115], v5, s[8:11], s39 offen offset:1024 sc1
    s_branch L_go31_main_kernel
L_px31_main_kernel:
    s_mov_b64 exec, -1
    s_add_u32 s38, s45, 0x0
    buffer_load_dwordx4 v[28:31], v5, s[8:11], s38 offen offset:0 sc1
    s_add_u32 s39, s45, 0x4000
    buffer_load_dwordx4 v[92:95], v5, s[8:11], s39 offen offset:0 sc1
    buffer_load_dwordx4 v[32:35], v5, s[8:11], s38 offen offset:1024 sc1
    buffer_load_dwordx4 v[96:99], v5, s[8:11], s39 offen offset:1024 sc1
    buffer_load_dwordx4 v[36:39], v5, s[8:11], s38 offen offset:2048 sc1
    buffer_load_dwordx4 v[100:103], v5, s[8:11], s39 offen offset:2048 sc1
    buffer_load_dwordx4 v[40:43], v5, s[8:11], s38 offen offset:3072 sc1
    buffer_load_dwordx4 v[104:107], v5, s[8:11], s39 offen offset:3072 sc1
    s_add_u32 s38, s45, 0x1000
    buffer_load_dwordx4 v[44:47], v5, s[8:11], s38 offen offset:0 sc1
    s_add_u32 s39, s45, 0x5000
    buffer_load_dwordx4 v[108:111], v5, s[8:11], s39 offen offset:0 sc1
    buffer_load_dwordx4 v[48:51], v5, s[8:11], s38 offen offset:1024 sc1
    buffer_load_dwordx4 v[112:115], v5, s[8:11], s39 offen offset:1024 sc1
    s_branch L_go31_main_kernel
L_rt32_main_kernel:
    s_cmp_eq_u32 s3, 0
    s_cbranch_scc1 L_ok32_main_kernel
    s_sub_u32 s3, s3, 1
    s_add_u32 s4, s45, 0x0
    buffer_load_dwordx4 v[28:31], v5, s[8:11], s4 offen offset:0 sc1
    s_add_u32 s4, s45, 0x4000
    buffer_load_dwordx4 v[92:95], v5, s[8:11], s4 offen offset:0 sc1
    s_waitcnt vmcnt(0)
    v_max_u32 v7, v31, v95
    v_cmp_eq_u32 vcc, -1, v7
    s_cbranch_vccnz L_rt32_main_kernel
    s_branch L_ok32_main_kernel
L_rt33_main_kernel:
    s_cmp_eq_u32 s3, 0
    s_cbranch_scc1 L_ok33_main_kernel
    s_sub_u32 s3, s3, 1
    s_add_u32 s4, s45, 0x0
    buffer_load_dwordx4 v[32:35], v5, s[8:11], s4 offen offset:1024 sc1
    s_add_u32 s4, s45, 0x4000
    buffer_load_dwordx4 v[96:99], v5, s[8:11], s4 offen offset:1024 sc1
    s_add_u32 s4, s45, 0x0
    buffer_load_dwordx4 v[36:39], v5, s[8:11], s4 offen offset:2048 sc1
    s_add_u32 s4, s45, 0x4000
    buffer_load_dwordx4 v[100:103], v5, s[8:11], s4 offen offset:2048 sc1
    s_waitcnt vmcnt(0)
    v_max3_u32 v7, v35, v99, v39
    v_max_u32 v7, v7, v103
    v_cmp_eq_u32 vcc, -1, v7
    s_cbranch_vccnz L_rt33_main_kernel
    s_branch L_ok33_main_kernel
L_rt34_main_kernel:
    s_cmp_eq_u32 s3, 0
    s_cbranch_scc1 L_ok34_main_kernel
    s_sub_u32 s3, s3, 1
    s_add_u32 s4, s45, 0x0
    buffer_load_dwordx4 v[40:43], v5, s[8:11], s4 offen offset:3072 sc1
    s_add_u32 s4, s45, 0x4000
    buffer_load_dwordx4 v[104:107], v5, s[8:11], s4 offen offset:3072 sc1
    s_add_u32 s4, s45, 0x1000
    buffer_load_dwordx4 v[44:47], v5, s[8:11], s4 offen offset:0 sc1
    s_add_u32 s4, s45, 0x5000
    buffer_load_dwordx4 v[108:111], v5, s[8:11], s4 offen offset:0 sc1
    s_waitcnt vmcnt(0)
    v_max3_u32 v7, v43, v107, v47
    v_max_u32 v7, v7, v111
    v_cmp_eq_u32 vcc, -1, v7
    s_cbranch_vccnz L_rt34_main_kernel
    s_branch L_ok34_main_kernel
L_rt35_main_kernel:
    s_cmp_eq_u32 s3, 0
    s_cbranch_scc1 L_ok35_main_kernel
    s_sub_u32 s3, s3, 1
    s_add_u32 s4, s45, 0x1000
    buffer_load_dwordx4 v[48:51], v5, s[8:11], s4 offen offset:1024 sc1
    s_add_u32 s4, s45, 0x5000
    buffer_load_dwordx4 v[112:115], v5, s[8:11], s4 offen offset:1024 sc1
    s_add_u32 s4, s45, 0x1000
    buffer_load_dwordx4 v[52:55], v5, s[8:11], s4 offen offset:2048 sc1
    s_add_u32 s4, s45, 0x5000
    buffer_load_dwordx4 v[116:119], v5, s[8:11], s4 offen offset:2048 sc1
    s_waitcnt vmcnt(0)
    v_max3_u32 v7, v51, v115, v55
    v_max_u32 v7, v7, v119
    v_cmp_eq_u32 vcc, -1, v7
    s_cbranch_vccnz L_rt35_main_kernel
    s_branch L_ok35_main_kernel
L_rt36_main_kernel:
    s_cmp_eq_u32 s3, 0
    s_cbranch_scc1 L_ok36_main_kernel
    s_sub_u32 s3, s3, 1
    s_add_u32 s4, s45, 0x1000
    buffer_load_dwordx4 v[56:59], v5, s[8:11], s4 offen offset:3072 sc1
    s_add_u32 s4, s45, 0x5000
    buffer_load_dwordx4 v[120:123], v5, s[8:11], s4 offen offset:3072 sc1
    s_add_u32 s4, s45, 0x2000
    buffer_load_dwordx4 v[60:63], v5, s[8:11], s4 offen offset:0 sc1
    s_add_u32 s4, s45, 0x6000
    buffer_load_dwordx4 v[124:127], v5, s[8:11], s4 offen offset:0 sc1
    s_waitcnt vmcnt(0)
    v_max3_u32 v7, v59, v123, v63
    v_max_u32 v7, v7, v127
    v_cmp_eq_u32 vcc, -1, v7
    s_cbranch_vccnz L_rt36_main_kernel
    s_branch L_ok36_main_kernel
L_rt37_main_kernel:
    s_cmp_eq_u32 s3, 0
    s_cbranch_scc1 L_ok37_main_kernel
    s_sub_u32 s3, s3, 1
    s_add_u32 s4, s45, 0x2000
    buffer_load_dwordx4 v[64:67], v5, s[8:11], s4 offen offset:1024 sc1
    s_add_u32 s4, s45, 0x6000
    buffer_load_dwordx4 v[128:131], v5, s[8:11], s4 offen offset:1024 sc1
    s_add_u32 s4, s45, 0x2000
    buffer_load_dwordx4 v[68:71], v5, s[8:11], s4 offen offset:2048 sc1
    s_add_u32 s4, s45, 0x6000
    buffer_load_dwordx4 v[132:135], v5, s[8:11], s4 offen offset:2048 sc1
    s_waitcnt vmcnt(0)
    v_max3_u32 v7, v67, v131, v71
    v_max_u32 v7, v7, v135
    v_cmp_eq_u32 vcc, -1, v7
    s_cbranch_vccnz L_rt37_main_kernel
    s_branch L_ok37_main_kernel
L_rt38_main_kernel:
    s_cmp_eq_u32 s3, 0
    s_cbranch_scc1 L_ok38_main_kernel
    s_sub_u32 s3, s3, 1
    s_add_u32 s4, s45, 0x2000
    buffer_load_dwordx4 v[72:75], v5, s[8:11], s4 offen offset:3072 sc1
    s_add_u32 s4, s45, 0x6000
    buffer_load_dwordx4 v[136:139], v5, s[8:11], s4 offen offset:3072 sc1
    s_add_u32 s4, s45, 0x3000
    buffer_load_dwordx4 v[76:79], v5, s[8:11], s4 offen offset:0 sc1
    s_add_u32 s4, s45, 0x7000
    buffer_load_dwordx4 v[140:143], v5, s[8:11], s4 offen offset:0 sc1
    s_waitcnt vmcnt(0)
    v_max3_u32 v7, v75, v139, v79
    v_max_u32 v7, v7, v143
    v_cmp_eq_u32 vcc, -1, v7
    s_cbranch_vccnz L_rt38_main_kernel
    s_branch L_ok38_main_kernel
L_rt39_main_kernel:
    s_cmp_eq_u32 s3, 0
    s_cbranch_scc1 L_ok39_main_kernel
    s_sub_u32 s3, s3, 1
    s_add_u32 s4, s45, 0x3000
    buffer_load_dwordx4 v[80:83], v5, s[8:11], s4 offen offset:1024 sc1
    s_add_u32 s4, s45, 0x7000
    buffer_load_dwordx4 v[144:147], v5, s[8:11], s4 offen offset:1024 sc1
    s_add_u32 s4, s45, 0x3000
    buffer_load_dwordx4 v[84:87], v5, s[8:11], s4 offen offset:2048 sc1
    s_add_u32 s4, s45, 0x7000
    buffer_load_dwordx4 v[148:151], v5, s[8:11], s4 offen offset:2048 sc1
    s_waitcnt vmcnt(0)
    v_max3_u32 v7, v83, v147, v87
    v_max_u32 v7, v7, v151
    v_cmp_eq_u32 vcc, -1, v7
    s_cbranch_vccnz L_rt39_main_kernel
    s_branch L_ok39_main_kernel
L_rt40_main_kernel:
    s_cmp_eq_u32 s3, 0
    s_cbranch_scc1 L_ok40_main_kernel
    s_sub_u32 s3, s3, 1
    s_add_u32 s4, s45, 0x3000
    buffer_load_dwordx4 v[88:91], v5, s[8:11], s4 offen offset:3072 sc1
    s_add_u32 s4, s45, 0x7000
    buffer_load_dwordx4 v[152:155], v5, s[8:11], s4 offen offset:3072 sc1
    s_waitcnt vmcnt(0)
    v_max_u32 v7, v91, v155
    v_cmp_eq_u32 vcc, -1, v7
    s_cbranch_vccnz L_rt40_main_kernel
    s_branch L_ok40_main_kernel
L_rt42_main_kernel:
    s_cmp_eq_u32 s3, 0
    s_cbranch_scc1 L_rt42_main_kernelx
    s_sub_u32 s3, s3, 1
    s_add_u32 s4, s45, 0x0
    buffer_load_dwordx4 v[20:23], v5, s[8:11], s4 offen offset:0 sc1
    s_add_u32 s4, s45, 0x0
    buffer_load_dwordx4 v[24:27], v5, s[8:11], s4 offen offset:1024 sc1
    s_add_u32 s4, s45, 0x0
    buffer_load_dwordx4 v[28:31], v5, s[8:11], s4 offen offset:2048 sc1
    s_waitcnt vmcnt(2)
    v_cmp_eq_u32 vcc, -1, v23
    s_cbranch_vccnz L_rt42_main_kernel
L_rt42_main_kernelx:
    s_add_u32 s4, s45, 0x0
    buffer_load_dwordx4 v[32:35], v5, s[8:11], s4 offen offset:3072 sc1
    s_add_u32 s4, s45, 0x1000
    buffer_load_dwordx4 v[36:39], v5, s[8:11], s4 offen offset:0 sc1
    s_add_u32 s4, s45, 0x1000
    buffer_load_dwordx4 v[40:43], v5, s[8:11], s4 offen offset:1024 sc1
    s_add_u32 s4, s45, 0x1000
    buffer_load_dwordx4 v[44:47], v5, s[8:11], s4 offen offset:2048 sc1
    s_add_u32 s4, s45, 0x1000
    buffer_load_dwordx4 v[48:51], v5, s[8:11], s4 offen offset:3072 sc1
    s_add_u32 s4, s45, 0x2000
    buffer_load_dwordx4 v[52:55], v5, s[8:11], s4 offen offset:0 sc1
    s_add_u32 s4, s45, 0x2000
    buffer_load_dwordx4 v[56:59], v5, s[8:11], s4 offen offset:1024 sc1
    s_add_u32 s4, s45, 0x2000
    buffer_load_dwordx4 v[60:63], v5, s[8:11], s4 offen offset:2048 sc1
    s_add_u32 s4, s45, 0x2000
    buffer_load_dwordx4 v[64:67], v5, s[8:11], s4 offen offset:3072 sc1
    s_branch L_ok42_main_kernel
L_rt43_main_kernel:
    s_cmp_eq_u32 s3, 0
    s_cbranch_scc1 L_rt43_main_kernelx
    s_sub_u32 s3, s3, 1
    s_add_u32 s4, s45, 0x0
    buffer_load_dwordx4 v[24:27], v5, s[8:11], s4 offen offset:1024 sc1
    s_add_u32 s4, s45, 0x0
    buffer_load_dwordx4 v[28:31], v5, s[8:11], s4 offen offset:2048 sc1
    s_add_u32 s4, s45, 0x0
    buffer_load_dwordx4 v[32:35], v5, s[8:11], s4 offen offset:3072 sc1
    s_waitcnt vmcnt(0)
    v_max3_u32 v7, v27, v31, v35
    v_cmp_eq_u32 vcc, -1, v7
    s_cbranch_vccnz L_rt43_main_kernel
L_rt43_main_kernelx:
    s_add_u32 s4, s45, 0x1000
    buffer_load_dwordx4 v[36:39], v5, s[8:11], s4 offen offset:0 sc1
    s_add_u32 s4, s45, 0x1000
    buffer_load_dwordx4 v[40:43], v5, s[8:11], s4 offen offset:1024 sc1
    s_add_u32 s4, s45, 0x1000
    buffer_load_dwordx4 v[44:47], v5, s[8:11], s4 offen offset:2048 sc1
    s_add_u32 s4, s45, 0x1000
    buffer_load_dwordx4 v[48:51], v5, s[8:11], s4 offen offset:3072 sc1
    s_add_u32 s4, s45, 0x2000
    buffer_load_dwordx4 v[52:55], v5, s[8:11], s4 offen offset:0 sc1
    s_add_u32 s4, s45, 0x2000
    buffer_load_dwordx4 v[56:59], v5, s[8:11], s4 offen offset:1024 sc1
    s_add_u32 s4, s45, 0x2000
    buffer_load_dwordx4 v[60:63], v5, s[8:11], s4 offen offset:2048 sc1
    s_add_u32 s4, s45, 0x2000
    buffer_load_dwordx4 v[64:67], v5, s[8:11], s4 offen offset:3072 sc1
    s_add_u32 s4, s45, 0x3000
    buffer_load_dwordx4 v[68:71], v5, s[8:11], s4 offen offset:0 sc1
    s_branch L_ok43_main_kernel
L_rt44_main_kernel:
    s_cmp_eq_u32 s3, 0
    s_cbranch_scc1 L_rt44_main_kernelx
    s_sub_u32 s3, s3, 1
    s_add_u32 s4, s45, 0x1000
    buffer_load_dwordx4 v[36:39], v5, s[8:11], s4 offen offset:0 sc1
    s_add_u32 s4, s45, 0x1000
    buffer_load_dwordx4 v[40:43], v5, s[8:11], s4 offen offset:1024 sc1
    s_add_u32 s4, s45, 0x1000
    buffer_load_dwordx4 v[44:47], v5, s[8:11], s4 offen offset:2048 sc1
    s_waitcnt vmcnt(0)
    v_max3_u32 v7, v39, v43, v47
    v_cmp_eq_u32 vcc, -1, v7
    s_cbranch_vccnz L_rt44_main_kernel
L_rt44_main_kernelx:
    s_add_u32 s4, s45, 0x1000
    buffer_load_dwordx4 v[48:51], v5, s[8:11], s4 offen offset:3072 sc1
    s_add_u32 s4, s45, 0x2000
    buffer_load_dwordx4 v[52:55], v5, s[8:11], s4 offen offset:0 sc1
    s_add_u32 s4, s45, 0x2000
    buffer_load_dwordx4 v[56:59], v5, s[8:11], s4 offen offset:1024 sc1
    s_add_u32 s4, s45, 0x2000
    buffer_load_dwordx4 v[60:63], v5, s[8:11], s4 offen offset:2048 sc1
    s_add_u32 s4, s45, 0x2000
    buffer_load_dwordx4 v[64:67], v5, s[8:11], s4 offen offset:3072 sc1
    s_add_u32 s4, s45, 0x3000
    buffer_load_dwordx4 v[68:71], v5, s[8:11], s4 offen offset:0 sc1
    s_add_u32 s4, s45, 0x3000
    buffer_load_dwordx4 v[72:75], v5, s[8:11], s4 offen offset:1024 sc1
    s_add_u32 s4, s45, 0x3000
    buffer_load_dwordx4 v[76:79], v5, s[8:11], s4 offen offset:2048 sc1
    s_add_u32 s4, s45, 0x3000
    buffer_load_dwordx4 v[80:83], v5, s[8:11], s4 offen offset:3072 sc1
    s_branch L_ok44_main_kernel
L_rt45_main_kernel:
    s_cmp_eq_u32 s3, 0
    s_cbranch_scc1 L_rt45_main_kernelx
    s_sub_u32 s3, s3, 1
    s_add_u32 s4, s45, 0x1000
    buffer_load_dwordx4 v[48:51], v5, s[8:11], s4 offen offset:3072 sc1
    s_add_u32 s4, s45, 0x2000
    buffer_load_dwordx4 v[52:55], v5, s[8:11], s4 offen offset:0 sc1
    s_add_u32 s4, s45, 0x2000
    buffer_load_dwordx4 v[56:59], v5, s[8:11], s4 offen offset:1024 sc1
    s_waitcnt vmcnt(0)
    v_max3_u32 v7, v51, v55, v59
    v_cmp_eq_u32 vcc, -1, v7
    s_cbranch_vccnz L_rt45_main_kernel
L_rt45_main_kernelx:
    s_add_u32 s4, s45, 0x2000
    buffer_load_dwordx4 v[60:63], v5, s[8:11], s4 offen offset:2048 sc1
    s_add_u32 s4, s45, 0x2000
    buffer_load_dwordx4 v[64:67], v5, s[8:11], s4 offen offset:3072 sc1
    s_add_u32 s4, s45, 0x3000
    buffer_load_dwordx4 v[68:71], v5, s[8:11], s4 offen offset:0 sc1
    s_add_u32 s4, s45, 0x3000
    buffer_load_dwordx4 v[72:75], v5, s[8:11], s4 offen offset:1024 sc1
    s_add_u32 s4, s45, 0x3000
    buffer_load_dwordx4 v[76:79], v5, s[8:11], s4 offen offset:2048 sc1
    s_add_u32 s4, s45, 0x3000
    buffer_load_dwordx4 v[80:83], v5, s[8:11], s4 offen offset:3072 sc1
    s_add_u32 s4, s45, 0x4000
    buffer_load_dwordx4 v[84:87], v5, s[8:11], s4 offen offset:0 sc1
    s_add_u32 s4, s45, 0x4000
    buffer_load_dwordx4 v[88:91], v5, s[8:11], s4 offen offset:1024 sc1
    s_add_u32 s4, s45, 0x4000
    buffer_load_dwordx4 v[92:95], v5, s[8:11], s4 offen offset:2048 sc1
    s_branch L_ok45_main_kernel
L_rt46_main_kernel:
    s_cmp_eq_u32 s3, 0
    s_cbranch_scc1 L_rt46_main_kernelx
    s_sub_u32 s3, s3, 1
    s_add_u32 s4, s45, 0x2000
    buffer_load_dwordx4 v[60:63], v5, s[8:11], s4 offen offset:2048 sc1
    s_add_u32 s4, s45, 0x2000
    buffer_load_dwordx4 v[64:67], v5, s[8:11], s4 offen offset:3072 sc1
    s_add_u32 s4, s45, 0x3000
    buffer_load_dwordx4 v[68:71], v5, s[8:11], s4 offen offset:0 sc1
    s_waitcnt vmcnt(0)
    v_max3_u32 v7, v63, v67, v71
    v_cmp_eq_u32 vcc, -1, v7
    s_cbranch_vccnz L_rt46_main_kernel
L_rt46_main_kernelx:
    s_add_u32 s4, s45, 0x3000
    buffer_load_dwordx4 v[72:75], v5, s[8:11], s4 offen offset:1024 sc1
    s_add_u32 s4, s45, 0x3000
    buffer_load_dwordx4 v[76:79], v5, s[8:11], s4 offen offset:2048 sc1
    s_add_u32 s4, s45, 0x3000
    buffer_load_dwordx4 v[80:83], v5, s[8:11], s4 offen offset:3072 sc1
    s_add_u32 s4, s45, 0x4000
    buffer_load_dwordx4 v[84:87], v5, s[8:11], s4 offen offset:0 sc1
    s_add_u32 s4, s45, 0x4000
    buffer_load_dwordx4 v[88:91], v5, s[8:11], s4 offen offset:1024 sc1
    s_add_u32 s4, s45, 0x4000
    buffer_load_dwordx4 v[92:95], v5, s[8:11], s4 offen offset:2048 sc1
    s_add_u32 s4, s45, 0x4000
    buffer_load_dwordx4 v[96:99], v5, s[8:11], s4 offen offset:3072 sc1
    s_add_u32 s4, s45, 0x5000
    buffer_load_dwordx4 v[100:103], v5, s[8:11], s4 offen offset:0 sc1
    s_add_u32 s4, s45, 0x5000
    buffer_load_dwordx4 v[104:107], v5, s[8:11], s4 offen offset:1024 sc1
    s_branch L_ok46_main_kernel
L_rt47_main_kernel:
    s_cmp_eq_u32 s3, 0
    s_cbranch_scc1 L_rt47_main_kernelx
    s_sub_u32 s3, s3, 1
    s_add_u32 s4, s45, 0x3000
    buffer_load_dwordx4 v[72:75], v5, s[8:11], s4 offen offset:1024 sc1
    s_add_u32 s4, s45, 0x3000
    buffer_load_dwordx4 v[76:79], v5, s[8:11], s4 offen offset:2048 sc1
    s_add_u32 s4, s45, 0x3000
    buffer_load_dwordx4 v[80:83], v5, s[8:11], s4 offen offset:3072 sc1
    s_waitcnt vmcnt(0)
    v_max3_u32 v7, v75, v79, v83
    v_cmp_eq_u32 vcc, -1, v7
    s_cbranch_vccnz L_rt47_main_kernel
L_rt47_main_kernelx:
    s_add_u32 s4, s45, 0x4000
    buffer_load_dwordx4 v[84:87], v5, s[8:11], s4 offen offset:0 sc1
    s_add_u32 s4, s45, 0x4000
    buffer_load_dwordx4 v[88:91], v5, s[8:11], s4 offen offset:1024 sc1
    s_add_u32 s4, s45, 0x4000
    buffer_load_dwordx4 v[92:95], v5, s[8:11], s4 offen offset:2048 sc1
    s_add_u32 s4, s45, 0x4000
    buffer_load_dwordx4 v[96:99], v5, s[8:11], s4 offen offset:3072 sc1
    s_add_u32 s4, s45, 0x5000
    buffer_load_dwordx4 v[100:103], v5, s[8:11], s4 offen offset:0 sc1
    s_add_u32 s4, s45, 0x5000
    buffer_load_dwordx4 v[104:107], v5, s[8:11], s4 offen offset:1024 sc1
    s_add_u32 s4, s45, 0x5000
    buffer_load_dwordx4 v[108:111], v5, s[8:11], s4 offen offset:2048 sc1
    s_add_u32 s4, s45, 0x5000
    buffer_load_dwordx4 v[112:115], v5, s[8:11], s4 offen offset:3072 sc1
    s_add_u32 s4, s45, 0x6000
    buffer_load_dwordx4 v[116:119], v5, s[8:11], s4 offen offset:0 sc1
    s_branch L_ok47_main_kernel
L_rt48_main_kernel:
    s_cmp_eq_u32 s3, 0
    s_cbranch_scc1 L_rt48_main_kernelx
    s_sub_u32 s3, s3, 1
    s_add_u32 s4, s45, 0x4000
    buffer_load_dwordx4 v[84:87], v5, s[8:11], s4 offen offset:0 sc1
    s_add_u32 s4, s45, 0x4000
    buffer_load_dwordx4 v[88:91], v5, s[8:11], s4 offen offset:1024 sc1
    s_add_u32 s4, s45, 0x4000
    buffer_load_dwordx4 v[92:95], v5, s[8:11], s4 offen offset:2048 sc1
    s_waitcnt vmcnt(0)
    v_max3_u32 v7, v87, v91, v95
    v_cmp_eq_u32 vcc, -1, v7
    s_cbranch_vccnz L_rt48_main_kernel
L_rt48_main_kernelx:
    s_add_u32 s4, s45, 0x4000
    buffer_load_dwordx4 v[96:99], v5, s[8:11], s4 offen offset:3072 sc1
    s_add_u32 s4, s45, 0x5000
    buffer_load_dwordx4 v[100:103], v5, s[8:11], s4 offen offset:0 sc1
    s_add_u32 s4, s45, 0x5000
    buffer_load_dwordx4 v[104:107], v5, s[8:11], s4 offen offset:1024 sc1
    s_add_u32 s4, s45, 0x5000
    buffer_load_dwordx4 v[108:111], v5, s[8:11], s4 offen offset:2048 sc1
    s_add_u32 s4, s45, 0x5000
    buffer_load_dwordx4 v[112:115], v5, s[8:11], s4 offen offset:3072 sc1
    s_add_u32 s4, s45, 0x6000
    buffer_load_dwordx4 v[116:119], v5, s[8:11], s4 offen offset:0 sc1
    s_add_u32 s4, s45, 0x6000
    buffer_load_dwordx4 v[120:123], v5, s[8:11], s4 offen offset:1024 sc1
    s_add_u32 s4, s45, 0x6000
    buffer_load_dwordx4 v[124:127], v5, s[8:11], s4 offen offset:2048 sc1
    s_add_u32 s4, s45, 0x6000
    buffer_load_dwordx4 v[128:131], v5, s[8:11], s4 offen offset:3072 sc1
    s_branch L_ok48_main_kernel
L_rt49_main_kernel:
    s_cmp_eq_u32 s3, 0
    s_cbranch_scc1 L_rt49_main_kernelx
    s_sub_u32 s3, s3, 1
    s_add_u32 s4, s45, 0x4000
    buffer_load_dwordx4 v[96:99], v5, s[8:11], s4 offen offset:3072 sc1
    s_add_u32 s4, s45, 0x5000
    buffer_load_dwordx4 v[100:103], v5, s[8:11], s4 offen offset:0 sc1
    s_add_u32 s4, s45, 0x5000
    buffer_load_dwordx4 v[104:107], v5, s[8:11], s4 offen offset:1024 sc1
    s_waitcnt vmcnt(0)
    v_max3_u32 v7, v99, v103, v107
    v_cmp_eq_u32 vcc, -1, v7
    s_cbranch_vccnz L_rt49_main_kernel
L_rt49_main_kernelx:
    s_add_u32 s4, s45, 0x5000
    buffer_load_dwordx4 v[108:111], v5, s[8:11], s4 offen offset:2048 sc1
    s_add_u32 s4, s45, 0x5000
    buffer_load_dwordx4 v[112:115], v5, s[8:11], s4 offen offset:3072 sc1
    s_add_u32 s4, s45, 0x6000
    buffer_load_dwordx4 v[116:119], v5, s[8:11], s4 offen offset:0 sc1
    s_add_u32 s4, s45, 0x6000
    buffer_load_dwordx4 v[120:123], v5, s[8:11], s4 offen offset:1024 sc1
    s_add_u32 s4, s45, 0x6000
    buffer_load_dwordx4 v[124:127], v5, s[8:11], s4 offen offset:2048 sc1
    s_add_u32 s4, s45, 0x6000
    buffer_load_dwordx4 v[128:131], v5, s[8:11], s4 offen offset:3072 sc1
    s_add_u32 s4, s45, 0x7000
    buffer_load_dwordx4 v[132:135], v5, s[8:11], s4 offen offset:0 sc1
    s_add_u32 s4, s45, 0x7000
    buffer_load_dwordx4 v[136:139], v5, s[8:11], s4 offen offset:1024 sc1
    s_add_u32 s4, s45, 0x7000
    buffer_load_dwordx4 v[140:143], v5, s[8:11], s4 offen offset:2048 sc1
    s_branch L_ok49_main_kernel
L_rt50_main_kernel:
    s_cmp_eq_u32 s3, 0
    s_cbranch_scc1 L_rt50_main_kernelx
    s_sub_u32 s3, s3, 1
    s_add_u32 s4, s45, 0x5000
    buffer_load_dwordx4 v[108:111], v5, s[8:11], s4 offen offset:2048 sc1
    s_add_u32 s4, s45, 0x5000
    buffer_load_dwordx4 v[112:115], v5, s[8:11], s4 offen offset:3072 sc1
    s_add_u32 s4, s45, 0x6000
    buffer_load_dwordx4 v[116:119], v5, s[8:11], s4 offen offset:0 sc1
    s_waitcnt vmcnt(0)
    v_max3_u32 v7, v111, v115, v119
    v_cmp_eq_u32 vcc, -1, v7
    s_cbranch_vccnz L_rt50_main_kernel
L_rt50_main_kernelx:
    s_add_u32 s4, s45, 0x6000
    buffer_load_dwordx4 v[120:123], v5, s[8:11], s4 offen offset:1024 sc1
    s_add_u32 s4, s45, 0x6000
    buffer_load_dwordx4 v[124:127], v5, s[8:11], s4 offen offset:2048 sc1
    s_add_u32 s4, s45, 0x6000
    buffer_load_dwordx4 v[128:131], v5, s[8:11], s4 offen offset:3072 sc1
    s_add_u32 s4, s45, 0x7000
    buffer_load_dwordx4 v[132:135], v5, s[8:11], s4 offen offset:0 sc1
    s_add_u32 s4, s45, 0x7000
    buffer_load_dwordx4 v[136:139], v5, s[8:11], s4 offen offset:1024 sc1
    s_add_u32 s4, s45, 0x7000
    buffer_load_dwordx4 v[140:143], v5, s[8:11], s4 offen offset:2048 sc1
    s_add_u32 s4, s45, 0x7000
    buffer_load_dwordx4 v[144:147], v5, s[8:11], s4 offen offset:3072 sc1
    s_add_u32 s4, s45, 0x8000
    buffer_load_dwordx4 v[148:151], v5, s[8:11], s4 offen offset:0 sc1
    s_add_u32 s4, s45, 0x8000
    buffer_load_dwordx4 v[152:155], v5, s[8:11], s4 offen offset:1024 sc1
    s_branch L_ok50_main_kernel
L_rt51_main_kernel:
    s_cmp_eq_u32 s3, 0
    s_cbranch_scc1 L_rt51_main_kernelx
    s_sub_u32 s3, s3, 1
    s_add_u32 s4, s45, 0x6000
    buffer_load_dwordx4 v[120:123], v5, s[8:11], s4 offen offset:1024 sc1
    s_add_u32 s4, s45, 0x6000
    buffer_load_dwordx4 v[124:127], v5, s[8:11], s4 offen offset:2048 sc1
    s_add_u32 s4, s45, 0x6000
    buffer_load_dwordx4 v[128:131], v5, s[8:11], s4 offen offset:3072 sc1
    s_waitcnt vmcnt(0)
    v_max3_u32 v7, v123, v127, v131
    v_cmp_eq_u32 vcc, -1, v7
    s_cbranch_vccnz L_rt51_main_kernel
L_rt51_main_kernelx:
    s_add_u32 s4, s45, 0x7000
    buffer_load_dwordx4 v[132:135], v5, s[8:11], s4 offen offset:0 sc1
    s_add_u32 s4, s45, 0x7000
    buffer_load_dwordx4 v[136:139], v5, s[8:11], s4 offen offset:1024 sc1
    s_add_u32 s4, s45, 0x7000
    buffer_load_dwordx4 v[140:143], v5, s[8:11], s4 offen offset:2048 sc1
    s_add_u32 s4, s45, 0x7000
    buffer_load_dwordx4 v[144:147], v5, s[8:11], s4 offen offset:3072 sc1
    s_add_u32 s4, s45, 0x8000
    buffer_load_dwordx4 v[148:151], v5, s[8:11], s4 offen offset:0 sc1
    s_add_u32 s4, s45, 0x8000
    buffer_load_dwordx4 v[152:155], v5, s[8:11], s4 offen offset:1024 sc1
    s_add_u32 s4, s45, 0x8000
    buffer_load_dwordx4 v[156:159], v5, s[8:11], s4 offen offset:2048 sc1
    s_add_u32 s4, s45, 0x8000
    buffer_load_dwordx4 v[160:163], v5, s[8:11], s4 offen offset:3072 sc1
    s_add_u32 s4, s45, 0x9000
    buffer_load_dwordx4 v[164:167], v5, s[8:11], s4 offen offset:0 sc1
    s_branch L_ok51_main_kernel
L_rt52_main_kernel:
    s_cmp_eq_u32 s3, 0
    s_cbranch_scc1 L_rt52_main_kernelx
    s_sub_u32 s3, s3, 1
    s_add_u32 s4, s45, 0x7000
    buffer_load_dwordx4 v[132:135], v5, s[8:11], s4 offen offset:0 sc1
    s_add_u32 s4, s45, 0x7000
    buffer_load_dwordx4 v[136:139], v5, s[8:11], s4 offen offset:1024 sc1
    s_add_u32 s4, s45, 0x7000
    buffer_load_dwordx4 v[140:143], v5, s[8:11], s4 offen offset:2048 sc1
    s_waitcnt vmcnt(0)
    v_max3_u32 v7, v135, v139, v143
    v_cmp_eq_u32 vcc, -1, v7
    s_cbranch_vccnz L_rt52_main_kernel
L_rt52_main_kernelx:
    s_add_u32 s4, s45, 0x7000
    buffer_load_dwordx4 v[144:147], v5, s[8:11], s4 offen offset:3072 sc1
    s_add_u32 s4, s45, 0x8000
    buffer_load_dwordx4 v[148:151], v5, s[8:11], s4 offen offset:0 sc1
    s_add_u32 s4, s45, 0x8000
    buffer_load_dwordx4 v[152:155], v5, s[8:11], s4 offen offset:1024 sc1
    s_add_u32 s4, s45, 0x8000
    buffer_load_dwordx4 v[156:159], v5, s[8:11], s4 offen offset:2048 sc1
    s_add_u32 s4, s45, 0x8000
    buffer_load_dwordx4 v[160:163], v5, s[8:11], s4 offen offset:3072 sc1
    s_add_u32 s4, s45, 0x9000
    buffer_load_dwordx4 v[164:167], v5, s[8:11], s4 offen offset:0 sc1
    s_add_u32 s4, s45, 0x9000
    buffer_load_dwordx4 v[168:171], v5, s[8:11], s4 offen offset:1024 sc1
    s_add_u32 s4, s45, 0x9000
    buffer_load_dwordx4 v[172:175], v5, s[8:11], s4 offen offset:2048 sc1
    s_add_u32 s4, s45, 0x9000
    buffer_load_dwordx4 v[176:179], v5, s[8:11], s4 offen offset:3072 sc1
    s_branch L_ok52_main_kernel
L_rt53_main_kernel:
    s_cmp_eq_u32 s3, 0
    s_cbranch_scc1 L_rt53_main_kernelx
    s_sub_u32 s3, s3, 1
    s_add_u32 s4, s45, 0x7000
    buffer_load_dwordx4 v[144:147], v5, s[8:11], s4 offen offset:3072 sc1
    s_add_u32 s4, s45, 0x8000
    buffer_load_dwordx4 v[148:151], v5, s[8:11], s4 offen offset:0 sc1
    s_add_u32 s4, s45, 0x8000
    buffer_load_dwordx4 v[152:155], v5, s[8:11], s4 offen offset:1024 sc1
    s_waitcnt vmcnt(0)
    v_max3_u32 v7, v147, v151, v155
    v_cmp_eq_u32 vcc, -1, v7
    s_cbranch_vccnz L_rt53_main_kernel
L_rt53_main_kernelx:
    s_add_u32 s4, s45, 0x8000
    buffer_load_dwordx4 v[156:159], v5, s[8:11], s4 offen offset:2048 sc1
    s_add_u32 s4, s45, 0x8000
    buffer_load_dwordx4 v[160:163], v5, s[8:11], s4 offen offset:3072 sc1
    s_add_u32 s4, s45, 0x9000
    buffer_load_dwordx4 v[164:167], v5, s[8:11], s4 offen offset:0 sc1
    s_add_u32 s4, s45, 0x9000
    buffer_load_dwordx4 v[168:171], v5, s[8:11], s4 offen offset:1024 sc1
    s_add_u32 s4, s45, 0x9000
    buffer_load_dwordx4 v[172:175], v5, s[8:11], s4 offen offset:2048 sc1
    s_add_u32 s4, s45, 0x9000
    buffer_load_dwordx4 v[176:179], v5, s[8:11], s4 offen offset:3072 sc1
    s_add_u32 s4, s45, 0xa000
    buffer_load_dwordx4 v[180:183], v5, s[8:11], s4 offen offset:0 sc1
    s_add_u32 s4, s45, 0xa000
    buffer_load_dwordx4 v[184:187], v5, s[8:11], s4 offen offset:1024 sc1
    s_add_u32 s4, s45, 0xa000
    buffer_load_dwordx4 v[188:191], v5, s[8:11], s4 offen offset:2048 sc1
    s_branch L_ok53_main_kernel
L_rt54_main_kernel:
    s_cmp_eq_u32 s3, 0
    s_cbranch_scc1 L_rt54_main_kernelx
    s_sub_u32 s3, s3, 1
    s_add_u32 s4, s45, 0x8000
    buffer_load_dwordx4 v[156:159], v5, s[8:11], s4 offen offset:2048 sc1
    s_add_u32 s4, s45, 0x8000
    buffer_load_dwordx4 v[160:163], v5, s[8:11], s4 offen offset:3072 sc1
    s_add_u32 s4, s45, 0x9000
    buffer_load_dwordx4 v[164:167], v5, s[8:11], s4 offen offset:0 sc1
    s_waitcnt vmcnt(0)
    v_max3_u32 v7, v159, v163, v167
    v_cmp_eq_u32 vcc, -1, v7
    s_cbranch_vccnz L_rt54_main_kernel
L_rt54_main_kernelx:
    s_add_u32 s4, s45, 0x9000
    buffer_load_dwordx4 v[168:171], v5, s[8:11], s4 offen offset:1024 sc1
    s_add_u32 s4, s45, 0x9000
    buffer_load_dwordx4 v[172:175], v5, s[8:11], s4 offen offset:2048 sc1
    s_add_u32 s4, s45, 0x9000
    buffer_load_dwordx4 v[176:179], v5, s[8:11], s4 offen offset:3072 sc1
    s_add_u32 s4, s45, 0xa000
    buffer_load_dwordx4 v[180:183], v5, s[8:11], s4 offen offset:0 sc1
    s_add_u32 s4, s45, 0xa000
    buffer_load_dwordx4 v[184:187], v5, s[8:11], s4 offen offset:1024 sc1
    s_add_u32 s4, s45, 0xa000
    buffer_load_dwordx4 v[188:191], v5, s[8:11], s4 offen offset:2048 sc1
    s_branch L_ok54_main_kernel
L_rt55_main_kernel:
    s_cmp_eq_u32 s3, 0
    s_cbranch_scc1 L_rt55_main_kernelx
    s_sub_u32 s3, s3, 1
    s_add_u32 s4, s45, 0x9000
    buffer_load_dwordx4 v[168:171], v5, s[8:11], s4 offen offset:1024 sc1
    s_add_u32 s4, s45, 0x9000
    buffer_load_dwordx4 v[172:175], v5, s[8:11], s4 offen offset:2048 sc1
    s_add_u32 s4, s45, 0x9000
    buffer_load_dwordx4 v[176:179], v5, s[8:11], s4 offen offset:3072 sc1
    s_waitcnt vmcnt(0)
    v_max3_u32 v7, v171, v175, v179
    v_cmp_eq_u32 vcc, -1, v7
    s_cbranch_vccnz L_rt55_main_kernel
L_rt55_main_kernelx:
    s_add_u32 s4, s45, 0xa000
    buffer_load_dwordx4 v[180:183], v5, s[8:11], s4 offen offset:0 sc1
    s_add_u32 s4, s45, 0xa000
    buffer_load_dwordx4 v[184:187], v5, s[8:11], s4 offen offset:1024 sc1
    s_add_u32 s4, s45, 0xa000
    buffer_load_dwordx4 v[188:191], v5, s[8:11], s4 offen offset:2048 sc1
    s_branch L_ok55_main_kernel
L_rt56_main_kernel:
    s_cmp_eq_u32 s3, 0
    s_cbranch_scc1 L_rt56_main_kernelx
    s_sub_u32 s3, s3, 1
    s_add_u32 s4, s45, 0xa000
    buffer_load_dwordx4 v[180:183], v5, s[8:11], s4 offen offset:0 sc1
    s_add_u32 s4, s45, 0xa000
    buffer_load_dwordx4 v[184:187], v5, s[8:11], s4 offen offset:1024 sc1
    s_add_u32 s4, s45, 0xa000
    buffer_load_dwordx4 v[188:191], v5, s[8:11], s4 offen offset:2048 sc1
    s_waitcnt vmcnt(0)
    v_max3_u32 v7, v183, v187, v191
    v_cmp_eq_u32 vcc, -1, v7
    s_cbranch_vccnz L_rt56_main_kernel
L_rt56_main_kernelx:
    s_branch L_ok56_main_kernel
L_end_main_kernel:
    s_endpgm
.section .rodata,"a"
.p2align 6
.amdhsa_kernel main_kernel
  .amdhsa_next_free_vgpr 256
  .amdhsa_next_free_sgpr 102
  .amdhsa_accum_offset 256
  .amdhsa_group_segment_fixed_size 0
  .amdhsa_kernarg_size 96
  .amdhsa_user_sgpr_count 2
  .amdhsa_user_sgpr_kernarg_segment_ptr 1
  .amdhsa_system_sgpr_workgroup_id_x 1
.end_amdhsa_kernel
```
